```python
import torch

def _softmax(x, axis=-1):
    return torch.softmax(x, dim=axis)
def _gelu(x):
    return torch.nn.functional.gelu(x, approximate="tanh")
def _silu(x):
    return torch.nn.functional.silu(x)
def _sigmoid(x):
    return torch.sigmoid(x)
def _layernorm(x, axis=-1, eps=1e-5):
    m = x.mean(dim=axis, keepdim=True)
    v = x.var(dim=axis, keepdim=True, unbiased=False)
    return (x - m) / torch.sqrt(v + eps)
def _scatter_add(tgt, idx, src, axis=0):
    return tgt.clone().index_add_(axis, idx, src)
def _segment_sum(src, seg, n):
    out = torch.zeros((n,) + src.shape[1:], dtype=src.dtype)
    return out.index_add_(0, seg, src)
def _pad(x, pw):
    flat = tuple(v for pair in reversed(pw) for v in pair)
    return torch.nn.functional.pad(x, flat)

kernel_name = 'sequential_preLN__softmax_full_mha__swiglu_ffn__prompt'

def setup_inputs():

    _w = (lambda a: (lambda t: t.to(torch.bfloat16) if t.is_floating_point() else t)(torch.as_tensor(a)))
    def _A_setup():
        B, S, D = 1, 2048, 640
        return {
            "x": _w((lambda *s: torch.randn(*s, dtype=torch.bfloat16) * 0.05)(B, S, D)),
            "wqkv": _w((lambda *s: torch.randn(*s, dtype=torch.bfloat16) * 0.05)(D, 3 * D)),
            "wo": _w((lambda *s: torch.randn(*s, dtype=torch.bfloat16) * 0.05)(D, D)),
        }
    _A_in = _A_setup()

    def _B_setup():
        B, S, D, F = 1, 2048, 640, 1536
        return {
            "x": _w((lambda *s: torch.randn(*s, dtype=torch.bfloat16) * 0.05)(B, S, D)),
            "w_gate": _w((lambda *s: torch.randn(*s, dtype=torch.bfloat16) * 0.05)(D, F)),
            "w_up": _w((lambda *s: torch.randn(*s, dtype=torch.bfloat16) * 0.05)(D, F)),
            "w_down": _w((lambda *s: torch.randn(*s, dtype=torch.bfloat16) * 0.05)(F, D)),
        }
    _B_in = _B_setup()

    return {
        "A_x": _A_in["x"],
        "A_wqkv": _A_in["wqkv"],
        "A_wo": _A_in["wo"],
        "B_x": _B_in["x"],
        "B_w_gate": _B_in["w_gate"],
        "B_w_up": _B_in["w_up"],
        "B_w_down": _B_in["w_down"],
    }

def reference(A_x, A_wqkv, A_wo, B_x, B_w_gate, B_w_up, B_w_down):
    def _A_ref(x, wqkv, wo):
        B, S, D = x.shape
        H = 32; Dh = D // H
        qkv = (lambda x, *d: x.permute(*d))((x @ wqkv).reshape(B, S, 3, H, Dh), 2, 0, 3, 1, 4)
        q, k, v = qkv[0], qkv[1], qkv[2]
        scale = Dh ** -0.5
        scores = torch.einsum("bhqd,bhkd->bhqk", q, k) * scale
        p = _softmax(scores, axis=-1)
        o = torch.einsum("bhqk,bhkd->bhqd", p, v)
        return (lambda x, *d: x.permute(*d))(o, 0, 2, 1, 3).reshape(B, S, D) @ wo

    def _B_ref(x, w_gate, w_up, w_down):
        g = _silu(x @ w_gate)
        u = x @ w_up
        return (g * u) @ w_down

    x = A_x
    h = x + _A_ref(_layernorm(x, axis=-1), A_wqkv, A_wo)
    h2 = h + _B_ref(_layernorm(h, axis=-1), B_w_gate, B_w_up, B_w_down)
    return h2
```

```asm
; @launch grid=(256,1,1) block=(512,1,1) lds=163840
.amdgcn_target "amdgcn-amd-amdhsa--gfx950"
.text
.globl sequential_preLN__softmax_full_mha__swiglu_ffn__prompt_kernel
.p2align 8
.type sequential_preLN__softmax_full_mha__swiglu_ffn__prompt_kernel,@function
sequential_preLN__softmax_full_mha__swiglu_ffn__prompt_kernel:
s_cmp_ge_u32 s2, 256
s_cbranch_scc1 L_end
s_load_dwordx16 s[40:55], s[0:1], 0
s_load_dwordx4 s[56:59], s[0:1], 64
v_lshrrev_b32 v1, 6, v0
v_and_b32 v0, 63, v0
v_readfirstlane_b32 s16, v1
v_lshlrev_b32 v6, 4, v0
v_lshrrev_b32 v7, 5, v0
v_and_b32 v8, 31, v0
s_and_b32 s18, s2, 7
s_lshr_b32 s19, s2, 3
s_mov_b32 s20, 0xffff0000
s_mov_b32 s22, 0
s_mov_b32 s23, -1
s_cmp_lg_u32 s16, 6
s_cbranch_scc1 L_noipf
s_cmp_ge_u32 s19, 2
s_cbranch_scc1 L_noipf
s_getpc_b64 s[24:25]
v_lshlrev_b32 v2, 7, v0
s_mul_i32 s26, s19, 24576
v_add_u32 v2, s26, v2
v_mov_b32 v191, s25
v_add_co_u32 v190, vcc, s24, v2
s_nop 1
v_addc_co_u32 v191, vcc, 0, v191, vcc
global_load_dword v192, v[190:191], off
v_add_co_u32 v190, vcc, 0x2000, v190
s_nop 1
v_addc_co_u32 v191, vcc, 0, v191, vcc
global_load_dword v192, v[190:191], off
v_add_co_u32 v190, vcc, 0x2000, v190
s_nop 1
v_addc_co_u32 v191, vcc, 0, v191, vcc
global_load_dword v192, v[190:191], off
L_noipf:
s_and_b32 s24, s2, 3
s_lshl_b32 s24, s24, 2
s_and_b32 s25, s19, 3
s_add_u32 s28, s24, s25
s_bfe_u32 s24, s2, 0x10002
s_lshl_b32 s24, s24, 3
s_lshr_b32 s25, s2, 5
s_add_u32 s29, s24, s25
s_and_b32 s30, s16, 3
s_lshr_b32 s31, s16, 2
s_xor_b32 s35, s30, s31
s_lshl_b32 s32, s16, 11
s_add_u32 s33, s32, 65536
s_and_b32 s27, s18, 3
s_mul_i32 s27, s27, 5
s_lshr_b32 s27, s27, 1
s_lshr_b32 s24, s18, 2
s_add_u32 s27, s27, s24
s_lshl_b32 s24, s28, 7
s_lshl_b32 s25, s16, 4
s_add_u32 s24, s24, s25
v_lshrrev_b32 v1, 3, v0
v_add_u32 v1, s24, v1
v_mul_u32_u24 v12, 1280, v1
v_lshrrev_b32 v2, 4, v0
v_and_b32 v3, 7, v0
v_xor_b32 v3, v3, v2
v_lshl_add_u32 v12, v3, 4, v12
v_xor_b32 v13, 64, v12
v_add_u32 v13, 9216, v13
s_lshl_b32 s24, s16, 3
v_add_u32 v1, s24, v2
v_mul_u32_u24 v14, 3840, v1
v_lshlrev_b32 v2, 2, v2
v_and_b32 v3, 15, v0
v_xor_b32 v3, v3, v2
v_lshl_add_u32 v14, v3, 4, v14
s_lshl_b32 s24, s29, 8
v_add_u32 v14, s24, v14
v_add_u32 v15, 14336, v14
s_waitcnt lgkmcnt(0)
s_lshl_b32 s0, s27, 7
s_mul_i32 s17, s27, 245760
s_mov_b32 s4, s58
s_mov_b32 s5, s59
s_mov_b32 s6, 0x1d00000
s_mov_b32 s7, 0x20000
s_mov_b32 s60, s56
s_mov_b32 s61, s57
s_mov_b32 s62, 0x100
s_mov_b32 s63, 0x20000
s_cmp_eq_u32 s29, 15
s_cbranch_scc1 L_p1_cs
s_mov_b32 s8, s40
s_mov_b32 s9, s41
s_mov_b32 s10, 0x280000
s_mov_b32 s11, 0x20000
s_mov_b32 s12, s42
s_mov_b32 s13, s43
s_mov_b32 s14, 0x258000
s_mov_b32 s15, 0x20000
s_add_u32 m0, s32, 0
s_nop 0
buffer_load_dwordx4 v12, s[8:11], s0 offen lds
buffer_load_dwordx4 v13, s[8:11], s0 offen offset:1024 lds
s_add_u32 s0, s0, 128
s_add_u32 m0, s33, 0
s_cmpk_eq_u32 s0, 1280
s_cselect_b32 s0, 0, s0
buffer_load_dwordx4 v14, s[12:15], s17 offen lds
buffer_load_dwordx4 v15, s[12:15], s17 offen offset:1024 lds
s_add_u32 s17, s17, 245760
s_cmp_eq_u32 s0, 0
s_cselect_b32 s17, 0, s17
s_barrier
s_add_u32 m0, s32, 16384
s_nop 0
buffer_load_dwordx4 v12, s[8:11], s0 offen lds
buffer_load_dwordx4 v13, s[8:11], s0 offen offset:1024 lds
s_add_u32 s0, s0, 128
s_add_u32 m0, s33, 16384
s_cmpk_eq_u32 s0, 1280
s_cselect_b32 s0, 0, s0
buffer_load_dwordx4 v14, s[12:15], s17 offen lds
buffer_load_dwordx4 v15, s[12:15], s17 offen offset:1024 lds
s_add_u32 s17, s17, 245760
s_cmp_eq_u32 s0, 0
s_cselect_b32 s17, 0, s17
s_cmp_lg_u32 s2, 0
s_cbranch_scc1 L_p1_notag
s_cmp_lg_u32 s16, 7
s_cbranch_scc1 L_p1_notag
s_memrealtime s[24:25]
s_waitcnt lgkmcnt(0)
s_or_b32 s24, s24, 1
s_lshl_b32 s25, s25, 28
s_xor_b32 s24, s24, s25
v_mov_b32 v1, s24
v_lshlrev_b32 v2, 2, v0
s_mov_b64 exec, 0xffff
buffer_store_dword v1, v2, s[60:63], 0 offen offset:128 sc1
s_mov_b64 exec, -1
L_p1_notag:
s_lshl_b32 s24, s35, 1
v_or_b32 v1, s24, v7
v_bfe_u32 v2, v0, 1, 3
v_xor_b32 v1, v1, v2
v_lshlrev_b32 v1, 4, v1
s_lshl_b32 s24, s30, 5
v_add_u32 v2, s24, v8
v_lshl_add_u32 v16, v2, 7, v1
v_xor_b32 v17, 32, v16
v_xor_b32 v18, 64, v16
v_xor_b32 v19, 0x60, v16
v_bfe_u32 v1, v0, 2, 2
s_lshl_b32 s24, s31, 1
v_xor_b32 v2, s24, v1
v_lshlrev_b32 v2, 6, v2
v_lshl_add_u32 v2, v1, 8, v2
v_lshl_add_u32 v2, v7, 11, v2
v_bfe_u32 v1, v0, 4, 1
v_lshl_add_u32 v2, v1, 5, v2
v_and_b32 v1, 3, v0
v_lshl_add_u32 v2, v1, 3, v2
s_lshl_b32 s24, s35, 12
s_add_u32 s24, s24, 65536
v_add_u32 v20, s24, v2
v_xor_b32 v21, 0x40, v20
v_xor_b32 v22, 0x1000, v20
v_xor_b32 v23, 0x1040, v20
v_xor_b32 v24, 0x2000, v20
v_xor_b32 v25, 0x2040, v20
v_xor_b32 v26, 0x3000, v20
v_xor_b32 v27, 0x3040, v20
v_bfe_u32 v1, v0, 4, 1
v_and_b32 v2, 15, v0
v_cmp_eq_u32 vcc, v1, v2
v_mov_b32 v3, 0x3f803f80
s_lshl_b32 s24, s28, 11
s_lshl_b32 s25, s30, 9
s_add_u32 s24, s24, s25
s_add_u32 s24, s24, 27820032
v_lshl_add_u32 v112, v8, 4, s24
v_cndmask_b32 v28, 0, v3, vcc
v_cndmask_b32 v29, 0, v3, vcc
v_cndmask_b32 v30, 0, v3, vcc
v_cndmask_b32 v31, 0, v3, vcc
s_cmp_ge_u32 s29, 10
s_cbranch_scc1 L_p1_v
s_waitcnt vmcnt(4)
s_barrier
ds_read_b128 v[72:75], v16 offset:0
ds_read_b64_tr_b16 v[84:85], v20 offset:0
ds_read_b64_tr_b16 v[86:87], v20 offset:1024
ds_read_b64_tr_b16 v[88:89], v21 offset:0
ds_read_b64_tr_b16 v[90:91], v21 offset:1024
ds_read_b128 v[76:79], v17 offset:0
ds_read_b64_tr_b16 v[92:93], v22 offset:0
ds_read_b64_tr_b16 v[94:95], v22 offset:1024
ds_read_b64_tr_b16 v[96:97], v23 offset:0
ds_read_b64_tr_b16 v[98:99], v23 offset:1024
s_waitcnt lgkmcnt(5)
v_mfma_f32_32x32x16_bf16 v[32:47], v[84:87], v[72:75], 0
ds_read_b128 v[80:83], v18 offset:0
ds_read_b64_tr_b16 v[100:101], v24 offset:0
ds_read_b64_tr_b16 v[102:103], v24 offset:1024
s_add_u32 m0, s32, 32768
s_nop 0
buffer_load_dwordx4 v12, s[8:11], s0 offen lds
s_lshl_b32 s24, s2, 10
s_add_u32 s24, s24, 27852800
buffer_load_dword v9, v6, s[4:7], s24 offen sc1
v_mfma_f32_32x32x16_bf16 v[48:63], v[88:91], v[72:75], 0
ds_read_b64_tr_b16 v[104:105], v25 offset:0
ds_read_b64_tr_b16 v[106:107], v25 offset:1024
buffer_load_dwordx4 v13, s[8:11], s0 offen offset:1024 lds
s_add_u32 s0, s0, 128
s_mul_i32 s24, s29, 52429
s_lshr_b32 s24, s24, 18
s_mul_i32 s25, s24, 5
v_mfma_f32_16x16x32_bf16 v[64:67], v[28:31], v[84:87], 0
v_mfma_f32_16x16x32_bf16 v[68:71], v[28:31], v[88:91], 0
s_waitcnt lgkmcnt(5)
v_mfma_f32_32x32x16_bf16 v[32:47], v[92:95], v[76:79], v[32:47]
ds_read_b128 v[72:75], v19 offset:0
ds_read_b64_tr_b16 v[84:85], v26 offset:0
ds_read_b64_tr_b16 v[86:87], v26 offset:1024
s_add_u32 m0, s33, 32768
s_cmpk_eq_u32 s0, 1280
s_cselect_b32 s0, 0, s0
buffer_load_dwordx4 v14, s[12:15], s17 offen lds
s_sub_u32 s25, s29, s25
s_mul_i32 s26, s25, 6
v_lshrrev_b32 v1, 3, v0
v_mfma_f32_32x32x16_bf16 v[48:63], v[96:99], v[76:79], v[48:63]
ds_read_b64_tr_b16 v[88:89], v27 offset:0
ds_read_b64_tr_b16 v[90:91], v27 offset:1024
buffer_load_dwordx4 v15, s[12:15], s17 offen offset:1024 lds
s_add_u32 s17, s17, 245760
s_cmp_eq_u32 s0, 0
s_cselect_b32 s17, 0, s17
v_cmp_le_u32 vcc, 6, v1
s_cmp_lt_u32 s25, 4
s_cselect_b64 s[64:65], vcc, 0
s_waitcnt lgkmcnt(5)
v_mfma_f32_32x32x16_bf16 v[32:47], v[100:103], v[80:83], v[32:47]
v_add_u32 v1, s26, v1
v_and_b32 v2, 7, v0
v_and_b32 v3, 3, v1
v_lshl_add_u32 v3, v2, 2, v3
s_waitcnt vmcnt(5) lgkmcnt(0)
s_barrier
v_mfma_f32_32x32x16_bf16 v[48:63], v[104:107], v[80:83], v[48:63]
ds_read_b128 v[76:79], v16 offset:16384
ds_read_b64_tr_b16 v[92:93], v20 offset:16384
ds_read_b64_tr_b16 v[94:95], v20 offset:17408
ds_read_b64_tr_b16 v[96:97], v21 offset:16384
ds_read_b64_tr_b16 v[98:99], v21 offset:17408
v_lshrrev_b32 v1, 2, v1
v_lshl_add_u32 v1, v3, 3, v1
s_lshr_b32 s26, s28, 1
v_cmp_eq_u32 vcc, s26, v2
s_add_u32 m0, s32, 49152
s_nop 0
buffer_load_dwordx4 v12, s[8:11], s0 offen lds
v_mfma_f32_32x32x16_bf16 v[32:47], v[84:87], v[72:75], v[32:47]
ds_read_b128 v[80:83], v17 offset:16384
ds_read_b64_tr_b16 v[100:101], v22 offset:16384
ds_read_b64_tr_b16 v[102:103], v22 offset:17408
buffer_load_dwordx4 v13, s[8:11], s0 offen offset:1024 lds
s_add_u32 s0, s0, 128
s_cmp_eq_u32 s24, 0
s_cselect_b64 s[66:67], vcc, -1
s_cselect_b32 s26, 8, 64
v_mfma_f32_32x32x16_bf16 v[48:63], v[88:91], v[72:75], v[48:63]
ds_read_b64_tr_b16 v[104:105], v23 offset:16384
ds_read_b64_tr_b16 v[106:107], v23 offset:17408
s_add_u32 m0, s33, 49152
s_cmpk_eq_u32 s0, 1280
s_cselect_b32 s0, 0, s0
buffer_load_dwordx4 v14, s[12:15], s17 offen lds
s_and_b32 s27, s28, 1
s_add_u32 s27, s27, 64
s_lshl_b32 s25, s24, 5
s_waitcnt lgkmcnt(5)
v_mfma_f32_32x32x16_bf16 v[32:47], v[92:95], v[76:79], v[32:47]
ds_read_b128 v[72:75], v18 offset:16384
ds_read_b64_tr_b16 v[84:85], v24 offset:16384
ds_read_b64_tr_b16 v[86:87], v24 offset:17408
buffer_load_dwordx4 v15, s[12:15], s17 offen offset:1024 lds
s_add_u32 s17, s17, 245760
s_cmp_eq_u32 s0, 0
s_cselect_b32 s17, 0, s17
s_sub_u32 s25, s25, 32
s_add_u32 s25, s25, s28
s_cmp_eq_u32 s24, 0
s_cselect_b32 s25, s27, s25
v_mfma_f32_32x32x16_bf16 v[48:63], v[96:99], v[76:79], v[48:63]
ds_read_b64_tr_b16 v[88:89], v25 offset:16384
ds_read_b64_tr_b16 v[90:91], v25 offset:17408
s_add_u32 m0, s32, 0
s_nop 0
buffer_load_dwordx4 v12, s[8:11], s0 offen lds
s_lshl_b32 s25, s25, 2
s_add_u32 s25, s25, 27852800
v_mov_b32 v2, s26
v_mfma_f32_16x16x32_bf16 v[64:67], v[28:31], v[92:95], v[64:67]
v_mfma_f32_16x16x32_bf16 v[68:71], v[28:31], v[96:99], v[68:71]
s_waitcnt lgkmcnt(5)
v_mfma_f32_32x32x16_bf16 v[32:47], v[100:103], v[80:83], v[32:47]
ds_read_b128 v[76:79], v19 offset:16384
ds_read_b64_tr_b16 v[92:93], v26 offset:16384
ds_read_b64_tr_b16 v[94:95], v26 offset:17408
buffer_load_dwordx4 v13, s[8:11], s0 offen offset:1024 lds
s_add_u32 s0, s0, 128
v_lshl_add_u32 v1, v1, 10, s25
v_cndmask_b32 v2, 0, v2, s[64:65]
v_add_u32 v10, v1, v2
v_mfma_f32_32x32x16_bf16 v[48:63], v[104:107], v[80:83], v[48:63]
ds_read_b64_tr_b16 v[96:97], v27 offset:16384
ds_read_b64_tr_b16 v[98:99], v27 offset:17408
s_add_u32 m0, s33, 0
s_cmpk_eq_u32 s0, 1280
s_cselect_b32 s0, 0, s0
buffer_load_dwordx4 v14, s[12:15], s17 offen lds
s_lshl_b32 s36, s28, 2
s_add_u32 s36, s36, s30
s_cmp_lt_u32 s29, 5
s_cselect_b32 s34, 0x3ea52b5c, 1.0
s_cselect_b32 s24, 0, 80
s_mov_b32 s37, 3072
s_cmov_b32 s37, 1536
s_mov_b32 s38, 2560
s_cmov_b32 s38, 1024
s_cselect_b32 s39, 6291456, 0
s_cselect_b32 s26, 0, 63
s_waitcnt lgkmcnt(5)
v_mfma_f32_32x32x16_bf16 v[32:47], v[84:87], v[72:75], v[32:47]
s_add_u32 s26, s26, s36
s_and_b32 s26, s26, 63
s_mul_i32 s26, s26, s37
s_add_u32 s39, s39, s26
s_waitcnt vmcnt(7) lgkmcnt(0)
s_barrier
v_mfma_f32_32x32x16_bf16 v[48:63], v[88:91], v[72:75], v[48:63]
ds_read_b128 v[80:83], v16 offset:32768
ds_read_b64_tr_b16 v[100:101], v20 offset:32768
ds_read_b64_tr_b16 v[102:103], v20 offset:33792
ds_read_b64_tr_b16 v[104:105], v21 offset:32768
ds_read_b64_tr_b16 v[106:107], v21 offset:33792
s_lshl_b32 s37, s37, 6
s_lshl_b32 s25, s29, 4
s_sub_u32 s24, s25, s24
s_lshl_b32 s25, s31, 3
buffer_load_dwordx4 v15, s[12:15], s17 offen offset:1024 lds
s_add_u32 s17, s17, 245760
s_cmp_eq_u32 s0, 0
s_cselect_b32 s17, 0, s17
v_mfma_f32_32x32x16_bf16 v[32:47], v[92:95], v[76:79], v[32:47]
ds_read_b128 v[72:75], v17 offset:32768
ds_read_b64_tr_b16 v[84:85], v22 offset:32768
ds_read_b64_tr_b16 v[86:87], v22 offset:33792
s_add_u32 s24, s24, s25
v_add_u32 v4, s24, v7
v_lshl_add_u32 v5, v8, 4, s39
v_mfma_f32_32x32x16_bf16 v[48:63], v[96:99], v[76:79], v[48:63]
ds_read_b64_tr_b16 v[88:89], v23 offset:32768
ds_read_b64_tr_b16 v[90:91], v23 offset:33792
s_add_u32 m0, s32, 16384
s_nop 0
buffer_load_dwordx4 v12, s[8:11], s0 offen lds
v_mov_b32 v114, s38
v_add_u32 v1, 0, v4
v_mul_u32_u24 v2, 52429, v1
s_waitcnt lgkmcnt(5)
v_mfma_f32_32x32x16_bf16 v[32:47], v[100:103], v[80:83], v[32:47]
ds_read_b128 v[76:79], v18 offset:32768
ds_read_b64_tr_b16 v[92:93], v24 offset:32768
ds_read_b64_tr_b16 v[94:95], v24 offset:33792
v_lshrrev_b32 v2, 18, v2
v_mul_u32_u24 v3, 5, v2
v_sub_u32 v1, v1, v3
v_mfma_f32_32x32x16_bf16 v[48:63], v[104:107], v[80:83], v[48:63]
ds_read_b64_tr_b16 v[96:97], v25 offset:32768
ds_read_b64_tr_b16 v[98:99], v25 offset:33792
buffer_load_dwordx4 v13, s[8:11], s0 offen offset:1024 lds
s_add_u32 s0, s0, 128
v_cmp_le_u32 vcc, 3, v1
v_lshlrev_b32 v2, 1, v2
v_subrev_u32 v3, 3, v1
v_mfma_f32_16x16x32_bf16 v[64:67], v[28:31], v[100:103], v[64:67]
v_mfma_f32_16x16x32_bf16 v[68:71], v[28:31], v[104:107], v[68:71]
s_waitcnt lgkmcnt(5)
v_mfma_f32_32x32x16_bf16 v[32:47], v[84:87], v[72:75], v[32:47]
ds_read_b128 v[80:83], v19 offset:32768
ds_read_b64_tr_b16 v[100:101], v26 offset:32768
ds_read_b64_tr_b16 v[102:103], v26 offset:33792
v_addc_co_u32 v2, s[64:65], 0, v2, vcc
v_cndmask_b32 v3, v1, v3, vcc
v_cmp_eq_u32 vcc, 2, v1
v_mfma_f32_32x32x16_bf16 v[48:63], v[88:91], v[72:75], v[48:63]
ds_read_b64_tr_b16 v[104:105], v27 offset:32768
ds_read_b64_tr_b16 v[106:107], v27 offset:33792
s_add_u32 m0, s33, 16384
s_cmpk_eq_u32 s0, 1280
s_cselect_b32 s0, 0, s0
buffer_load_dwordx4 v14, s[12:15], s17 offen lds
v_lshlrev_b32 v3, 9, v3
v_mul_lo_u32 v2, v2, s37
v_cndmask_b32 v3, v3, v114, vcc
s_waitcnt lgkmcnt(5)
v_mfma_f32_32x32x16_bf16 v[32:47], v[92:95], v[76:79], v[32:47]
v_add3_u32 v118, v2, v3, v5
v_add_u32 v1, 2, v4
v_mul_u32_u24 v2, 52429, v1
v_lshrrev_b32 v2, 18, v2
s_waitcnt vmcnt(7) lgkmcnt(0)
s_barrier
v_mfma_f32_32x32x16_bf16 v[48:63], v[96:99], v[76:79], v[48:63]
ds_read_b128 v[72:75], v16 offset:49152
ds_read_b64_tr_b16 v[84:85], v20 offset:49152
ds_read_b64_tr_b16 v[86:87], v20 offset:50176
ds_read_b64_tr_b16 v[88:89], v21 offset:49152
ds_read_b64_tr_b16 v[90:91], v21 offset:50176
v_mul_u32_u24 v3, 5, v2
v_sub_u32 v1, v1, v3
v_cmp_le_u32 vcc, 3, v1
v_lshlrev_b32 v2, 1, v2
buffer_load_dwordx4 v15, s[12:15], s17 offen offset:1024 lds
s_add_u32 s17, s17, 245760
s_cmp_eq_u32 s0, 0
s_cselect_b32 s17, 0, s17
v_mfma_f32_32x32x16_bf16 v[32:47], v[100:103], v[80:83], v[32:47]
ds_read_b128 v[76:79], v17 offset:49152
ds_read_b64_tr_b16 v[92:93], v22 offset:49152
ds_read_b64_tr_b16 v[94:95], v22 offset:50176
v_subrev_u32 v3, 3, v1
v_addc_co_u32 v2, s[64:65], 0, v2, vcc
v_cndmask_b32 v3, v1, v3, vcc
v_mfma_f32_32x32x16_bf16 v[48:63], v[104:107], v[80:83], v[48:63]
ds_read_b64_tr_b16 v[96:97], v23 offset:49152
ds_read_b64_tr_b16 v[98:99], v23 offset:50176
s_add_u32 m0, s32, 32768
s_nop 0
buffer_load_dwordx4 v12, s[8:11], s0 offen lds
v_cmp_eq_u32 vcc, 2, v1
v_lshlrev_b32 v3, 9, v3
v_mul_lo_u32 v2, v2, s37
s_waitcnt lgkmcnt(5)
v_mfma_f32_32x32x16_bf16 v[32:47], v[84:87], v[72:75], v[32:47]
ds_read_b128 v[80:83], v18 offset:49152
ds_read_b64_tr_b16 v[100:101], v24 offset:49152
ds_read_b64_tr_b16 v[102:103], v24 offset:50176
v_cndmask_b32 v3, v3, v114, vcc
v_add3_u32 v119, v2, v3, v5
v_add_u32 v1, 4, v4
v_mfma_f32_32x32x16_bf16 v[48:63], v[88:91], v[72:75], v[48:63]
ds_read_b64_tr_b16 v[104:105], v25 offset:49152
ds_read_b64_tr_b16 v[106:107], v25 offset:50176
buffer_load_dwordx4 v13, s[8:11], s0 offen offset:1024 lds
s_add_u32 s0, s0, 128
v_mul_u32_u24 v2, 52429, v1
v_lshrrev_b32 v2, 18, v2
v_mul_u32_u24 v3, 5, v2
v_mfma_f32_16x16x32_bf16 v[64:67], v[28:31], v[84:87], v[64:67]
v_mfma_f32_16x16x32_bf16 v[68:71], v[28:31], v[88:91], v[68:71]
s_waitcnt lgkmcnt(5)
v_mfma_f32_32x32x16_bf16 v[32:47], v[92:95], v[76:79], v[32:47]
ds_read_b128 v[72:75], v19 offset:49152
ds_read_b64_tr_b16 v[84:85], v26 offset:49152
ds_read_b64_tr_b16 v[86:87], v26 offset:50176
v_sub_u32 v1, v1, v3
v_cmp_le_u32 vcc, 3, v1
v_lshlrev_b32 v2, 1, v2
v_mfma_f32_32x32x16_bf16 v[48:63], v[96:99], v[76:79], v[48:63]
ds_read_b64_tr_b16 v[88:89], v27 offset:49152
ds_read_b64_tr_b16 v[90:91], v27 offset:50176
s_add_u32 m0, s33, 32768
s_cmpk_eq_u32 s0, 1280
s_cselect_b32 s0, 0, s0
buffer_load_dwordx4 v14, s[12:15], s17 offen lds
v_subrev_u32 v3, 3, v1
v_addc_co_u32 v2, s[64:65], 0, v2, vcc
v_cndmask_b32 v3, v1, v3, vcc
s_waitcnt lgkmcnt(5)
v_mfma_f32_32x32x16_bf16 v[32:47], v[100:103], v[80:83], v[32:47]
v_cmp_eq_u32 vcc, 2, v1
v_lshlrev_b32 v3, 9, v3
v_mul_lo_u32 v2, v2, s37
v_cndmask_b32 v3, v3, v114, vcc
s_waitcnt vmcnt(7) lgkmcnt(0)
s_barrier
v_mfma_f32_32x32x16_bf16 v[48:63], v[104:107], v[80:83], v[48:63]
ds_read_b128 v[76:79], v16 offset:0
ds_read_b64_tr_b16 v[92:93], v20 offset:0
ds_read_b64_tr_b16 v[94:95], v20 offset:1024
ds_read_b64_tr_b16 v[96:97], v21 offset:0
ds_read_b64_tr_b16 v[98:99], v21 offset:1024
v_add3_u32 v120, v2, v3, v5
v_add_u32 v1, 6, v4
v_mul_u32_u24 v2, 52429, v1
v_lshrrev_b32 v2, 18, v2
buffer_load_dwordx4 v15, s[12:15], s17 offen offset:1024 lds
s_add_u32 s17, s17, 245760
s_cmp_eq_u32 s0, 0
s_cselect_b32 s17, 0, s17
v_mfma_f32_32x32x16_bf16 v[32:47], v[84:87], v[72:75], v[32:47]
ds_read_b128 v[80:83], v17 offset:0
ds_read_b64_tr_b16 v[100:101], v22 offset:0
ds_read_b64_tr_b16 v[102:103], v22 offset:1024
v_mul_u32_u24 v3, 5, v2
v_sub_u32 v1, v1, v3
v_cmp_le_u32 vcc, 3, v1
v_mfma_f32_32x32x16_bf16 v[48:63], v[88:91], v[72:75], v[48:63]
ds_read_b64_tr_b16 v[104:105], v23 offset:0
ds_read_b64_tr_b16 v[106:107], v23 offset:1024
s_add_u32 m0, s32, 49152
s_nop 0
buffer_load_dwordx4 v12, s[8:11], s0 offen lds
v_lshlrev_b32 v2, 1, v2
v_subrev_u32 v3, 3, v1
v_addc_co_u32 v2, s[64:65], 0, v2, vcc
s_waitcnt lgkmcnt(5)
v_mfma_f32_32x32x16_bf16 v[32:47], v[92:95], v[76:79], v[32:47]
ds_read_b128 v[72:75], v18 offset:0
ds_read_b64_tr_b16 v[84:85], v24 offset:0
ds_read_b64_tr_b16 v[86:87], v24 offset:1024
v_cndmask_b32 v3, v1, v3, vcc
v_cmp_eq_u32 vcc, 2, v1
v_lshlrev_b32 v3, 9, v3
v_mfma_f32_32x32x16_bf16 v[48:63], v[96:99], v[76:79], v[48:63]
ds_read_b64_tr_b16 v[88:89], v25 offset:0
ds_read_b64_tr_b16 v[90:91], v25 offset:1024
buffer_load_dwordx4 v13, s[8:11], s0 offen offset:1024 lds
s_add_u32 s0, s0, 128
v_mul_lo_u32 v2, v2, s37
v_cndmask_b32 v3, v3, v114, vcc
v_add3_u32 v121, v2, v3, v5
v_mfma_f32_16x16x32_bf16 v[64:67], v[28:31], v[92:95], v[64:67]
v_mfma_f32_16x16x32_bf16 v[68:71], v[28:31], v[96:99], v[68:71]
s_waitcnt lgkmcnt(5)
v_mfma_f32_32x32x16_bf16 v[32:47], v[100:103], v[80:83], v[32:47]
ds_read_b128 v[76:79], v19 offset:0
ds_read_b64_tr_b16 v[92:93], v26 offset:0
ds_read_b64_tr_b16 v[94:95], v26 offset:1024
v_mfma_f32_32x32x16_bf16 v[48:63], v[104:107], v[80:83], v[48:63]
ds_read_b64_tr_b16 v[96:97], v27 offset:0
ds_read_b64_tr_b16 v[98:99], v27 offset:1024
s_add_u32 m0, s33, 49152
s_cmpk_eq_u32 s0, 1280
s_cselect_b32 s0, 0, s0
buffer_load_dwordx4 v14, s[12:15], s17 offen lds
s_waitcnt lgkmcnt(5)
v_mfma_f32_32x32x16_bf16 v[32:47], v[84:87], v[72:75], v[32:47]
s_waitcnt vmcnt(7) lgkmcnt(0)
s_barrier
v_mfma_f32_32x32x16_bf16 v[48:63], v[88:91], v[72:75], v[48:63]
ds_read_b128 v[80:83], v16 offset:16384
ds_read_b64_tr_b16 v[100:101], v20 offset:16384
ds_read_b64_tr_b16 v[102:103], v20 offset:17408
ds_read_b64_tr_b16 v[104:105], v21 offset:16384
ds_read_b64_tr_b16 v[106:107], v21 offset:17408
buffer_load_dwordx4 v15, s[12:15], s17 offen offset:1024 lds
s_add_u32 s17, s17, 245760
s_cmp_eq_u32 s0, 0
s_cselect_b32 s17, 0, s17
v_mfma_f32_32x32x16_bf16 v[32:47], v[92:95], v[76:79], v[32:47]
ds_read_b128 v[72:75], v17 offset:16384
ds_read_b64_tr_b16 v[84:85], v22 offset:16384
ds_read_b64_tr_b16 v[86:87], v22 offset:17408
v_mfma_f32_32x32x16_bf16 v[48:63], v[96:99], v[76:79], v[48:63]
ds_read_b64_tr_b16 v[88:89], v23 offset:16384
ds_read_b64_tr_b16 v[90:91], v23 offset:17408
s_add_u32 m0, s32, 0
s_nop 0
buffer_load_dwordx4 v12, s[8:11], s0 offen lds
s_waitcnt lgkmcnt(5)
v_mfma_f32_32x32x16_bf16 v[32:47], v[100:103], v[80:83], v[32:47]
ds_read_b128 v[76:79], v18 offset:16384
ds_read_b64_tr_b16 v[92:93], v24 offset:16384
ds_read_b64_tr_b16 v[94:95], v24 offset:17408
v_mfma_f32_32x32x16_bf16 v[48:63], v[104:107], v[80:83], v[48:63]
ds_read_b64_tr_b16 v[96:97], v25 offset:16384
ds_read_b64_tr_b16 v[98:99], v25 offset:17408
buffer_load_dwordx4 v13, s[8:11], s0 offen offset:1024 lds
s_add_u32 s0, s0, 128
v_mfma_f32_16x16x32_bf16 v[64:67], v[28:31], v[100:103], v[64:67]
v_mfma_f32_16x16x32_bf16 v[68:71], v[28:31], v[104:107], v[68:71]
s_waitcnt lgkmcnt(5)
v_mfma_f32_32x32x16_bf16 v[32:47], v[84:87], v[72:75], v[32:47]
ds_read_b128 v[80:83], v19 offset:16384
ds_read_b64_tr_b16 v[100:101], v26 offset:16384
ds_read_b64_tr_b16 v[102:103], v26 offset:17408
v_mfma_f32_32x32x16_bf16 v[48:63], v[88:91], v[72:75], v[48:63]
ds_read_b64_tr_b16 v[104:105], v27 offset:16384
ds_read_b64_tr_b16 v[106:107], v27 offset:17408
s_add_u32 m0, s33, 0
s_cmpk_eq_u32 s0, 1280
s_cselect_b32 s0, 0, s0
buffer_load_dwordx4 v14, s[12:15], s17 offen lds
s_waitcnt lgkmcnt(5)
v_mfma_f32_32x32x16_bf16 v[32:47], v[92:95], v[76:79], v[32:47]
s_waitcnt vmcnt(7) lgkmcnt(0)
s_barrier
v_mfma_f32_32x32x16_bf16 v[48:63], v[96:99], v[76:79], v[48:63]
ds_read_b128 v[72:75], v16 offset:32768
ds_read_b64_tr_b16 v[84:85], v20 offset:32768
ds_read_b64_tr_b16 v[86:87], v20 offset:33792
ds_read_b64_tr_b16 v[88:89], v21 offset:32768
ds_read_b64_tr_b16 v[90:91], v21 offset:33792
buffer_load_dwordx4 v15, s[12:15], s17 offen offset:1024 lds
s_add_u32 s17, s17, 245760
s_cmp_eq_u32 s0, 0
s_cselect_b32 s17, 0, s17
v_mfma_f32_32x32x16_bf16 v[32:47], v[100:103], v[80:83], v[32:47]
ds_read_b128 v[76:79], v17 offset:32768
ds_read_b64_tr_b16 v[92:93], v22 offset:32768
ds_read_b64_tr_b16 v[94:95], v22 offset:33792
v_mfma_f32_32x32x16_bf16 v[48:63], v[104:107], v[80:83], v[48:63]
ds_read_b64_tr_b16 v[96:97], v23 offset:32768
ds_read_b64_tr_b16 v[98:99], v23 offset:33792
s_add_u32 m0, s32, 16384
s_nop 0
buffer_load_dwordx4 v12, s[8:11], s0 offen lds
s_waitcnt lgkmcnt(5)
v_mfma_f32_32x32x16_bf16 v[32:47], v[84:87], v[72:75], v[32:47]
ds_read_b128 v[80:83], v18 offset:32768
ds_read_b64_tr_b16 v[100:101], v24 offset:32768
ds_read_b64_tr_b16 v[102:103], v24 offset:33792
v_mfma_f32_32x32x16_bf16 v[48:63], v[88:91], v[72:75], v[48:63]
ds_read_b64_tr_b16 v[104:105], v25 offset:32768
ds_read_b64_tr_b16 v[106:107], v25 offset:33792
buffer_load_dwordx4 v13, s[8:11], s0 offen offset:1024 lds
s_add_u32 s0, s0, 128
v_mfma_f32_16x16x32_bf16 v[64:67], v[28:31], v[84:87], v[64:67]
v_mfma_f32_16x16x32_bf16 v[68:71], v[28:31], v[88:91], v[68:71]
s_waitcnt lgkmcnt(5)
v_mfma_f32_32x32x16_bf16 v[32:47], v[92:95], v[76:79], v[32:47]
ds_read_b128 v[72:75], v19 offset:32768
ds_read_b64_tr_b16 v[84:85], v26 offset:32768
ds_read_b64_tr_b16 v[86:87], v26 offset:33792
v_mfma_f32_32x32x16_bf16 v[48:63], v[96:99], v[76:79], v[48:63]
ds_read_b64_tr_b16 v[88:89], v27 offset:32768
ds_read_b64_tr_b16 v[90:91], v27 offset:33792
s_add_u32 m0, s33, 16384
s_cmpk_eq_u32 s0, 1280
s_cselect_b32 s0, 0, s0
buffer_load_dwordx4 v14, s[12:15], s17 offen lds
s_waitcnt lgkmcnt(5)
v_mfma_f32_32x32x16_bf16 v[32:47], v[100:103], v[80:83], v[32:47]
s_waitcnt vmcnt(7) lgkmcnt(0)
s_barrier
v_mfma_f32_32x32x16_bf16 v[48:63], v[104:107], v[80:83], v[48:63]
ds_read_b128 v[76:79], v16 offset:49152
ds_read_b64_tr_b16 v[92:93], v20 offset:49152
ds_read_b64_tr_b16 v[94:95], v20 offset:50176
ds_read_b64_tr_b16 v[96:97], v21 offset:49152
ds_read_b64_tr_b16 v[98:99], v21 offset:50176
buffer_load_dwordx4 v15, s[12:15], s17 offen offset:1024 lds
s_add_u32 s17, s17, 245760
s_cmp_eq_u32 s0, 0
s_cselect_b32 s17, 0, s17
buffer_load_dword v9, off, s[60:63], 0 offset:128 sc1
v_mfma_f32_32x32x16_bf16 v[32:47], v[84:87], v[72:75], v[32:47]
ds_read_b128 v[80:83], v17 offset:49152
ds_read_b64_tr_b16 v[100:101], v22 offset:49152
ds_read_b64_tr_b16 v[102:103], v22 offset:50176
v_mfma_f32_32x32x16_bf16 v[48:63], v[88:91], v[72:75], v[48:63]
ds_read_b64_tr_b16 v[104:105], v23 offset:49152
ds_read_b64_tr_b16 v[106:107], v23 offset:50176
s_waitcnt lgkmcnt(5)
v_mfma_f32_32x32x16_bf16 v[32:47], v[92:95], v[76:79], v[32:47]
ds_read_b128 v[72:75], v18 offset:49152
ds_read_b64_tr_b16 v[84:85], v24 offset:49152
ds_read_b64_tr_b16 v[86:87], v24 offset:50176
v_mfma_f32_32x32x16_bf16 v[48:63], v[96:99], v[76:79], v[48:63]
ds_read_b64_tr_b16 v[88:89], v25 offset:49152
ds_read_b64_tr_b16 v[90:91], v25 offset:50176
v_mfma_f32_16x16x32_bf16 v[64:67], v[28:31], v[92:95], v[64:67]
v_mfma_f32_16x16x32_bf16 v[68:71], v[28:31], v[96:99], v[68:71]
s_waitcnt lgkmcnt(5)
v_mfma_f32_32x32x16_bf16 v[32:47], v[100:103], v[80:83], v[32:47]
ds_read_b128 v[76:79], v19 offset:49152
ds_read_b64_tr_b16 v[92:93], v26 offset:49152
ds_read_b64_tr_b16 v[94:95], v26 offset:50176
v_mfma_f32_32x32x16_bf16 v[48:63], v[104:107], v[80:83], v[48:63]
ds_read_b64_tr_b16 v[96:97], v27 offset:49152
ds_read_b64_tr_b16 v[98:99], v27 offset:50176
s_waitcnt lgkmcnt(5)
v_mfma_f32_32x32x16_bf16 v[32:47], v[84:87], v[72:75], v[32:47]
s_waitcnt vmcnt(5) lgkmcnt(0)
s_barrier
v_mfma_f32_32x32x16_bf16 v[48:63], v[88:91], v[72:75], v[48:63]
ds_read_b128 v[80:83], v16 offset:0
ds_read_b64_tr_b16 v[100:101], v20 offset:0
ds_read_b64_tr_b16 v[102:103], v20 offset:1024
ds_read_b64_tr_b16 v[104:105], v21 offset:0
ds_read_b64_tr_b16 v[106:107], v21 offset:1024
v_mfma_f32_32x32x16_bf16 v[32:47], v[92:95], v[76:79], v[32:47]
ds_read_b128 v[72:75], v17 offset:0
ds_read_b64_tr_b16 v[84:85], v22 offset:0
ds_read_b64_tr_b16 v[86:87], v22 offset:1024
v_mfma_f32_32x32x16_bf16 v[48:63], v[96:99], v[76:79], v[48:63]
ds_read_b64_tr_b16 v[88:89], v23 offset:0
ds_read_b64_tr_b16 v[90:91], v23 offset:1024
s_waitcnt lgkmcnt(5)
v_mfma_f32_32x32x16_bf16 v[32:47], v[100:103], v[80:83], v[32:47]
ds_read_b128 v[76:79], v18 offset:0
ds_read_b64_tr_b16 v[92:93], v24 offset:0
ds_read_b64_tr_b16 v[94:95], v24 offset:1024
v_mfma_f32_32x32x16_bf16 v[48:63], v[104:107], v[80:83], v[48:63]
ds_read_b64_tr_b16 v[96:97], v25 offset:0
ds_read_b64_tr_b16 v[98:99], v25 offset:1024
v_mfma_f32_16x16x32_bf16 v[64:67], v[28:31], v[100:103], v[64:67]
v_mfma_f32_16x16x32_bf16 v[68:71], v[28:31], v[104:107], v[68:71]
s_waitcnt lgkmcnt(5)
v_mfma_f32_32x32x16_bf16 v[32:47], v[84:87], v[72:75], v[32:47]
ds_read_b128 v[80:83], v19 offset:0
ds_read_b64_tr_b16 v[100:101], v26 offset:0
ds_read_b64_tr_b16 v[102:103], v26 offset:1024
v_mfma_f32_32x32x16_bf16 v[48:63], v[88:91], v[72:75], v[48:63]
ds_read_b64_tr_b16 v[104:105], v27 offset:0
ds_read_b64_tr_b16 v[106:107], v27 offset:1024
s_waitcnt lgkmcnt(5)
v_mfma_f32_32x32x16_bf16 v[32:47], v[92:95], v[76:79], v[32:47]
s_waitcnt vmcnt(1) lgkmcnt(0)
s_barrier
v_mfma_f32_32x32x16_bf16 v[48:63], v[96:99], v[76:79], v[48:63]
ds_read_b128 v[72:75], v16 offset:16384
ds_read_b64_tr_b16 v[84:85], v20 offset:16384
ds_read_b64_tr_b16 v[86:87], v20 offset:17408
ds_read_b64_tr_b16 v[88:89], v21 offset:16384
ds_read_b64_tr_b16 v[90:91], v21 offset:17408
buffer_load_dwordx4 v[108:111], v112, s[4:7], 0 offen sc1
v_mfma_f32_32x32x16_bf16 v[32:47], v[100:103], v[80:83], v[32:47]
ds_read_b128 v[76:79], v17 offset:16384
ds_read_b64_tr_b16 v[92:93], v22 offset:16384
ds_read_b64_tr_b16 v[94:95], v22 offset:17408
v_mfma_f32_32x32x16_bf16 v[48:63], v[104:107], v[80:83], v[48:63]
ds_read_b64_tr_b16 v[96:97], v23 offset:16384
ds_read_b64_tr_b16 v[98:99], v23 offset:17408
s_waitcnt lgkmcnt(5)
v_mfma_f32_32x32x16_bf16 v[32:47], v[84:87], v[72:75], v[32:47]
ds_read_b128 v[80:83], v18 offset:16384
ds_read_b64_tr_b16 v[100:101], v24 offset:16384
ds_read_b64_tr_b16 v[102:103], v24 offset:17408
v_mfma_f32_32x32x16_bf16 v[48:63], v[88:91], v[72:75], v[48:63]
ds_read_b64_tr_b16 v[104:105], v25 offset:16384
ds_read_b64_tr_b16 v[106:107], v25 offset:17408
v_mfma_f32_16x16x32_bf16 v[64:67], v[28:31], v[84:87], v[64:67]
v_mfma_f32_16x16x32_bf16 v[68:71], v[28:31], v[88:91], v[68:71]
s_waitcnt lgkmcnt(5)
v_mfma_f32_32x32x16_bf16 v[32:47], v[92:95], v[76:79], v[32:47]
ds_read_b128 v[72:75], v19 offset:16384
ds_read_b64_tr_b16 v[84:85], v26 offset:16384
ds_read_b64_tr_b16 v[86:87], v26 offset:17408
v_mfma_f32_32x32x16_bf16 v[48:63], v[96:99], v[76:79], v[48:63]
ds_read_b64_tr_b16 v[88:89], v27 offset:16384
ds_read_b64_tr_b16 v[90:91], v27 offset:17408
s_waitcnt lgkmcnt(5)
v_mfma_f32_32x32x16_bf16 v[32:47], v[100:103], v[80:83], v[32:47]
v_mfma_f32_32x32x16_bf16 v[48:63], v[104:107], v[80:83], v[48:63]
s_waitcnt lgkmcnt(0)
v_mfma_f32_32x32x16_bf16 v[32:47], v[84:87], v[72:75], v[32:47]
v_mfma_f32_32x32x16_bf16 v[48:63], v[88:91], v[72:75], v[48:63]
s_lshl_b32 s25, s31, 8
s_add_u32 s25, s25, 131072
v_lshl_add_u32 v2, v0, 2, s25
s_lshl_b32 s25, s30, 9
v_add_u32 v3, s25, v2
s_mov_b64 exec, 0xffff
ds_write_b32 v3, v64 offset:0
ds_write_b32 v3, v65 offset:64
ds_write_b32 v3, v68 offset:128
ds_write_b32 v3, v69 offset:192
s_mov_b64 exec, -1
s_waitcnt vmcnt(0)
s_movk_i32 s24, 20000
L_rs_1:
v_cmp_ne_u32 s[64:65], v110, v9
v_cmp_eq_u32 vcc, 0, v9
s_nop 0
s_or_b64 vcc, vcc, s[64:65]
s_cbranch_scc0 L_rsok_2
s_sub_u32 s24, s24, 1
s_cbranch_scc1 L_rsok_2
buffer_load_dword v9, off, s[60:63], 0 offset:128 sc1
buffer_load_dwordx4 v[108:111], v112, s[4:7], 0 offen sc1
s_waitcnt vmcnt(0)
s_branch L_rs_1
L_rsok_2:
s_lshl_b32 s25, s16, 8
s_add_u32 s25, s25, 135168
v_lshl_add_u32 v1, v0, 2, s25
v_lshl_add_u32 v4, v7, 4, s25
s_waitcnt lgkmcnt(0)
s_barrier
ds_read2st64_b32 v[64:65], v2 offset0:0 offset1:2
ds_read2st64_b32 v[66:67], v2 offset0:4 offset1:6
s_waitcnt lgkmcnt(0)
v_pk_add_f32 v[64:65], v[64:65], v[66:67]
v_add_f32 v64, v64, v65
ds_write_b32 v1, v64
s_waitcnt lgkmcnt(0)
ds_read_b128 v[128:131], v4 offset:0
ds_read_b128 v[132:135], v4 offset:32
ds_read_b128 v[136:139], v4 offset:64
ds_read_b128 v[140:143], v4 offset:96
ds_read_b128 v[144:147], v4 offset:128
ds_read_b128 v[148:151], v4 offset:160
ds_read_b128 v[152:155], v4 offset:192
ds_read_b128 v[156:159], v4 offset:224
v_mul_f32 v114, s34, v108
v_mul_f32 v115, s34, v109
s_waitcnt lgkmcnt(6)
v_pk_mul_f32 v[128:129], v[128:129], v[114:115] op_sel:[0,1] op_sel_hi:[1,1]
v_pk_mul_f32 v[130:131], v[130:131], v[114:115] op_sel:[0,1] op_sel_hi:[1,1]
v_pk_mul_f32 v[132:133], v[132:133], v[114:115] op_sel:[0,1] op_sel_hi:[1,1]
v_pk_mul_f32 v[134:135], v[134:135], v[114:115] op_sel:[0,1] op_sel_hi:[1,1]
v_pk_fma_f32 v[128:129], v[32:33], v[114:115], v[128:129] op_sel_hi:[1,0,1]
v_pk_fma_f32 v[130:131], v[34:35], v[114:115], v[130:131] op_sel_hi:[1,0,1]
v_pk_fma_f32 v[132:133], v[36:37], v[114:115], v[132:133] op_sel_hi:[1,0,1]
v_pk_fma_f32 v[134:135], v[38:39], v[114:115], v[134:135] op_sel_hi:[1,0,1]
v_cvt_pk_bf16_f32 v128, v128, v129
v_cvt_pk_bf16_f32 v129, v130, v131
v_cvt_pk_bf16_f32 v130, v132, v133
v_cvt_pk_bf16_f32 v131, v134, v135
s_waitcnt lgkmcnt(4)
v_pk_mul_f32 v[136:137], v[136:137], v[114:115] op_sel:[0,1] op_sel_hi:[1,1]
v_pk_mul_f32 v[138:139], v[138:139], v[114:115] op_sel:[0,1] op_sel_hi:[1,1]
v_pk_mul_f32 v[140:141], v[140:141], v[114:115] op_sel:[0,1] op_sel_hi:[1,1]
v_pk_mul_f32 v[142:143], v[142:143], v[114:115] op_sel:[0,1] op_sel_hi:[1,1]
v_pk_fma_f32 v[136:137], v[40:41], v[114:115], v[136:137] op_sel_hi:[1,0,1]
v_pk_fma_f32 v[138:139], v[42:43], v[114:115], v[138:139] op_sel_hi:[1,0,1]
v_pk_fma_f32 v[140:141], v[44:45], v[114:115], v[140:141] op_sel_hi:[1,0,1]
v_pk_fma_f32 v[142:143], v[46:47], v[114:115], v[142:143] op_sel_hi:[1,0,1]
v_cvt_pk_bf16_f32 v136, v136, v137
v_cvt_pk_bf16_f32 v137, v138, v139
v_cvt_pk_bf16_f32 v138, v140, v141
v_cvt_pk_bf16_f32 v139, v142, v143
v_permlane32_swap_b32 v128, v130
v_permlane32_swap_b32 v129, v131
buffer_store_dwordx4 v[128:131], v118, s[4:7], 0 offen sc1
s_waitcnt lgkmcnt(2)
v_pk_mul_f32 v[144:145], v[144:145], v[114:115] op_sel:[0,1] op_sel_hi:[1,1]
v_pk_mul_f32 v[146:147], v[146:147], v[114:115] op_sel:[0,1] op_sel_hi:[1,1]
v_pk_mul_f32 v[148:149], v[148:149], v[114:115] op_sel:[0,1] op_sel_hi:[1,1]
v_pk_mul_f32 v[150:151], v[150:151], v[114:115] op_sel:[0,1] op_sel_hi:[1,1]
v_pk_fma_f32 v[144:145], v[48:49], v[114:115], v[144:145] op_sel_hi:[1,0,1]
v_pk_fma_f32 v[146:147], v[50:51], v[114:115], v[146:147] op_sel_hi:[1,0,1]
v_pk_fma_f32 v[148:149], v[52:53], v[114:115], v[148:149] op_sel_hi:[1,0,1]
v_pk_fma_f32 v[150:151], v[54:55], v[114:115], v[150:151] op_sel_hi:[1,0,1]
v_cvt_pk_bf16_f32 v144, v144, v145
v_cvt_pk_bf16_f32 v145, v146, v147
v_cvt_pk_bf16_f32 v146, v148, v149
v_cvt_pk_bf16_f32 v147, v150, v151
v_permlane32_swap_b32 v136, v138
v_permlane32_swap_b32 v137, v139
buffer_store_dwordx4 v[136:139], v119, s[4:7], 0 offen sc1
s_waitcnt lgkmcnt(0)
v_pk_mul_f32 v[152:153], v[152:153], v[114:115] op_sel:[0,1] op_sel_hi:[1,1]
v_pk_mul_f32 v[154:155], v[154:155], v[114:115] op_sel:[0,1] op_sel_hi:[1,1]
v_pk_mul_f32 v[156:157], v[156:157], v[114:115] op_sel:[0,1] op_sel_hi:[1,1]
v_pk_mul_f32 v[158:159], v[158:159], v[114:115] op_sel:[0,1] op_sel_hi:[1,1]
v_pk_fma_f32 v[152:153], v[56:57], v[114:115], v[152:153] op_sel_hi:[1,0,1]
v_pk_fma_f32 v[154:155], v[58:59], v[114:115], v[154:155] op_sel_hi:[1,0,1]
v_pk_fma_f32 v[156:157], v[60:61], v[114:115], v[156:157] op_sel_hi:[1,0,1]
v_pk_fma_f32 v[158:159], v[62:63], v[114:115], v[158:159] op_sel_hi:[1,0,1]
v_cvt_pk_bf16_f32 v152, v152, v153
v_cvt_pk_bf16_f32 v153, v154, v155
v_cvt_pk_bf16_f32 v154, v156, v157
v_cvt_pk_bf16_f32 v155, v158, v159
v_permlane32_swap_b32 v144, v146
v_permlane32_swap_b32 v145, v147
buffer_store_dwordx4 v[144:147], v120, s[4:7], 0 offen sc1
v_permlane32_swap_b32 v152, v154
v_permlane32_swap_b32 v153, v155
buffer_store_dwordx4 v[152:155], v121, s[4:7], 0 offen sc1
s_branch L_p1_done
L_p1_v:
s_waitcnt vmcnt(4)
s_barrier
ds_read_b128 v[72:75], v16 offset:0
ds_read_b64_tr_b16 v[84:85], v20 offset:0
ds_read_b64_tr_b16 v[86:87], v20 offset:1024
ds_read_b64_tr_b16 v[88:89], v21 offset:0
ds_read_b64_tr_b16 v[90:91], v21 offset:1024
ds_read_b128 v[76:79], v17 offset:0
ds_read_b64_tr_b16 v[92:93], v22 offset:0
ds_read_b64_tr_b16 v[94:95], v22 offset:1024
ds_read_b64_tr_b16 v[96:97], v23 offset:0
ds_read_b64_tr_b16 v[98:99], v23 offset:1024
s_waitcnt lgkmcnt(5)
v_mfma_f32_32x32x16_bf16 v[32:47], v[72:75], v[84:87], 0
ds_read_b128 v[80:83], v18 offset:0
ds_read_b64_tr_b16 v[100:101], v24 offset:0
ds_read_b64_tr_b16 v[102:103], v24 offset:1024
s_add_u32 m0, s32, 32768
s_nop 0
buffer_load_dwordx4 v12, s[8:11], s0 offen lds
s_lshl_b32 s24, s2, 10
s_add_u32 s24, s24, 27852800
buffer_load_dword v9, v6, s[4:7], s24 offen sc1
v_mfma_f32_32x32x16_bf16 v[48:63], v[72:75], v[88:91], 0
ds_read_b64_tr_b16 v[104:105], v25 offset:0
ds_read_b64_tr_b16 v[106:107], v25 offset:1024
buffer_load_dwordx4 v13, s[8:11], s0 offen offset:1024 lds
s_add_u32 s0, s0, 128
s_mul_i32 s24, s29, 52429
s_lshr_b32 s24, s24, 18
s_mul_i32 s25, s24, 5
v_mfma_f32_16x16x32_bf16 v[64:67], v[28:31], v[84:87], 0
v_mfma_f32_16x16x32_bf16 v[68:71], v[28:31], v[88:91], 0
s_waitcnt lgkmcnt(5)
v_mfma_f32_32x32x16_bf16 v[32:47], v[76:79], v[92:95], v[32:47]
ds_read_b128 v[72:75], v19 offset:0
ds_read_b64_tr_b16 v[84:85], v26 offset:0
ds_read_b64_tr_b16 v[86:87], v26 offset:1024
s_add_u32 m0, s33, 32768
s_cmpk_eq_u32 s0, 1280
s_cselect_b32 s0, 0, s0
buffer_load_dwordx4 v14, s[12:15], s17 offen lds
s_sub_u32 s25, s29, s25
s_mul_i32 s26, s25, 6
v_lshrrev_b32 v1, 3, v0
v_mfma_f32_32x32x16_bf16 v[48:63], v[76:79], v[96:99], v[48:63]
ds_read_b64_tr_b16 v[88:89], v27 offset:0
ds_read_b64_tr_b16 v[90:91], v27 offset:1024
buffer_load_dwordx4 v15, s[12:15], s17 offen offset:1024 lds
s_add_u32 s17, s17, 245760
s_cmp_eq_u32 s0, 0
s_cselect_b32 s17, 0, s17
v_cmp_le_u32 vcc, 6, v1
s_cmp_lt_u32 s25, 4
s_cselect_b64 s[64:65], vcc, 0
s_waitcnt lgkmcnt(5)
v_mfma_f32_32x32x16_bf16 v[32:47], v[80:83], v[100:103], v[32:47]
v_add_u32 v1, s26, v1
v_and_b32 v2, 7, v0
v_and_b32 v3, 3, v1
v_lshl_add_u32 v3, v2, 2, v3
s_waitcnt vmcnt(5) lgkmcnt(0)
s_barrier
v_mfma_f32_32x32x16_bf16 v[48:63], v[80:83], v[104:107], v[48:63]
ds_read_b128 v[76:79], v16 offset:16384
ds_read_b64_tr_b16 v[92:93], v20 offset:16384
ds_read_b64_tr_b16 v[94:95], v20 offset:17408
ds_read_b64_tr_b16 v[96:97], v21 offset:16384
ds_read_b64_tr_b16 v[98:99], v21 offset:17408
v_lshrrev_b32 v1, 2, v1
v_lshl_add_u32 v1, v3, 3, v1
s_lshr_b32 s26, s28, 1
v_cmp_eq_u32 vcc, s26, v2
s_add_u32 m0, s32, 49152
s_nop 0
buffer_load_dwordx4 v12, s[8:11], s0 offen lds
v_mfma_f32_32x32x16_bf16 v[32:47], v[72:75], v[84:87], v[32:47]
ds_read_b128 v[80:83], v17 offset:16384
ds_read_b64_tr_b16 v[100:101], v22 offset:16384
ds_read_b64_tr_b16 v[102:103], v22 offset:17408
buffer_load_dwordx4 v13, s[8:11], s0 offen offset:1024 lds
s_add_u32 s0, s0, 128
s_cmp_eq_u32 s24, 0
s_cselect_b64 s[66:67], vcc, -1
s_cselect_b32 s26, 8, 64
v_mfma_f32_32x32x16_bf16 v[48:63], v[72:75], v[88:91], v[48:63]
ds_read_b64_tr_b16 v[104:105], v23 offset:16384
ds_read_b64_tr_b16 v[106:107], v23 offset:17408
s_add_u32 m0, s33, 49152
s_cmpk_eq_u32 s0, 1280
s_cselect_b32 s0, 0, s0
buffer_load_dwordx4 v14, s[12:15], s17 offen lds
s_and_b32 s27, s28, 1
s_add_u32 s27, s27, 64
s_lshl_b32 s25, s24, 5
s_waitcnt lgkmcnt(5)
v_mfma_f32_32x32x16_bf16 v[32:47], v[76:79], v[92:95], v[32:47]
ds_read_b128 v[72:75], v18 offset:16384
ds_read_b64_tr_b16 v[84:85], v24 offset:16384
ds_read_b64_tr_b16 v[86:87], v24 offset:17408
buffer_load_dwordx4 v15, s[12:15], s17 offen offset:1024 lds
s_add_u32 s17, s17, 245760
s_cmp_eq_u32 s0, 0
s_cselect_b32 s17, 0, s17
s_sub_u32 s25, s25, 32
s_add_u32 s25, s25, s28
s_cmp_eq_u32 s24, 0
s_cselect_b32 s25, s27, s25
v_mfma_f32_32x32x16_bf16 v[48:63], v[76:79], v[96:99], v[48:63]
ds_read_b64_tr_b16 v[88:89], v25 offset:16384
ds_read_b64_tr_b16 v[90:91], v25 offset:17408
s_add_u32 m0, s32, 0
s_nop 0
buffer_load_dwordx4 v12, s[8:11], s0 offen lds
s_lshl_b32 s25, s25, 2
s_add_u32 s25, s25, 27852800
v_mov_b32 v2, s26
v_mfma_f32_16x16x32_bf16 v[64:67], v[28:31], v[92:95], v[64:67]
v_mfma_f32_16x16x32_bf16 v[68:71], v[28:31], v[96:99], v[68:71]
s_waitcnt lgkmcnt(5)
v_mfma_f32_32x32x16_bf16 v[32:47], v[80:83], v[100:103], v[32:47]
ds_read_b128 v[76:79], v19 offset:16384
ds_read_b64_tr_b16 v[92:93], v26 offset:16384
ds_read_b64_tr_b16 v[94:95], v26 offset:17408
buffer_load_dwordx4 v13, s[8:11], s0 offen offset:1024 lds
s_add_u32 s0, s0, 128
v_lshl_add_u32 v1, v1, 10, s25
v_cndmask_b32 v2, 0, v2, s[64:65]
v_add_u32 v10, v1, v2
v_mfma_f32_32x32x16_bf16 v[48:63], v[80:83], v[104:107], v[48:63]
ds_read_b64_tr_b16 v[96:97], v27 offset:16384
ds_read_b64_tr_b16 v[98:99], v27 offset:17408
s_add_u32 m0, s33, 0
s_cmpk_eq_u32 s0, 1280
s_cselect_b32 s0, 0, s0
buffer_load_dwordx4 v14, s[12:15], s17 offen lds
s_lshl_b32 s36, s28, 2
s_add_u32 s36, s36, s30
s_lshl_b32 s24, s29, 7
s_waitcnt lgkmcnt(5)
v_mfma_f32_32x32x16_bf16 v[32:47], v[72:75], v[84:87], v[32:47]
s_sub_u32 s24, s24, 1280
s_lshl_b32 s25, s31, 6
s_add_u32 s24, s24, s25
s_mul_i32 s39, s36, 3072
s_waitcnt vmcnt(7) lgkmcnt(0)
s_barrier
v_mfma_f32_32x32x16_bf16 v[48:63], v[72:75], v[88:91], v[48:63]
ds_read_b128 v[80:83], v16 offset:32768
ds_read_b64_tr_b16 v[100:101], v20 offset:32768
ds_read_b64_tr_b16 v[102:103], v20 offset:33792
ds_read_b64_tr_b16 v[104:105], v21 offset:32768
ds_read_b64_tr_b16 v[106:107], v21 offset:33792
s_add_u32 s39, s39, 1024
s_mov_b32 s37, 196608
v_mul_u32_u24 v4, 24, v7
v_mov_b32 v5, 0x7ffffff0
buffer_load_dwordx4 v15, s[12:15], s17 offen offset:1024 lds
s_add_u32 s17, s17, 245760
s_cmp_eq_u32 s0, 0
s_cselect_b32 s17, 0, s17
v_mfma_f32_32x32x16_bf16 v[32:47], v[76:79], v[92:95], v[32:47]
ds_read_b128 v[72:75], v17 offset:32768
ds_read_b64_tr_b16 v[84:85], v22 offset:32768
ds_read_b64_tr_b16 v[86:87], v22 offset:33792
v_mov_b32 v114, 0x3f803f80
s_add_u32 s25, s24, 0
v_add_u32 v1, s25, v8
v_mfma_f32_32x32x16_bf16 v[48:63], v[76:79], v[96:99], v[48:63]
ds_read_b64_tr_b16 v[88:89], v23 offset:32768
ds_read_b64_tr_b16 v[90:91], v23 offset:33792
s_add_u32 m0, s32, 16384
s_nop 0
buffer_load_dwordx4 v12, s[8:11], s0 offen lds
v_mul_u32_u24 v2, 52429, v1
v_lshrrev_b32 v2, 20, v2
v_mul_u32_u24 v3, 20, v2
s_waitcnt lgkmcnt(5)
v_mfma_f32_32x32x16_bf16 v[32:47], v[80:83], v[100:103], v[32:47]
ds_read_b128 v[76:79], v18 offset:32768
ds_read_b64_tr_b16 v[92:93], v24 offset:32768
ds_read_b64_tr_b16 v[94:95], v24 offset:33792
v_sub_u32 v1, v1, v3
v_cmp_eq_u32 vcc, 0, v1
v_mul_lo_u32 v2, v2, s37
v_mfma_f32_32x32x16_bf16 v[48:63], v[80:83], v[104:107], v[48:63]
ds_read_b64_tr_b16 v[96:97], v25 offset:32768
ds_read_b64_tr_b16 v[98:99], v25 offset:33792
buffer_load_dwordx4 v13, s[8:11], s0 offen offset:1024 lds
s_add_u32 s0, s0, 128
v_add_lshl_u32 v3, v1, v4, 4
v_cndmask_b32 v128, 0, v114, vcc
v_cndmask_b32 v129, 0, v114, vcc
v_mfma_f32_16x16x32_bf16 v[64:67], v[28:31], v[100:103], v[64:67]
v_mfma_f32_16x16x32_bf16 v[68:71], v[28:31], v[104:107], v[68:71]
s_waitcnt lgkmcnt(5)
v_mfma_f32_32x32x16_bf16 v[32:47], v[72:75], v[84:87], v[32:47]
ds_read_b128 v[80:83], v19 offset:32768
ds_read_b64_tr_b16 v[100:101], v26 offset:32768
ds_read_b64_tr_b16 v[102:103], v26 offset:33792
v_cndmask_b32 v130, 0, v114, vcc
v_cndmask_b32 v131, 0, v114, vcc
v_cmp_gt_u32 vcc, 4, v1
v_mfma_f32_32x32x16_bf16 v[48:63], v[72:75], v[88:91], v[48:63]
ds_read_b64_tr_b16 v[104:105], v27 offset:32768
ds_read_b64_tr_b16 v[106:107], v27 offset:33792
s_add_u32 m0, s33, 16384
s_cmpk_eq_u32 s0, 1280
s_cselect_b32 s0, 0, s0
buffer_load_dwordx4 v14, s[12:15], s17 offen lds
v_add3_u32 v118, v2, v3, s39
s_nop 0
v_cndmask_b32 v124, v5, v118, vcc
s_waitcnt lgkmcnt(5)
v_mfma_f32_32x32x16_bf16 v[32:47], v[76:79], v[92:95], v[32:47]
s_add_u32 s25, s24, 32
v_add_u32 v1, s25, v8
v_mul_u32_u24 v2, 52429, v1
v_lshrrev_b32 v2, 20, v2
s_waitcnt vmcnt(7) lgkmcnt(0)
s_barrier
v_mfma_f32_32x32x16_bf16 v[48:63], v[76:79], v[96:99], v[48:63]
ds_read_b128 v[72:75], v16 offset:49152
ds_read_b64_tr_b16 v[84:85], v20 offset:49152
ds_read_b64_tr_b16 v[86:87], v20 offset:50176
ds_read_b64_tr_b16 v[88:89], v21 offset:49152
ds_read_b64_tr_b16 v[90:91], v21 offset:50176
v_mul_u32_u24 v3, 20, v2
v_sub_u32 v1, v1, v3
v_cmp_eq_u32 vcc, 0, v1
v_mul_lo_u32 v2, v2, s37
buffer_load_dwordx4 v15, s[12:15], s17 offen offset:1024 lds
s_add_u32 s17, s17, 245760
s_cmp_eq_u32 s0, 0
s_cselect_b32 s17, 0, s17
v_mfma_f32_32x32x16_bf16 v[32:47], v[80:83], v[100:103], v[32:47]
ds_read_b128 v[76:79], v17 offset:49152
ds_read_b64_tr_b16 v[92:93], v22 offset:49152
ds_read_b64_tr_b16 v[94:95], v22 offset:50176
v_add_lshl_u32 v3, v1, v4, 4
v_cndmask_b32 v132, 0, v114, vcc
v_cndmask_b32 v133, 0, v114, vcc
v_mfma_f32_32x32x16_bf16 v[48:63], v[80:83], v[104:107], v[48:63]
ds_read_b64_tr_b16 v[96:97], v23 offset:49152
ds_read_b64_tr_b16 v[98:99], v23 offset:50176
s_add_u32 m0, s32, 32768
s_nop 0
buffer_load_dwordx4 v12, s[8:11], s0 offen lds
v_cndmask_b32 v134, 0, v114, vcc
v_cndmask_b32 v135, 0, v114, vcc
v_cmp_gt_u32 vcc, 4, v1
s_waitcnt lgkmcnt(5)
v_mfma_f32_32x32x16_bf16 v[32:47], v[72:75], v[84:87], v[32:47]
ds_read_b128 v[80:83], v18 offset:49152
ds_read_b64_tr_b16 v[100:101], v24 offset:49152
ds_read_b64_tr_b16 v[102:103], v24 offset:50176
v_add3_u32 v119, v2, v3, s39
s_nop 0
v_cndmask_b32 v125, v5, v119, vcc
v_mfma_f32_32x32x16_bf16 v[48:63], v[72:75], v[88:91], v[48:63]
ds_read_b64_tr_b16 v[104:105], v25 offset:49152
ds_read_b64_tr_b16 v[106:107], v25 offset:50176
buffer_load_dwordx4 v13, s[8:11], s0 offen offset:1024 lds
s_add_u32 s0, s0, 128
buffer_store_dwordx4 v[128:131], v124, s[4:7], 0 offen offset:320 sc1
buffer_store_dwordx4 v[128:131], v124, s[4:7], 0 offen offset:1088 sc1
buffer_store_dwordx4 v[132:135], v125, s[4:7], 0 offen offset:320 sc1
v_mfma_f32_16x16x32_bf16 v[64:67], v[28:31], v[84:87], v[64:67]
v_mfma_f32_16x16x32_bf16 v[68:71], v[28:31], v[88:91], v[68:71]
s_waitcnt lgkmcnt(5)
v_mfma_f32_32x32x16_bf16 v[32:47], v[76:79], v[92:95], v[32:47]
ds_read_b128 v[72:75], v19 offset:49152
ds_read_b64_tr_b16 v[84:85], v26 offset:49152
ds_read_b64_tr_b16 v[86:87], v26 offset:50176
buffer_store_dwordx4 v[132:135], v125, s[4:7], 0 offen offset:1088 sc1
v_mfma_f32_32x32x16_bf16 v[48:63], v[76:79], v[96:99], v[48:63]
ds_read_b64_tr_b16 v[88:89], v27 offset:49152
ds_read_b64_tr_b16 v[90:91], v27 offset:50176
s_add_u32 m0, s33, 32768
s_cmpk_eq_u32 s0, 1280
s_cselect_b32 s0, 0, s0
buffer_load_dwordx4 v14, s[12:15], s17 offen lds
s_waitcnt lgkmcnt(5)
v_mfma_f32_32x32x16_bf16 v[32:47], v[80:83], v[100:103], v[32:47]
s_waitcnt vmcnt(11) lgkmcnt(0)
s_barrier
v_mfma_f32_32x32x16_bf16 v[48:63], v[80:83], v[104:107], v[48:63]
ds_read_b128 v[76:79], v16 offset:0
ds_read_b64_tr_b16 v[92:93], v20 offset:0
ds_read_b64_tr_b16 v[94:95], v20 offset:1024
ds_read_b64_tr_b16 v[96:97], v21 offset:0
ds_read_b64_tr_b16 v[98:99], v21 offset:1024
buffer_load_dwordx4 v15, s[12:15], s17 offen offset:1024 lds
s_add_u32 s17, s17, 245760
s_cmp_eq_u32 s0, 0
s_cselect_b32 s17, 0, s17
v_mfma_f32_32x32x16_bf16 v[32:47], v[72:75], v[84:87], v[32:47]
ds_read_b128 v[80:83], v17 offset:0
ds_read_b64_tr_b16 v[100:101], v22 offset:0
ds_read_b64_tr_b16 v[102:103], v22 offset:1024
v_mfma_f32_32x32x16_bf16 v[48:63], v[72:75], v[88:91], v[48:63]
ds_read_b64_tr_b16 v[104:105], v23 offset:0
ds_read_b64_tr_b16 v[106:107], v23 offset:1024
s_add_u32 m0, s32, 49152
s_nop 0
buffer_load_dwordx4 v12, s[8:11], s0 offen lds
s_waitcnt lgkmcnt(5)
v_mfma_f32_32x32x16_bf16 v[32:47], v[76:79], v[92:95], v[32:47]
ds_read_b128 v[72:75], v18 offset:0
ds_read_b64_tr_b16 v[84:85], v24 offset:0
ds_read_b64_tr_b16 v[86:87], v24 offset:1024
v_mfma_f32_32x32x16_bf16 v[48:63], v[76:79], v[96:99], v[48:63]
ds_read_b64_tr_b16 v[88:89], v25 offset:0
ds_read_b64_tr_b16 v[90:91], v25 offset:1024
buffer_load_dwordx4 v13, s[8:11], s0 offen offset:1024 lds
s_add_u32 s0, s0, 128
v_mfma_f32_16x16x32_bf16 v[64:67], v[28:31], v[92:95], v[64:67]
v_mfma_f32_16x16x32_bf16 v[68:71], v[28:31], v[96:99], v[68:71]
s_waitcnt lgkmcnt(5)
v_mfma_f32_32x32x16_bf16 v[32:47], v[80:83], v[100:103], v[32:47]
ds_read_b128 v[76:79], v19 offset:0
ds_read_b64_tr_b16 v[92:93], v26 offset:0
ds_read_b64_tr_b16 v[94:95], v26 offset:1024
v_mfma_f32_32x32x16_bf16 v[48:63], v[80:83], v[104:107], v[48:63]
ds_read_b64_tr_b16 v[96:97], v27 offset:0
ds_read_b64_tr_b16 v[98:99], v27 offset:1024
s_add_u32 m0, s33, 49152
s_cmpk_eq_u32 s0, 1280
s_cselect_b32 s0, 0, s0
buffer_load_dwordx4 v14, s[12:15], s17 offen lds
s_waitcnt lgkmcnt(5)
v_mfma_f32_32x32x16_bf16 v[32:47], v[72:75], v[84:87], v[32:47]
s_waitcnt vmcnt(11) lgkmcnt(0)
s_barrier
v_mfma_f32_32x32x16_bf16 v[48:63], v[72:75], v[88:91], v[48:63]
ds_read_b128 v[80:83], v16 offset:16384
ds_read_b64_tr_b16 v[100:101], v20 offset:16384
ds_read_b64_tr_b16 v[102:103], v20 offset:17408
ds_read_b64_tr_b16 v[104:105], v21 offset:16384
ds_read_b64_tr_b16 v[106:107], v21 offset:17408
buffer_load_dwordx4 v15, s[12:15], s17 offen offset:1024 lds
s_add_u32 s17, s17, 245760
s_cmp_eq_u32 s0, 0
s_cselect_b32 s17, 0, s17
v_mfma_f32_32x32x16_bf16 v[32:47], v[76:79], v[92:95], v[32:47]
ds_read_b128 v[72:75], v17 offset:16384
ds_read_b64_tr_b16 v[84:85], v22 offset:16384
ds_read_b64_tr_b16 v[86:87], v22 offset:17408
v_mfma_f32_32x32x16_bf16 v[48:63], v[76:79], v[96:99], v[48:63]
ds_read_b64_tr_b16 v[88:89], v23 offset:16384
ds_read_b64_tr_b16 v[90:91], v23 offset:17408
s_add_u32 m0, s32, 0
s_nop 0
buffer_load_dwordx4 v12, s[8:11], s0 offen lds
s_waitcnt lgkmcnt(5)
v_mfma_f32_32x32x16_bf16 v[32:47], v[80:83], v[100:103], v[32:47]
ds_read_b128 v[76:79], v18 offset:16384
ds_read_b64_tr_b16 v[92:93], v24 offset:16384
ds_read_b64_tr_b16 v[94:95], v24 offset:17408
v_mfma_f32_32x32x16_bf16 v[48:63], v[80:83], v[104:107], v[48:63]
ds_read_b64_tr_b16 v[96:97], v25 offset:16384
ds_read_b64_tr_b16 v[98:99], v25 offset:17408
buffer_load_dwordx4 v13, s[8:11], s0 offen offset:1024 lds
s_add_u32 s0, s0, 128
v_mfma_f32_16x16x32_bf16 v[64:67], v[28:31], v[100:103], v[64:67]
v_mfma_f32_16x16x32_bf16 v[68:71], v[28:31], v[104:107], v[68:71]
s_waitcnt lgkmcnt(5)
v_mfma_f32_32x32x16_bf16 v[32:47], v[72:75], v[84:87], v[32:47]
ds_read_b128 v[80:83], v19 offset:16384
ds_read_b64_tr_b16 v[100:101], v26 offset:16384
ds_read_b64_tr_b16 v[102:103], v26 offset:17408
v_mfma_f32_32x32x16_bf16 v[48:63], v[72:75], v[88:91], v[48:63]
ds_read_b64_tr_b16 v[104:105], v27 offset:16384
ds_read_b64_tr_b16 v[106:107], v27 offset:17408
s_add_u32 m0, s33, 0
s_cmpk_eq_u32 s0, 1280
s_cselect_b32 s0, 0, s0
buffer_load_dwordx4 v14, s[12:15], s17 offen lds
s_waitcnt lgkmcnt(5)
v_mfma_f32_32x32x16_bf16 v[32:47], v[76:79], v[92:95], v[32:47]
s_waitcnt vmcnt(7) lgkmcnt(0)
s_barrier
v_mfma_f32_32x32x16_bf16 v[48:63], v[76:79], v[96:99], v[48:63]
ds_read_b128 v[72:75], v16 offset:32768
ds_read_b64_tr_b16 v[84:85], v20 offset:32768
ds_read_b64_tr_b16 v[86:87], v20 offset:33792
ds_read_b64_tr_b16 v[88:89], v21 offset:32768
ds_read_b64_tr_b16 v[90:91], v21 offset:33792
buffer_load_dwordx4 v15, s[12:15], s17 offen offset:1024 lds
s_add_u32 s17, s17, 245760
s_cmp_eq_u32 s0, 0
s_cselect_b32 s17, 0, s17
v_mfma_f32_32x32x16_bf16 v[32:47], v[80:83], v[100:103], v[32:47]
ds_read_b128 v[76:79], v17 offset:32768
ds_read_b64_tr_b16 v[92:93], v22 offset:32768
ds_read_b64_tr_b16 v[94:95], v22 offset:33792
v_mfma_f32_32x32x16_bf16 v[48:63], v[80:83], v[104:107], v[48:63]
ds_read_b64_tr_b16 v[96:97], v23 offset:32768
ds_read_b64_tr_b16 v[98:99], v23 offset:33792
s_add_u32 m0, s32, 16384
s_nop 0
buffer_load_dwordx4 v12, s[8:11], s0 offen lds
s_waitcnt lgkmcnt(5)
v_mfma_f32_32x32x16_bf16 v[32:47], v[72:75], v[84:87], v[32:47]
ds_read_b128 v[80:83], v18 offset:32768
ds_read_b64_tr_b16 v[100:101], v24 offset:32768
ds_read_b64_tr_b16 v[102:103], v24 offset:33792
v_mfma_f32_32x32x16_bf16 v[48:63], v[72:75], v[88:91], v[48:63]
ds_read_b64_tr_b16 v[104:105], v25 offset:32768
ds_read_b64_tr_b16 v[106:107], v25 offset:33792
buffer_load_dwordx4 v13, s[8:11], s0 offen offset:1024 lds
s_add_u32 s0, s0, 128
v_mfma_f32_16x16x32_bf16 v[64:67], v[28:31], v[84:87], v[64:67]
v_mfma_f32_16x16x32_bf16 v[68:71], v[28:31], v[88:91], v[68:71]
s_waitcnt lgkmcnt(5)
v_mfma_f32_32x32x16_bf16 v[32:47], v[76:79], v[92:95], v[32:47]
ds_read_b128 v[72:75], v19 offset:32768
ds_read_b64_tr_b16 v[84:85], v26 offset:32768
ds_read_b64_tr_b16 v[86:87], v26 offset:33792
v_mfma_f32_32x32x16_bf16 v[48:63], v[76:79], v[96:99], v[48:63]
ds_read_b64_tr_b16 v[88:89], v27 offset:32768
ds_read_b64_tr_b16 v[90:91], v27 offset:33792
s_add_u32 m0, s33, 16384
s_cmpk_eq_u32 s0, 1280
s_cselect_b32 s0, 0, s0
buffer_load_dwordx4 v14, s[12:15], s17 offen lds
s_waitcnt lgkmcnt(5)
v_mfma_f32_32x32x16_bf16 v[32:47], v[80:83], v[100:103], v[32:47]
s_waitcnt vmcnt(7) lgkmcnt(0)
s_barrier
v_mfma_f32_32x32x16_bf16 v[48:63], v[80:83], v[104:107], v[48:63]
ds_read_b128 v[76:79], v16 offset:49152
ds_read_b64_tr_b16 v[92:93], v20 offset:49152
ds_read_b64_tr_b16 v[94:95], v20 offset:50176
ds_read_b64_tr_b16 v[96:97], v21 offset:49152
ds_read_b64_tr_b16 v[98:99], v21 offset:50176
buffer_load_dwordx4 v15, s[12:15], s17 offen offset:1024 lds
s_add_u32 s17, s17, 245760
s_cmp_eq_u32 s0, 0
s_cselect_b32 s17, 0, s17
buffer_load_dword v9, off, s[60:63], 0 offset:128 sc1
v_mfma_f32_32x32x16_bf16 v[32:47], v[72:75], v[84:87], v[32:47]
ds_read_b128 v[80:83], v17 offset:49152
ds_read_b64_tr_b16 v[100:101], v22 offset:49152
ds_read_b64_tr_b16 v[102:103], v22 offset:50176
v_mfma_f32_32x32x16_bf16 v[48:63], v[72:75], v[88:91], v[48:63]
ds_read_b64_tr_b16 v[104:105], v23 offset:49152
ds_read_b64_tr_b16 v[106:107], v23 offset:50176
s_waitcnt lgkmcnt(5)
v_mfma_f32_32x32x16_bf16 v[32:47], v[76:79], v[92:95], v[32:47]
ds_read_b128 v[72:75], v18 offset:49152
ds_read_b64_tr_b16 v[84:85], v24 offset:49152
ds_read_b64_tr_b16 v[86:87], v24 offset:50176
v_mfma_f32_32x32x16_bf16 v[48:63], v[76:79], v[96:99], v[48:63]
ds_read_b64_tr_b16 v[88:89], v25 offset:49152
ds_read_b64_tr_b16 v[90:91], v25 offset:50176
v_mfma_f32_16x16x32_bf16 v[64:67], v[28:31], v[92:95], v[64:67]
v_mfma_f32_16x16x32_bf16 v[68:71], v[28:31], v[96:99], v[68:71]
s_waitcnt lgkmcnt(5)
v_mfma_f32_32x32x16_bf16 v[32:47], v[80:83], v[100:103], v[32:47]
ds_read_b128 v[76:79], v19 offset:49152
ds_read_b64_tr_b16 v[92:93], v26 offset:49152
ds_read_b64_tr_b16 v[94:95], v26 offset:50176
v_mfma_f32_32x32x16_bf16 v[48:63], v[80:83], v[104:107], v[48:63]
ds_read_b64_tr_b16 v[96:97], v27 offset:49152
ds_read_b64_tr_b16 v[98:99], v27 offset:50176
s_waitcnt lgkmcnt(5)
v_mfma_f32_32x32x16_bf16 v[32:47], v[72:75], v[84:87], v[32:47]
s_waitcnt vmcnt(5) lgkmcnt(0)
s_barrier
v_mfma_f32_32x32x16_bf16 v[48:63], v[72:75], v[88:91], v[48:63]
ds_read_b128 v[80:83], v16 offset:0
ds_read_b64_tr_b16 v[100:101], v20 offset:0
ds_read_b64_tr_b16 v[102:103], v20 offset:1024
ds_read_b64_tr_b16 v[104:105], v21 offset:0
ds_read_b64_tr_b16 v[106:107], v21 offset:1024
v_mfma_f32_32x32x16_bf16 v[32:47], v[76:79], v[92:95], v[32:47]
ds_read_b128 v[72:75], v17 offset:0
ds_read_b64_tr_b16 v[84:85], v22 offset:0
ds_read_b64_tr_b16 v[86:87], v22 offset:1024
v_mfma_f32_32x32x16_bf16 v[48:63], v[76:79], v[96:99], v[48:63]
ds_read_b64_tr_b16 v[88:89], v23 offset:0
ds_read_b64_tr_b16 v[90:91], v23 offset:1024
s_waitcnt lgkmcnt(5)
v_mfma_f32_32x32x16_bf16 v[32:47], v[80:83], v[100:103], v[32:47]
ds_read_b128 v[76:79], v18 offset:0
ds_read_b64_tr_b16 v[92:93], v24 offset:0
ds_read_b64_tr_b16 v[94:95], v24 offset:1024
v_mfma_f32_32x32x16_bf16 v[48:63], v[80:83], v[104:107], v[48:63]
ds_read_b64_tr_b16 v[96:97], v25 offset:0
ds_read_b64_tr_b16 v[98:99], v25 offset:1024
v_mfma_f32_16x16x32_bf16 v[64:67], v[28:31], v[100:103], v[64:67]
v_mfma_f32_16x16x32_bf16 v[68:71], v[28:31], v[104:107], v[68:71]
s_waitcnt lgkmcnt(5)
v_mfma_f32_32x32x16_bf16 v[32:47], v[72:75], v[84:87], v[32:47]
ds_read_b128 v[80:83], v19 offset:0
ds_read_b64_tr_b16 v[100:101], v26 offset:0
ds_read_b64_tr_b16 v[102:103], v26 offset:1024
v_mfma_f32_32x32x16_bf16 v[48:63], v[72:75], v[88:91], v[48:63]
ds_read_b64_tr_b16 v[104:105], v27 offset:0
ds_read_b64_tr_b16 v[106:107], v27 offset:1024
s_waitcnt lgkmcnt(5)
v_mfma_f32_32x32x16_bf16 v[32:47], v[76:79], v[92:95], v[32:47]
s_waitcnt vmcnt(1) lgkmcnt(0)
s_barrier
v_mfma_f32_32x32x16_bf16 v[48:63], v[76:79], v[96:99], v[48:63]
ds_read_b128 v[72:75], v16 offset:16384
ds_read_b64_tr_b16 v[84:85], v20 offset:16384
ds_read_b64_tr_b16 v[86:87], v20 offset:17408
ds_read_b64_tr_b16 v[88:89], v21 offset:16384
ds_read_b64_tr_b16 v[90:91], v21 offset:17408
buffer_load_dwordx4 v[108:111], v112, s[4:7], 0 offen sc1
v_mfma_f32_32x32x16_bf16 v[32:47], v[80:83], v[100:103], v[32:47]
ds_read_b128 v[76:79], v17 offset:16384
ds_read_b64_tr_b16 v[92:93], v22 offset:16384
ds_read_b64_tr_b16 v[94:95], v22 offset:17408
v_mfma_f32_32x32x16_bf16 v[48:63], v[80:83], v[104:107], v[48:63]
ds_read_b64_tr_b16 v[96:97], v23 offset:16384
ds_read_b64_tr_b16 v[98:99], v23 offset:17408
s_waitcnt lgkmcnt(5)
v_mfma_f32_32x32x16_bf16 v[32:47], v[72:75], v[84:87], v[32:47]
ds_read_b128 v[80:83], v18 offset:16384
ds_read_b64_tr_b16 v[100:101], v24 offset:16384
ds_read_b64_tr_b16 v[102:103], v24 offset:17408
v_mfma_f32_32x32x16_bf16 v[48:63], v[72:75], v[88:91], v[48:63]
ds_read_b64_tr_b16 v[104:105], v25 offset:16384
ds_read_b64_tr_b16 v[106:107], v25 offset:17408
v_mfma_f32_16x16x32_bf16 v[64:67], v[28:31], v[84:87], v[64:67]
v_mfma_f32_16x16x32_bf16 v[68:71], v[28:31], v[88:91], v[68:71]
s_waitcnt lgkmcnt(5)
v_mfma_f32_32x32x16_bf16 v[32:47], v[76:79], v[92:95], v[32:47]
ds_read_b128 v[72:75], v19 offset:16384
ds_read_b64_tr_b16 v[84:85], v26 offset:16384
ds_read_b64_tr_b16 v[86:87], v26 offset:17408
v_mfma_f32_32x32x16_bf16 v[48:63], v[76:79], v[96:99], v[48:63]
ds_read_b64_tr_b16 v[88:89], v27 offset:16384
ds_read_b64_tr_b16 v[90:91], v27 offset:17408
s_waitcnt lgkmcnt(5)
v_mfma_f32_32x32x16_bf16 v[32:47], v[80:83], v[100:103], v[32:47]
v_mfma_f32_32x32x16_bf16 v[48:63], v[80:83], v[104:107], v[48:63]
s_waitcnt lgkmcnt(0)
v_mfma_f32_32x32x16_bf16 v[32:47], v[72:75], v[84:87], v[32:47]
v_mfma_f32_32x32x16_bf16 v[48:63], v[72:75], v[88:91], v[48:63]
s_lshl_b32 s25, s31, 8
s_add_u32 s25, s25, 131072
v_lshl_add_u32 v2, v0, 2, s25
s_lshl_b32 s25, s30, 9
v_add_u32 v3, s25, v2
s_mov_b64 exec, 0xffff
ds_write_b32 v3, v64 offset:0
ds_write_b32 v3, v65 offset:64
ds_write_b32 v3, v68 offset:128
ds_write_b32 v3, v69 offset:192
s_mov_b64 exec, -1
s_waitcnt vmcnt(0)
s_movk_i32 s24, 20000
L_rs_3:
v_cmp_ne_u32 s[64:65], v110, v9
v_cmp_eq_u32 vcc, 0, v9
s_nop 0
s_or_b64 vcc, vcc, s[64:65]
s_cbranch_scc0 L_rsok_4
s_sub_u32 s24, s24, 1
s_cbranch_scc1 L_rsok_4
buffer_load_dword v9, off, s[60:63], 0 offset:128 sc1
buffer_load_dwordx4 v[108:111], v112, s[4:7], 0 offen sc1
s_waitcnt vmcnt(0)
s_branch L_rs_3
L_rsok_4:
s_lshl_b32 s25, s16, 8
s_add_u32 s25, s25, 135168
v_lshl_add_u32 v1, v0, 2, s25
v_lshl_add_u32 v4, v7, 4, s25
v_cndmask_b32 v3, v108, v109, s[22:23]
ds_write_b32 v1, v3
s_waitcnt lgkmcnt(0)
s_barrier
ds_read2st64_b32 v[64:65], v2 offset0:0 offset1:2
ds_read2st64_b32 v[66:67], v2 offset0:4 offset1:6
ds_read_b128 v[128:131], v4 offset:0
ds_read_b128 v[144:147], v4 offset:128
ds_read_b128 v[132:135], v4 offset:32
ds_read_b128 v[148:151], v4 offset:160
ds_read_b128 v[136:139], v4 offset:64
ds_read_b128 v[152:155], v4 offset:192
ds_read_b128 v[140:143], v4 offset:96
ds_read_b128 v[156:159], v4 offset:224
s_waitcnt lgkmcnt(8)
v_pk_add_f32 v[64:65], v[64:65], v[66:67]
v_add_f32 v64, v64, v65
v_mov_b32 v120, v64
v_mov_b32 v122, v64
s_nop 1
v_permlane32_swap_b32 v120, v122
s_waitcnt lgkmcnt(0)
v_pk_mul_f32 v[84:85], v[144:145], v[120:121] op_sel_hi:[1,0]
v_pk_mul_f32 v[86:87], v[146:147], v[120:121] op_sel_hi:[1,0]
v_pk_mul_f32 v[88:89], v[148:149], v[120:121] op_sel_hi:[1,0]
v_pk_mul_f32 v[90:91], v[150:151], v[120:121] op_sel_hi:[1,0]
v_pk_fma_f32 v[84:85], v[32:33], v[128:129], v[84:85]
v_pk_fma_f32 v[86:87], v[34:35], v[130:131], v[86:87]
v_pk_fma_f32 v[88:89], v[36:37], v[132:133], v[88:89]
v_pk_fma_f32 v[90:91], v[38:39], v[134:135], v[90:91]
v_cvt_pk_bf16_f32 v32, v84, v85
v_cvt_pk_bf16_f32 v33, v86, v87
v_cvt_pk_bf16_f32 v34, v88, v89
v_cvt_pk_bf16_f32 v35, v90, v91
buffer_store_dwordx4 v[32:35], v118, s[4:7], 0 offen offset:0 sc1
v_pk_mul_f32 v[84:85], v[152:153], v[120:121] op_sel_hi:[1,0]
v_pk_mul_f32 v[86:87], v[154:155], v[120:121] op_sel_hi:[1,0]
v_pk_mul_f32 v[88:89], v[156:157], v[120:121] op_sel_hi:[1,0]
v_pk_mul_f32 v[90:91], v[158:159], v[120:121] op_sel_hi:[1,0]
v_pk_fma_f32 v[84:85], v[40:41], v[136:137], v[84:85]
v_pk_fma_f32 v[86:87], v[42:43], v[138:139], v[86:87]
v_pk_fma_f32 v[88:89], v[44:45], v[140:141], v[88:89]
v_pk_fma_f32 v[90:91], v[46:47], v[142:143], v[90:91]
v_cvt_pk_bf16_f32 v40, v84, v85
v_cvt_pk_bf16_f32 v41, v86, v87
v_cvt_pk_bf16_f32 v42, v88, v89
v_cvt_pk_bf16_f32 v43, v90, v91
buffer_store_dwordx4 v[40:43], v118, s[4:7], 0 offen offset:768 sc1
v_pk_mul_f32 v[84:85], v[144:145], v[122:123] op_sel_hi:[1,0]
v_pk_mul_f32 v[86:87], v[146:147], v[122:123] op_sel_hi:[1,0]
v_pk_mul_f32 v[88:89], v[148:149], v[122:123] op_sel_hi:[1,0]
v_pk_mul_f32 v[90:91], v[150:151], v[122:123] op_sel_hi:[1,0]
v_pk_fma_f32 v[84:85], v[48:49], v[128:129], v[84:85]
v_pk_fma_f32 v[86:87], v[50:51], v[130:131], v[86:87]
v_pk_fma_f32 v[88:89], v[52:53], v[132:133], v[88:89]
v_pk_fma_f32 v[90:91], v[54:55], v[134:135], v[90:91]
v_cvt_pk_bf16_f32 v48, v84, v85
v_cvt_pk_bf16_f32 v49, v86, v87
v_cvt_pk_bf16_f32 v50, v88, v89
v_cvt_pk_bf16_f32 v51, v90, v91
buffer_store_dwordx4 v[48:51], v119, s[4:7], 0 offen offset:0 sc1
v_pk_mul_f32 v[84:85], v[152:153], v[122:123] op_sel_hi:[1,0]
v_pk_mul_f32 v[86:87], v[154:155], v[122:123] op_sel_hi:[1,0]
v_pk_mul_f32 v[88:89], v[156:157], v[122:123] op_sel_hi:[1,0]
v_pk_mul_f32 v[90:91], v[158:159], v[122:123] op_sel_hi:[1,0]
v_pk_fma_f32 v[84:85], v[56:57], v[136:137], v[84:85]
v_pk_fma_f32 v[86:87], v[58:59], v[138:139], v[86:87]
v_pk_fma_f32 v[88:89], v[60:61], v[140:141], v[88:89]
v_pk_fma_f32 v[90:91], v[62:63], v[142:143], v[90:91]
v_cvt_pk_bf16_f32 v56, v84, v85
v_cvt_pk_bf16_f32 v57, v86, v87
v_cvt_pk_bf16_f32 v58, v88, v89
v_cvt_pk_bf16_f32 v59, v90, v91
buffer_store_dwordx4 v[56:59], v119, s[4:7], 0 offen offset:768 sc1
s_branch L_p1_done
L_p1_cs:
s_mov_b32 s8, s40
s_mov_b32 s9, s41
s_mov_b32 s10, 0x280000
s_mov_b32 s11, 0x20000
s_mov_b64 s[66:67], 0
v_mov_b32 v10, 0x7ffffff0
s_lshl_b32 s24, s28, 7
s_lshl_b32 s25, s16, 4
s_add_u32 s24, s24, s25
v_lshrrev_b32 v3, 3, v0
v_add_u32 v1, s24, v3
v_mul_u32_u24 v1, 1280, v1
v_and_b32 v2, 7, v0
v_lshl_add_u32 v1, v2, 4, v1
v_add_u32 v2, s25, v3
v_lshlrev_b32 v108, 3, v2
s_movk_i32 s24, 10240
buffer_load_dwordx4 v[16:19], v1, s[8:11], 0 offen offset:0
buffer_load_dwordx4 v[20:23], v1, s[8:11], s24 offen offset:0
buffer_load_dwordx4 v[24:27], v1, s[8:11], 0 offen offset:128
buffer_load_dwordx4 v[28:31], v1, s[8:11], s24 offen offset:128
buffer_load_dwordx4 v[32:35], v1, s[8:11], 0 offen offset:256
buffer_load_dwordx4 v[36:39], v1, s[8:11], s24 offen offset:256
buffer_load_dwordx4 v[40:43], v1, s[8:11], 0 offen offset:384
buffer_load_dwordx4 v[44:47], v1, s[8:11], s24 offen offset:384
buffer_load_dwordx4 v[48:51], v1, s[8:11], 0 offen offset:512
buffer_load_dwordx4 v[52:55], v1, s[8:11], s24 offen offset:512
buffer_load_dwordx4 v[56:59], v1, s[8:11], 0 offen offset:640
buffer_load_dwordx4 v[60:63], v1, s[8:11], s24 offen offset:640
buffer_load_dwordx4 v[64:67], v1, s[8:11], 0 offen offset:768
buffer_load_dwordx4 v[68:71], v1, s[8:11], s24 offen offset:768
buffer_load_dwordx4 v[72:75], v1, s[8:11], 0 offen offset:896
buffer_load_dwordx4 v[76:79], v1, s[8:11], s24 offen offset:896
buffer_load_dwordx4 v[80:83], v1, s[8:11], 0 offen offset:1024
buffer_load_dwordx4 v[84:87], v1, s[8:11], s24 offen offset:1024
buffer_load_dwordx4 v[88:91], v1, s[8:11], 0 offen offset:1152
buffer_load_dwordx4 v[92:95], v1, s[8:11], s24 offen offset:1152
s_lshl_b32 s24, s2, 10
s_add_u32 s24, s24, 27852800
buffer_load_dword v109, v6, s[4:7], s24 offen sc1
s_mov_b32 s25, 0x3f803f80
v_mov_b32 v100, 0
v_mov_b32 v101, 0
v_mov_b32 v102, 0
v_mov_b32 v103, 0
v_mov_b32 v104, 0
v_mov_b32 v105, 0
v_mov_b32 v106, 0
v_mov_b32 v107, 0
s_waitcnt vmcnt(20)
v_dot2_f32_bf16 v100, v16, s25, v100
v_dot2_f32_bf16 v101, v16, v16, v101
v_dot2_f32_bf16 v104, v17, s25, v104
v_dot2_f32_bf16 v105, v17, v17, v105
v_dot2_f32_bf16 v100, v18, s25, v100
v_dot2_f32_bf16 v101, v18, v18, v101
v_dot2_f32_bf16 v104, v19, s25, v104
v_dot2_f32_bf16 v105, v19, v19, v105
s_waitcnt vmcnt(19)
v_dot2_f32_bf16 v102, v20, s25, v102
v_dot2_f32_bf16 v103, v20, v20, v103
v_dot2_f32_bf16 v106, v21, s25, v106
v_dot2_f32_bf16 v107, v21, v21, v107
v_dot2_f32_bf16 v102, v22, s25, v102
v_dot2_f32_bf16 v103, v22, v22, v103
v_dot2_f32_bf16 v106, v23, s25, v106
v_dot2_f32_bf16 v107, v23, v23, v107
s_waitcnt vmcnt(18)
v_dot2_f32_bf16 v100, v24, s25, v100
v_dot2_f32_bf16 v101, v24, v24, v101
v_dot2_f32_bf16 v104, v25, s25, v104
v_dot2_f32_bf16 v105, v25, v25, v105
v_dot2_f32_bf16 v100, v26, s25, v100
v_dot2_f32_bf16 v101, v26, v26, v101
v_dot2_f32_bf16 v104, v27, s25, v104
v_dot2_f32_bf16 v105, v27, v27, v105
s_waitcnt vmcnt(17)
v_dot2_f32_bf16 v102, v28, s25, v102
v_dot2_f32_bf16 v103, v28, v28, v103
v_dot2_f32_bf16 v106, v29, s25, v106
v_dot2_f32_bf16 v107, v29, v29, v107
v_dot2_f32_bf16 v102, v30, s25, v102
v_dot2_f32_bf16 v103, v30, v30, v103
v_dot2_f32_bf16 v106, v31, s25, v106
v_dot2_f32_bf16 v107, v31, v31, v107
s_waitcnt vmcnt(16)
v_dot2_f32_bf16 v100, v32, s25, v100
v_dot2_f32_bf16 v101, v32, v32, v101
v_dot2_f32_bf16 v104, v33, s25, v104
v_dot2_f32_bf16 v105, v33, v33, v105
v_dot2_f32_bf16 v100, v34, s25, v100
v_dot2_f32_bf16 v101, v34, v34, v101
v_dot2_f32_bf16 v104, v35, s25, v104
v_dot2_f32_bf16 v105, v35, v35, v105
s_waitcnt vmcnt(15)
v_dot2_f32_bf16 v102, v36, s25, v102
v_dot2_f32_bf16 v103, v36, v36, v103
v_dot2_f32_bf16 v106, v37, s25, v106
v_dot2_f32_bf16 v107, v37, v37, v107
v_dot2_f32_bf16 v102, v38, s25, v102
v_dot2_f32_bf16 v103, v38, v38, v103
v_dot2_f32_bf16 v106, v39, s25, v106
v_dot2_f32_bf16 v107, v39, v39, v107
s_waitcnt vmcnt(14)
v_dot2_f32_bf16 v100, v40, s25, v100
v_dot2_f32_bf16 v101, v40, v40, v101
v_dot2_f32_bf16 v104, v41, s25, v104
v_dot2_f32_bf16 v105, v41, v41, v105
v_dot2_f32_bf16 v100, v42, s25, v100
v_dot2_f32_bf16 v101, v42, v42, v101
v_dot2_f32_bf16 v104, v43, s25, v104
v_dot2_f32_bf16 v105, v43, v43, v105
s_waitcnt vmcnt(13)
v_dot2_f32_bf16 v102, v44, s25, v102
v_dot2_f32_bf16 v103, v44, v44, v103
v_dot2_f32_bf16 v106, v45, s25, v106
v_dot2_f32_bf16 v107, v45, v45, v107
v_dot2_f32_bf16 v102, v46, s25, v102
v_dot2_f32_bf16 v103, v46, v46, v103
v_dot2_f32_bf16 v106, v47, s25, v106
v_dot2_f32_bf16 v107, v47, v47, v107
s_waitcnt vmcnt(12)
v_dot2_f32_bf16 v100, v48, s25, v100
v_dot2_f32_bf16 v101, v48, v48, v101
v_dot2_f32_bf16 v104, v49, s25, v104
v_dot2_f32_bf16 v105, v49, v49, v105
v_dot2_f32_bf16 v100, v50, s25, v100
v_dot2_f32_bf16 v101, v50, v50, v101
v_dot2_f32_bf16 v104, v51, s25, v104
v_dot2_f32_bf16 v105, v51, v51, v105
s_waitcnt vmcnt(11)
v_dot2_f32_bf16 v102, v52, s25, v102
v_dot2_f32_bf16 v103, v52, v52, v103
v_dot2_f32_bf16 v106, v53, s25, v106
v_dot2_f32_bf16 v107, v53, v53, v107
v_dot2_f32_bf16 v102, v54, s25, v102
v_dot2_f32_bf16 v103, v54, v54, v103
v_dot2_f32_bf16 v106, v55, s25, v106
v_dot2_f32_bf16 v107, v55, v55, v107
s_waitcnt vmcnt(10)
v_dot2_f32_bf16 v100, v56, s25, v100
v_dot2_f32_bf16 v101, v56, v56, v101
v_dot2_f32_bf16 v104, v57, s25, v104
v_dot2_f32_bf16 v105, v57, v57, v105
v_dot2_f32_bf16 v100, v58, s25, v100
v_dot2_f32_bf16 v101, v58, v58, v101
v_dot2_f32_bf16 v104, v59, s25, v104
v_dot2_f32_bf16 v105, v59, v59, v105
s_waitcnt vmcnt(9)
v_dot2_f32_bf16 v102, v60, s25, v102
v_dot2_f32_bf16 v103, v60, v60, v103
v_dot2_f32_bf16 v106, v61, s25, v106
v_dot2_f32_bf16 v107, v61, v61, v107
v_dot2_f32_bf16 v102, v62, s25, v102
v_dot2_f32_bf16 v103, v62, v62, v103
v_dot2_f32_bf16 v106, v63, s25, v106
v_dot2_f32_bf16 v107, v63, v63, v107
s_waitcnt vmcnt(8)
v_dot2_f32_bf16 v100, v64, s25, v100
v_dot2_f32_bf16 v101, v64, v64, v101
v_dot2_f32_bf16 v104, v65, s25, v104
v_dot2_f32_bf16 v105, v65, v65, v105
v_dot2_f32_bf16 v100, v66, s25, v100
v_dot2_f32_bf16 v101, v66, v66, v101
v_dot2_f32_bf16 v104, v67, s25, v104
v_dot2_f32_bf16 v105, v67, v67, v105
s_waitcnt vmcnt(7)
v_dot2_f32_bf16 v102, v68, s25, v102
v_dot2_f32_bf16 v103, v68, v68, v103
v_dot2_f32_bf16 v106, v69, s25, v106
v_dot2_f32_bf16 v107, v69, v69, v107
v_dot2_f32_bf16 v102, v70, s25, v102
v_dot2_f32_bf16 v103, v70, v70, v103
v_dot2_f32_bf16 v106, v71, s25, v106
v_dot2_f32_bf16 v107, v71, v71, v107
s_waitcnt vmcnt(6)
v_dot2_f32_bf16 v100, v72, s25, v100
v_dot2_f32_bf16 v101, v72, v72, v101
v_dot2_f32_bf16 v104, v73, s25, v104
v_dot2_f32_bf16 v105, v73, v73, v105
v_dot2_f32_bf16 v100, v74, s25, v100
v_dot2_f32_bf16 v101, v74, v74, v101
v_dot2_f32_bf16 v104, v75, s25, v104
v_dot2_f32_bf16 v105, v75, v75, v105
s_waitcnt vmcnt(5)
v_dot2_f32_bf16 v102, v76, s25, v102
v_dot2_f32_bf16 v103, v76, v76, v103
v_dot2_f32_bf16 v106, v77, s25, v106
v_dot2_f32_bf16 v107, v77, v77, v107
v_dot2_f32_bf16 v102, v78, s25, v102
v_dot2_f32_bf16 v103, v78, v78, v103
v_dot2_f32_bf16 v106, v79, s25, v106
v_dot2_f32_bf16 v107, v79, v79, v107
s_waitcnt vmcnt(4)
v_dot2_f32_bf16 v100, v80, s25, v100
v_dot2_f32_bf16 v101, v80, v80, v101
v_dot2_f32_bf16 v104, v81, s25, v104
v_dot2_f32_bf16 v105, v81, v81, v105
v_dot2_f32_bf16 v100, v82, s25, v100
v_dot2_f32_bf16 v101, v82, v82, v101
v_dot2_f32_bf16 v104, v83, s25, v104
v_dot2_f32_bf16 v105, v83, v83, v105
s_waitcnt vmcnt(3)
v_dot2_f32_bf16 v102, v84, s25, v102
v_dot2_f32_bf16 v103, v84, v84, v103
v_dot2_f32_bf16 v106, v85, s25, v106
v_dot2_f32_bf16 v107, v85, v85, v107
v_dot2_f32_bf16 v102, v86, s25, v102
v_dot2_f32_bf16 v103, v86, v86, v103
v_dot2_f32_bf16 v106, v87, s25, v106
v_dot2_f32_bf16 v107, v87, v87, v107
s_waitcnt vmcnt(2)
v_dot2_f32_bf16 v100, v88, s25, v100
v_dot2_f32_bf16 v101, v88, v88, v101
v_dot2_f32_bf16 v104, v89, s25, v104
v_dot2_f32_bf16 v105, v89, v89, v105
v_dot2_f32_bf16 v100, v90, s25, v100
v_dot2_f32_bf16 v101, v90, v90, v101
v_dot2_f32_bf16 v104, v91, s25, v104
v_dot2_f32_bf16 v105, v91, v91, v105
s_waitcnt vmcnt(1)
v_dot2_f32_bf16 v102, v92, s25, v102
v_dot2_f32_bf16 v103, v92, v92, v103
v_dot2_f32_bf16 v106, v93, s25, v106
v_dot2_f32_bf16 v107, v93, v93, v107
v_dot2_f32_bf16 v102, v94, s25, v102
v_dot2_f32_bf16 v103, v94, v94, v103
v_dot2_f32_bf16 v106, v95, s25, v106
v_dot2_f32_bf16 v107, v95, v95, v107
buffer_load_dword v9, off, s[60:63], 0 offset:128 sc1
v_add_f32 v100, v100, v104
v_add_f32 v101, v101, v105
v_add_f32 v102, v102, v106
v_add_f32 v103, v103, v107
v_add_f32_dpp v100, v100, v100 quad_perm:[1,0,3,2] row_mask:0xf bank_mask:0xf
v_add_f32_dpp v101, v101, v101 quad_perm:[1,0,3,2] row_mask:0xf bank_mask:0xf
v_add_f32_dpp v102, v102, v102 quad_perm:[1,0,3,2] row_mask:0xf bank_mask:0xf
v_add_f32_dpp v103, v103, v103 quad_perm:[1,0,3,2] row_mask:0xf bank_mask:0xf
v_add_f32_dpp v100, v100, v100 quad_perm:[2,3,0,1] row_mask:0xf bank_mask:0xf
v_add_f32_dpp v101, v101, v101 quad_perm:[2,3,0,1] row_mask:0xf bank_mask:0xf
v_add_f32_dpp v102, v102, v102 quad_perm:[2,3,0,1] row_mask:0xf bank_mask:0xf
v_add_f32_dpp v103, v103, v103 quad_perm:[2,3,0,1] row_mask:0xf bank_mask:0xf
v_add_f32_dpp v100, v100, v100 row_half_mirror row_mask:0xf bank_mask:0xf
v_add_f32_dpp v101, v101, v101 row_half_mirror row_mask:0xf bank_mask:0xf
v_add_f32_dpp v102, v102, v102 row_half_mirror row_mask:0xf bank_mask:0xf
v_add_f32_dpp v103, v103, v103 row_half_mirror row_mask:0xf bank_mask:0xf
ds_write_b64 v108, v[100:101]
ds_write_b64 v108, v[102:103] offset:64
s_waitcnt vmcnt(0) lgkmcnt(0)
s_movk_i32 s24, 20000
L_non_5:
v_readfirstlane_b32 s17, v9
s_sub_u32 s24, s24, 1
s_cbranch_scc1 L_nonok_6
s_cmp_lg_u32 s17, 0
s_cbranch_scc1 L_nonok_6
buffer_load_dword v9, off, s[60:63], 0 offset:128 sc1
s_waitcnt vmcnt(0)
s_branch L_non_5
L_nonok_6:
s_barrier
s_cmp_ge_u32 s16, 2
s_cbranch_scc1 L_p1_rsdone
s_lshl_b32 s24, s16, 6
v_add_lshl_u32 v1, v0, s24, 3
ds_read_b64 v[100:101], v1
v_lshlrev_b32 v1, 1, v1
v_mov_b32 v106, s17
v_mov_b32 v107, s17
s_lshl_b32 s24, s28, 11
s_add_u32 s24, s24, 27820032
s_waitcnt lgkmcnt(0)
v_mul_f32 v100, 0x3acccccd, v100
v_mul_f32 v101, 0x3acccccd, v101
v_fma_f32 v101, -v100, v100, v101
v_max_f32 v101, 0, v101
v_add_f32 v101, 0x3727c5ac, v101
v_rsq_f32 v104, v101
s_nop 0
v_mul_f32_e64 v105, -v100, v104
buffer_store_dwordx4 v[104:107], v1, s[4:7], s24 offen sc1
L_p1_rsdone:
L_p1_done:
s_and_b32 s28, s16, 3
s_lshr_b32 s29, s16, 2
s_lshl_b32 s24, s18, 2
s_and_b32 s25, s19, 3
s_add_u32 s30, s24, s25
s_lshr_b32 s31, s2, 5
s_mov_b32 s34, 0
s_lshl_b32 s24, s30, 6
s_lshl_b32 s25, s31, 3
s_add_u32 s25, s25, s24
s_lshl_b32 s26, s28, 1
s_add_u32 s25, s25, s26
s_add_u32 s25, s25, s29
s_xor_b32 s26, s25, 1
s_mul_i32 s36, s25, 1536
s_mul_i32 s64, s26, 1536
s_add_u32 s36, s36, 6291456
s_add_u32 s64, s64, 6291456
s_lshl_b32 s27, s29, 5
s_add_u32 s37, s24, s27
s_add_u32 s37, s37, s28
s_mul_i32 s37, s37, 3072
s_add_u32 s38, s27, 63
s_and_b32 s38, s38, 63
s_add_u32 s38, s38, s24
s_mul_i32 s38, s38, 3072
s_mul_i32 s27, s29, 24576
s_mul_i32 s33, s28, 3072
s_add_u32 s33, s33, s27
s_and_b32 s24, s30, 1
s_mul_i32 s25, s24, 98296
s_mul_i32 s26, s24, 196600
v_mov_b32 v2, s36
v_mov_b32 v3, s64
v_cndmask_b32 v2, v2, v3, s[22:23]
v_lshlrev_b32 v5, 4, v8
v_add_u32 v2, v2, v5
v_subrev_u32 v16, s25, v2
v_add_u32 v2, s38, v5
v_subrev_u32 v17, s26, v2
v_add_u32 v12, s27, v6
s_lshl_b32 s25, s24, 3
s_add_u32 s25, s25, s27
s_add_u32 s25, s25, 2560
v_add_u32 v13, s25, v5
v_mul_u32_u24 v3, 24, v7
v_min_u32 v1, 21, v8
v_add_lshl_u32 v1, v1, v3, 4
s_add_u32 s27, s27, 1024
v_add_u32 v14, s27, v1
s_mul_i32 s0, s24, 196608
v_add_u32 v1, s0, v6
v_cndmask_b32 v15, v1, v6, s[22:23]
s_lshl_b32 s24, s31, 3
s_lshl_b32 s25, s28, 1
s_add_u32 s24, s24, s25
s_add_u32 s24, s24, s29
s_xor_b32 s24, s24, 1
s_mul_i32 s24, s24, 40960
s_add_u32 s24, s24, 9437184
s_lshl_b32 s26, s30, 9
s_add_u32 s26, s26, s24
s_lshl_b32 s25, s30, 7
s_add_u32 s25, s25, s24
s_add_u32 s25, s25, 16384
v_bfe_u32 v1, v0, 4, 1
v_mul_u32_u24 v1, 20480, v1
v_and_b32 v5, 15, v0
v_lshl_add_u32 v2, v5, 4, v1
v_lshl_add_u32 v2, v7, 8, v2
v_lshl_add_u32 v1, v5, 3, v1
v_add_u32 v18, s26, v2
v_add_u32 v19, s25, v1
v_mov_b32 v144, 0
v_mov_b32 v145, 0
v_mov_b32 v146, 0
v_mov_b32 v147, 0
v_mov_b32 v148, 0
v_mov_b32 v149, 0
v_mov_b32 v150, 0
v_mov_b32 v151, 0
v_mov_b32 v152, 0
v_mov_b32 v153, 0
v_mov_b32 v154, 0
v_mov_b32 v155, 0
v_mov_b32 v156, 0
v_mov_b32 v157, 0
v_mov_b32 v158, 0
v_mov_b32 v159, 0
v_mov_b32 v160, 0
v_mov_b32 v161, 0
v_mov_b32 v162, 0
v_mov_b32 v163, 0
v_mov_b32 v164, 0
v_mov_b32 v165, 0
v_mov_b32 v166, 0
v_mov_b32 v167, 0
v_mov_b32 v168, 0
v_mov_b32 v169, 0
v_mov_b32 v170, 0
v_mov_b32 v171, 0
v_mov_b32 v172, 0
v_mov_b32 v173, 0
v_mov_b32 v174, 0
v_mov_b32 v175, 0
s_mov_b32 s39, s64
s_lshl_b32 s21, s16, 8
s_add_u32 s21, s21, s2
s_mul_i32 s1, s16, 5120
s_add_u32 s1, s1, 61440
s_cmp_ge_u32 s21, 960
s_cbranch_scc1 L_jp_b0
s_mul_i32 s24, s21, 1366
s_lshr_b32 s24, s24, 16
s_mul_i32 s25, s24, 48
s_sub_u32 s25, s21, s25
s_and_b32 s64, s25, 1
s_lshr_b32 s25, s25, 1
s_mul_i32 s26, s24, 98304
s_lshl_b32 s27, s25, 7
s_add_u32 s26, s26, s27
v_lshrrev_b32 v1, 3, v0
v_mul_u32_u24 v1, 3072, v1
v_and_b32 v2, 7, v0
v_lshl_add_u32 v1, v2, 4, v1
v_add_u32 v194, s26, v1
v_add_u32 v195, 24576, v194
v_add_u32 v196, 49152, v194
v_add_u32 v197, 73728, v194
v_mov_b32 v198, 0x7ffffff0
s_bitcmp1_b32 s21, 0
s_cselect_b32 s8, s50, s48
s_cselect_b32 s9, s51, s49
s_mov_b32 s10, 0x1e0000
s_mov_b32 s11, 0x20000
s_mul_i32 s46, s24, 6
s_add_u32 s46, s46, s64
s_lshl_b32 s46, s46, 10
s_add_u32 s46, s46, 21790720
s_lshl_b32 s47, s25, 2
s_branch L_jp_e0
L_jp_b0:
s_sub_u32 s24, s21, 960
s_cmp_ge_u32 s24, 160
s_cbranch_scc1 L_jp_d0
s_and_b32 s25, s24, 7
s_lshr_b32 s24, s24, 3
s_mul_i32 s46, s25, 20
s_add_u32 s46, s46, s24
s_mul_i32 s46, s46, 5120
s_add_u32 s46, s46, 20971520
s_cmp_ge_u32 s24, 10
s_cselect_b32 s26, 10, 0
s_cselect_b32 s27, 320, 0
s_sub_u32 s24, s24, s26
s_mul_i32 s26, s24, 40
s_mul_i32 s47, s24, 160
s_sub_u32 s47, s47, 1264
s_cmp_lt_u32 s24, 8
s_cselect_b32 s24, s26, s47
s_cselect_b32 s64, 20, 80
s_cselect_b32 s65, 4, 40
s_cselect_b32 s3, 8, 20
s_add_u32 s24, s24, s27
s_branch L_jp_r0
L_jp_d0:
s_sub_u32 s24, s24, 160
s_and_b32 s25, s24, 7
s_lshr_b32 s24, s24, 3
s_mul_i32 s46, s25, 48
s_add_u32 s46, s46, s24
s_mul_i32 s46, s46, 5120
s_add_u32 s46, s46, 25722880
s_lshl_b32 s24, s24, 5
s_mov_b32 s64, 16
s_mov_b32 s65, 8
s_mov_b32 s3, 4
L_jp_r0:
s_cmp_ge_u32 s21, 1120
s_cselect_b32 s8, s52, s44
s_cselect_b32 s9, s53, s45
s_mov_b32 s10, 0xc8000
s_cmov_b32 s10, 0x1e0000
s_mov_b32 s11, 0x20000
s_mul_i32 s24, s24, 1280
s_mul_i32 s25, s25, 160
s_add_u32 s25, s25, s24
v_add_u32 v1, 0, v0
v_mul_u32_u24 v2, 6554, v1
v_lshrrev_b32 v2, 16, v2
v_mul_u32_u24 v3, 10, v2
v_sub_u32 v1, v1, v3
v_lshl_add_u32 v194, v1, 4, s25
v_and_b32 v1, 3, v2
v_bfe_u32 v3, v2, 2, 1
v_mad_u32_u24 v1, v3, s3, v1
v_bfe_u32 v3, v2, 3, 1
v_mad_u32_u24 v1, v3, s65, v1
v_lshrrev_b32 v3, 4, v2
v_mad_u32_u24 v1, v3, s64, v1
v_mul_u32_u24 v1, 1280, v1
v_add_u32 v194, v194, v1
v_add_u32 v1, 64, v0
v_mul_u32_u24 v2, 6554, v1
v_lshrrev_b32 v2, 16, v2
v_mul_u32_u24 v3, 10, v2
v_sub_u32 v1, v1, v3
v_lshl_add_u32 v195, v1, 4, s25
v_and_b32 v1, 3, v2
v_bfe_u32 v3, v2, 2, 1
v_mad_u32_u24 v1, v3, s3, v1
v_bfe_u32 v3, v2, 3, 1
v_mad_u32_u24 v1, v3, s65, v1
v_lshrrev_b32 v3, 4, v2
v_mad_u32_u24 v1, v3, s64, v1
v_mul_u32_u24 v1, 1280, v1
v_add_u32 v195, v195, v1
v_add_u32 v1, 128, v0
v_mul_u32_u24 v2, 6554, v1
v_lshrrev_b32 v2, 16, v2
v_mul_u32_u24 v3, 10, v2
v_sub_u32 v1, v1, v3
v_lshl_add_u32 v196, v1, 4, s25
v_and_b32 v1, 3, v2
v_bfe_u32 v3, v2, 2, 1
v_mad_u32_u24 v1, v3, s3, v1
v_bfe_u32 v3, v2, 3, 1
v_mad_u32_u24 v1, v3, s65, v1
v_lshrrev_b32 v3, 4, v2
v_mad_u32_u24 v1, v3, s64, v1
v_mul_u32_u24 v1, 1280, v1
v_add_u32 v196, v196, v1
v_add_u32 v1, 192, v0
v_mul_u32_u24 v2, 6554, v1
v_lshrrev_b32 v2, 16, v2
v_mul_u32_u24 v3, 10, v2
v_sub_u32 v1, v1, v3
v_lshl_add_u32 v197, v1, 4, s25
v_and_b32 v1, 3, v2
v_bfe_u32 v3, v2, 2, 1
v_mad_u32_u24 v1, v3, s3, v1
v_bfe_u32 v3, v2, 3, 1
v_mad_u32_u24 v1, v3, s65, v1
v_lshrrev_b32 v3, 4, v2
v_mad_u32_u24 v1, v3, s64, v1
v_mul_u32_u24 v1, 1280, v1
v_add_u32 v197, v197, v1
v_add_u32 v1, 256, v0
v_mul_u32_u24 v2, 6554, v1
v_lshrrev_b32 v2, 16, v2
v_mul_u32_u24 v3, 10, v2
v_sub_u32 v1, v1, v3
v_lshl_add_u32 v198, v1, 4, s25
v_and_b32 v1, 3, v2
v_bfe_u32 v3, v2, 2, 1
v_mad_u32_u24 v1, v3, s3, v1
v_bfe_u32 v3, v2, 3, 1
v_mad_u32_u24 v1, v3, s65, v1
v_lshrrev_b32 v3, 4, v2
v_mad_u32_u24 v1, v3, s64, v1
v_mul_u32_u24 v1, 1280, v1
v_add_u32 v198, v198, v1
L_jp_e0:
v_lshrrev_b32 v1, 4, v0
v_bfe_u32 v2, v0, 2, 2
v_lshl_add_u32 v1, v1, 3, v2
v_and_b32 v2, 3, v0
s_cmp_ge_u32 s21, 960
s_cbranch_scc1 L_j2_b
v_lshlrev_b32 v1, 7, v1
v_lshl_add_u32 v1, v2, 3, v1
v_add_u32 v50, s1, v1
v_mov_b32 v51, v50
s_add_u32 s24, s47, 0
s_mul_i32 s25, s24, 21846
s_lshr_b32 s25, s25, 16
s_mul_i32 s25, s25, 57
s_add_u32 s24, s24, s25
s_lshl_b32 s24, s24, 11
s_add_u32 s12, s24, s46
s_add_u32 s24, s47, 1
s_mul_i32 s25, s24, 21846
s_lshr_b32 s25, s25, 16
s_mul_i32 s25, s25, 57
s_add_u32 s24, s24, s25
s_lshl_b32 s24, s24, 11
s_add_u32 s13, s24, s46
s_add_u32 s24, s47, 2
s_mul_i32 s25, s24, 21846
s_lshr_b32 s25, s25, 16
s_mul_i32 s25, s25, 57
s_add_u32 s24, s24, s25
s_lshl_b32 s24, s24, 11
s_add_u32 s14, s24, s46
s_add_u32 s24, s47, 3
s_mul_i32 s25, s24, 21846
s_lshr_b32 s25, s25, 16
s_mul_i32 s25, s25, 57
s_add_u32 s24, s24, s25
s_lshl_b32 s24, s24, 11
s_add_u32 s15, s24, s46
s_mov_b32 s46, 0x7ffffff0
s_branch L_j2_e
L_j2_b:
s_cmp_ge_u32 s21, 1504
s_cselect_b32 s46, 0x7fff0000, s46
v_mul_u32_u24 v1, 160, v1
v_add_u32 v1, s1, v1
v_lshl_add_u32 v51, v2, 3, v1
v_lshl_add_u32 v50, v2, 4, v1
s_mov_b32 s12, s46
s_add_u32 s13, s46, 1024
s_add_u32 s14, s46, 2048
s_add_u32 s15, s46, 3072
s_add_u32 s46, s46, 4096
L_j2_e:
s_mov_b32 s64, s39
s_waitcnt vmcnt(0) lgkmcnt(0)
s_movk_i32 s24, 20000
L_non_7:
v_readfirstlane_b32 s17, v9
s_sub_u32 s24, s24, 1
s_cbranch_scc1 L_nonok_8
s_cmp_lg_u32 s17, 0
s_cbranch_scc1 L_nonok_8
buffer_load_dword v9, off, s[60:63], 0 offset:128 sc1
s_waitcnt vmcnt(0)
s_branch L_non_7
L_nonok_8:
s_barrier
s_cmp_lg_u32 s16, 7
s_cbranch_scc1 L_at_go
v_mov_b32 v1, s17
s_mov_b64 exec, s[66:67]
s_cbranch_execz L_at_nosig
buffer_atomic_swap v1, v10, s[4:7], 0 offen sc1
L_at_nosig:
s_mov_b64 exec, -1
s_lshr_b32 s24, s30, 1
s_mul_i32 s25, s24, 21846
s_lshr_b32 s25, s25, 16
s_mul_i32 s26, s25, 3
s_sub_u32 s25, s25, 1
s_cmp_lt_u32 s25, 4
s_cselect_b32 s25, s26, 99
s_cmp_eq_u32 s25, s24
s_cselect_b32 s66, -1, 0xffff
s_cselect_b32 s26, 15, 3
s_mov_b32 s67, s66
s_mov_b32 s27, 0
s_lshl_b32 s25, s2, 10
s_add_u32 s25, s25, 27852800
v_lshlrev_b32 v10, 2, v0
s_movk_i32 s24, 20000
L_at_poll:
v_mov_b32 v1, 0
v_mov_b32 v2, 0
buffer_atomic_or v1, v10, s[4:7], s25 offen sc0 sc1
s_mov_b64 exec, 15
buffer_atomic_or v2, v10, s[4:7], s25 offen offset:256 sc0 sc1
s_mov_b64 exec, -1
s_sub_u32 s24, s24, 1
s_cbranch_scc1 L_at_pollok
s_waitcnt vmcnt(0)
v_cmp_ne_u32 vcc, s17, v2
s_nop 0
s_and_b64 s[64:65], vcc, s[26:27]
v_cmp_ne_u32 vcc, s17, v1
s_nop 0
s_and_b64 vcc, vcc, s[66:67]
s_or_b64 vcc, vcc, s[64:65]
s_cbranch_scc1 L_at_poll
L_at_pollok:
s_waitcnt vmcnt(0)
s_xor_b32 s26, s29, 1
s_lshl_b32 s26, s26, 1
s_sub_u32 s26, s26, 1
s_mul_i32 s26, s26, 1536
s_add_u32 s64, s36, s26
L_at_go:
s_barrier
buffer_load_dwordx2 v[32:33], v16, s[4:7], 0 offen offset:1024 sc1
buffer_load_dwordx4 v[24:27], v6, s[4:7], s36 offen sc1
buffer_load_dwordx4 v[28:31], v6, s[4:7], s64 offen sc1
buffer_load_dwordx4 v[36:39], v6, s[4:7], s38 offen sc1
buffer_load_dwordx2 v[34:35], v17, s[4:7], 0 offen offset:2560 sc1
s_mov_b32 s32, s37
s_add_u32 m0, s33, 0
s_sub_u32 s24, s32, s0
buffer_load_dwordx4 v6, s[4:7], s32 offen sc1 lds
buffer_load_dwordx4 v6, s[4:7], s32 offen offset:1024 sc1 lds
buffer_load_dwordx4 v15, s[4:7], s24 offen offset:2048 sc1 lds
s_add_u32 s32, s32, 12288
s_waitcnt vmcnt(3)
v_mfma_f32_32x32x4_2b_bf16 v[80:111], v[34:35], v[32:33], 0
s_nop 15
s_nop 1
v_mfma_f32_32x32x16_bf16 v[80:95], v[36:39], v[24:27], v[80:95]
v_mfma_f32_32x32x16_bf16 v[96:111], v[36:39], v[28:31], v[96:111]
s_waitcnt vmcnt(0)
s_barrier
ds_read_b128 v[40:43], v14
ds_read_b128 v[36:39], v12
ds_read_b64 v[34:35], v13
s_add_u32 m0, s33, 12288
s_sub_u32 s24, s32, s0
buffer_load_dwordx4 v6, s[4:7], s32 offen sc1 lds
buffer_load_dwordx4 v6, s[4:7], s32 offen offset:1024 sc1 lds
buffer_load_dwordx4 v15, s[4:7], s24 offen offset:2048 sc1 lds
s_add_u32 s32, s32, 12288
v_exp_f32 v80, v80
v_exp_f32 v81, v81
v_exp_f32 v82, v82
ds_read_b128 v[44:47], v14 offset:768
v_exp_f32 v83, v83
v_cvt_pk_bf16_f32 v80, v80, v81
v_exp_f32 v84, v84
v_exp_f32 v85, v85
v_cvt_pk_bf16_f32 v81, v82, v83
v_exp_f32 v86, v86
v_exp_f32 v87, v87
v_cvt_pk_bf16_f32 v82, v84, v85
s_waitcnt lgkmcnt(0)
v_mfma_f32_32x32x4_2b_bf16 v[112:143], v[34:35], v[32:33], 0
ds_read_b64 v[34:35], v13 offset:3072
s_add_u32 m0, s1, 0
s_nop 0
buffer_load_dwordx4 v194, s[8:11], 0 offen lds
v_cvt_pk_bf16_f32 v83, v86, v87
v_exp_f32 v88, v88
v_exp_f32 v89, v89
v_exp_f32 v90, v90
v_exp_f32 v91, v91
v_cvt_pk_bf16_f32 v88, v88, v89
v_exp_f32 v92, v92
v_exp_f32 v93, v93
v_mfma_f32_32x32x16_bf16 v[144:159], v[40:43], v[80:83], v[144:159]
v_cvt_pk_bf16_f32 v89, v90, v91
v_exp_f32 v94, v94
v_exp_f32 v95, v95
v_cvt_pk_bf16_f32 v90, v92, v93
v_cvt_pk_bf16_f32 v91, v94, v95
v_exp_f32 v96, v96
v_exp_f32 v97, v97
v_exp_f32 v98, v98
v_mfma_f32_32x32x16_bf16 v[144:159], v[44:47], v[88:91], v[144:159]
v_exp_f32 v99, v99
v_cvt_pk_bf16_f32 v96, v96, v97
v_exp_f32 v100, v100
v_exp_f32 v101, v101
v_cvt_pk_bf16_f32 v97, v98, v99
v_mfma_f32_32x32x16_bf16 v[112:127], v[36:39], v[24:27], v[112:127]
v_exp_f32 v102, v102
v_exp_f32 v103, v103
v_cvt_pk_bf16_f32 v98, v100, v101
v_cvt_pk_bf16_f32 v99, v102, v103
v_exp_f32 v104, v104
v_exp_f32 v105, v105
v_exp_f32 v106, v106
v_mfma_f32_32x32x16_bf16 v[160:175], v[40:43], v[96:99], v[160:175]
ds_read_b128 v[40:43], v14 offset:3072
v_exp_f32 v107, v107
v_cvt_pk_bf16_f32 v104, v104, v105
v_exp_f32 v108, v108
v_exp_f32 v109, v109
v_cvt_pk_bf16_f32 v105, v106, v107
v_mfma_f32_32x32x16_bf16 v[128:143], v[36:39], v[28:31], v[128:143]
ds_read_b128 v[36:39], v12 offset:3072
v_exp_f32 v110, v110
v_exp_f32 v111, v111
v_cvt_pk_bf16_f32 v106, v108, v109
v_cvt_pk_bf16_f32 v107, v110, v111
v_exp_f32 v112, v112
v_exp_f32 v113, v113
v_exp_f32 v114, v114
v_mfma_f32_32x32x16_bf16 v[160:175], v[44:47], v[104:107], v[160:175]
ds_read_b128 v[44:47], v14 offset:3840
v_exp_f32 v115, v115
v_cvt_pk_bf16_f32 v112, v112, v113
v_exp_f32 v116, v116
v_exp_f32 v117, v117
v_cvt_pk_bf16_f32 v113, v114, v115
v_exp_f32 v118, v118
v_exp_f32 v119, v119
v_cvt_pk_bf16_f32 v114, v116, v117
s_waitcnt lgkmcnt(0)
v_mfma_f32_32x32x4_2b_bf16 v[80:111], v[34:35], v[32:33], 0
ds_read_b64 v[34:35], v13 offset:6144
s_add_u32 m0, s1, 1024
s_nop 0
buffer_load_dwordx4 v195, s[8:11], 0 offen lds
v_cvt_pk_bf16_f32 v115, v118, v119
v_exp_f32 v120, v120
v_exp_f32 v121, v121
v_exp_f32 v122, v122
v_exp_f32 v123, v123
v_cvt_pk_bf16_f32 v120, v120, v121
v_exp_f32 v124, v124
v_exp_f32 v125, v125
v_mfma_f32_32x32x16_bf16 v[144:159], v[40:43], v[112:115], v[144:159]
v_cvt_pk_bf16_f32 v121, v122, v123
v_exp_f32 v126, v126
v_exp_f32 v127, v127
v_cvt_pk_bf16_f32 v122, v124, v125
v_cvt_pk_bf16_f32 v123, v126, v127
v_exp_f32 v128, v128
v_exp_f32 v129, v129
v_exp_f32 v130, v130
v_mfma_f32_32x32x16_bf16 v[144:159], v[44:47], v[120:123], v[144:159]
v_exp_f32 v131, v131
v_cvt_pk_bf16_f32 v128, v128, v129
v_exp_f32 v132, v132
v_exp_f32 v133, v133
v_cvt_pk_bf16_f32 v129, v130, v131
v_mfma_f32_32x32x16_bf16 v[80:95], v[36:39], v[24:27], v[80:95]
v_exp_f32 v134, v134
v_exp_f32 v135, v135
v_cvt_pk_bf16_f32 v130, v132, v133
v_cvt_pk_bf16_f32 v131, v134, v135
v_exp_f32 v136, v136
v_exp_f32 v137, v137
v_exp_f32 v138, v138
v_mfma_f32_32x32x16_bf16 v[160:175], v[40:43], v[128:131], v[160:175]
ds_read_b128 v[40:43], v14 offset:6144
v_exp_f32 v139, v139
v_cvt_pk_bf16_f32 v136, v136, v137
v_exp_f32 v140, v140
v_exp_f32 v141, v141
v_cvt_pk_bf16_f32 v137, v138, v139
v_mfma_f32_32x32x16_bf16 v[96:111], v[36:39], v[28:31], v[96:111]
ds_read_b128 v[36:39], v12 offset:6144
v_exp_f32 v142, v142
v_exp_f32 v143, v143
v_cvt_pk_bf16_f32 v138, v140, v141
v_cvt_pk_bf16_f32 v139, v142, v143
v_exp_f32 v80, v80
v_exp_f32 v81, v81
v_exp_f32 v82, v82
v_mfma_f32_32x32x16_bf16 v[160:175], v[44:47], v[136:139], v[160:175]
ds_read_b128 v[44:47], v14 offset:6912
v_exp_f32 v83, v83
v_cvt_pk_bf16_f32 v80, v80, v81
v_exp_f32 v84, v84
v_exp_f32 v85, v85
v_cvt_pk_bf16_f32 v81, v82, v83
v_exp_f32 v86, v86
v_exp_f32 v87, v87
v_cvt_pk_bf16_f32 v82, v84, v85
s_waitcnt lgkmcnt(0)
v_mfma_f32_32x32x4_2b_bf16 v[112:143], v[34:35], v[32:33], 0
ds_read_b64 v[34:35], v13 offset:9216
s_add_u32 m0, s1, 2048
s_nop 0
buffer_load_dwordx4 v196, s[8:11], 0 offen lds
v_cvt_pk_bf16_f32 v83, v86, v87
v_exp_f32 v88, v88
v_exp_f32 v89, v89
v_exp_f32 v90, v90
v_exp_f32 v91, v91
v_cvt_pk_bf16_f32 v88, v88, v89
v_exp_f32 v92, v92
v_exp_f32 v93, v93
v_mfma_f32_32x32x16_bf16 v[144:159], v[40:43], v[80:83], v[144:159]
v_cvt_pk_bf16_f32 v89, v90, v91
v_exp_f32 v94, v94
v_exp_f32 v95, v95
v_cvt_pk_bf16_f32 v90, v92, v93
v_cvt_pk_bf16_f32 v91, v94, v95
v_exp_f32 v96, v96
v_exp_f32 v97, v97
v_exp_f32 v98, v98
v_mfma_f32_32x32x16_bf16 v[144:159], v[44:47], v[88:91], v[144:159]
v_exp_f32 v99, v99
v_cvt_pk_bf16_f32 v96, v96, v97
v_exp_f32 v100, v100
v_exp_f32 v101, v101
v_cvt_pk_bf16_f32 v97, v98, v99
v_mfma_f32_32x32x16_bf16 v[112:127], v[36:39], v[24:27], v[112:127]
v_exp_f32 v102, v102
v_exp_f32 v103, v103
v_cvt_pk_bf16_f32 v98, v100, v101
v_cvt_pk_bf16_f32 v99, v102, v103
v_exp_f32 v104, v104
v_exp_f32 v105, v105
v_exp_f32 v106, v106
v_mfma_f32_32x32x16_bf16 v[160:175], v[40:43], v[96:99], v[160:175]
ds_read_b128 v[40:43], v14 offset:9216
v_exp_f32 v107, v107
v_cvt_pk_bf16_f32 v104, v104, v105
v_exp_f32 v108, v108
v_exp_f32 v109, v109
v_cvt_pk_bf16_f32 v105, v106, v107
v_mfma_f32_32x32x16_bf16 v[128:143], v[36:39], v[28:31], v[128:143]
ds_read_b128 v[36:39], v12 offset:9216
v_exp_f32 v110, v110
v_exp_f32 v111, v111
v_cvt_pk_bf16_f32 v106, v108, v109
v_cvt_pk_bf16_f32 v107, v110, v111
v_exp_f32 v112, v112
v_exp_f32 v113, v113
v_exp_f32 v114, v114
v_mfma_f32_32x32x16_bf16 v[160:175], v[44:47], v[104:107], v[160:175]
ds_read_b128 v[44:47], v14 offset:9984
v_exp_f32 v115, v115
v_cvt_pk_bf16_f32 v112, v112, v113
v_exp_f32 v116, v116
v_exp_f32 v117, v117
v_cvt_pk_bf16_f32 v113, v114, v115
v_exp_f32 v118, v118
v_exp_f32 v119, v119
v_cvt_pk_bf16_f32 v114, v116, v117
s_waitcnt vmcnt(3) lgkmcnt(0)
s_barrier
v_mfma_f32_32x32x4_2b_bf16 v[80:111], v[34:35], v[32:33], 0
ds_read_b64 v[34:35], v13 offset:12288
s_add_u32 m0, s1, 3072
s_nop 0
buffer_load_dwordx4 v197, s[8:11], 0 offen lds
s_add_u32 m0, s33, 0
s_nop 0
buffer_load_dwordx4 v6, s[4:7], s32 offen offset:0 sc1 lds
v_cvt_pk_bf16_f32 v115, v118, v119
v_exp_f32 v120, v120
v_exp_f32 v121, v121
v_exp_f32 v122, v122
v_exp_f32 v123, v123
v_cvt_pk_bf16_f32 v120, v120, v121
v_exp_f32 v124, v124
v_exp_f32 v125, v125
v_mfma_f32_32x32x16_bf16 v[144:159], v[40:43], v[112:115], v[144:159]
s_add_u32 m0, s33, 0
s_nop 0
buffer_load_dwordx4 v6, s[4:7], s32 offen offset:1024 sc1 lds
v_cvt_pk_bf16_f32 v121, v122, v123
v_exp_f32 v126, v126
v_exp_f32 v127, v127
v_cvt_pk_bf16_f32 v122, v124, v125
v_cvt_pk_bf16_f32 v123, v126, v127
v_exp_f32 v128, v128
v_exp_f32 v129, v129
v_exp_f32 v130, v130
v_mfma_f32_32x32x16_bf16 v[144:159], v[44:47], v[120:123], v[144:159]
s_add_u32 m0, s33, 0
s_sub_u32 s24, s32, s0
buffer_load_dwordx4 v15, s[4:7], s24 offen offset:2048 sc1 lds
s_add_u32 s32, s32, 12288
v_exp_f32 v131, v131
v_cvt_pk_bf16_f32 v128, v128, v129
v_exp_f32 v132, v132
v_exp_f32 v133, v133
v_cvt_pk_bf16_f32 v129, v130, v131
v_mfma_f32_32x32x16_bf16 v[80:95], v[36:39], v[24:27], v[80:95]
v_exp_f32 v134, v134
v_exp_f32 v135, v135
v_cvt_pk_bf16_f32 v130, v132, v133
v_cvt_pk_bf16_f32 v131, v134, v135
v_exp_f32 v136, v136
v_exp_f32 v137, v137
v_exp_f32 v138, v138
v_mfma_f32_32x32x16_bf16 v[160:175], v[40:43], v[128:131], v[160:175]
ds_read_b128 v[40:43], v14 offset:12288
v_exp_f32 v139, v139
v_cvt_pk_bf16_f32 v136, v136, v137
v_exp_f32 v140, v140
v_exp_f32 v141, v141
v_cvt_pk_bf16_f32 v137, v138, v139
v_mfma_f32_32x32x16_bf16 v[96:111], v[36:39], v[28:31], v[96:111]
ds_read_b128 v[36:39], v12 offset:12288
v_exp_f32 v142, v142
v_exp_f32 v143, v143
v_cvt_pk_bf16_f32 v138, v140, v141
v_cvt_pk_bf16_f32 v139, v142, v143
v_exp_f32 v80, v80
v_exp_f32 v81, v81
v_exp_f32 v82, v82
v_mfma_f32_32x32x16_bf16 v[160:175], v[44:47], v[136:139], v[160:175]
ds_read_b128 v[44:47], v14 offset:13056
v_exp_f32 v83, v83
v_cvt_pk_bf16_f32 v80, v80, v81
v_exp_f32 v84, v84
v_exp_f32 v85, v85
v_cvt_pk_bf16_f32 v81, v82, v83
v_exp_f32 v86, v86
v_exp_f32 v87, v87
v_cvt_pk_bf16_f32 v82, v84, v85
s_waitcnt lgkmcnt(0)
v_mfma_f32_32x32x4_2b_bf16 v[112:143], v[34:35], v[32:33], 0
ds_read_b64 v[34:35], v13 offset:15360
s_add_u32 m0, s1, 4096
s_nop 0
buffer_load_dwordx4 v198, s[8:11], 0 offen lds
v_cvt_pk_bf16_f32 v83, v86, v87
v_exp_f32 v88, v88
v_exp_f32 v89, v89
v_exp_f32 v90, v90
v_exp_f32 v91, v91
v_cvt_pk_bf16_f32 v88, v88, v89
v_exp_f32 v92, v92
v_exp_f32 v93, v93
v_mfma_f32_32x32x16_bf16 v[144:159], v[40:43], v[80:83], v[144:159]
v_cvt_pk_bf16_f32 v89, v90, v91
v_exp_f32 v94, v94
v_exp_f32 v95, v95
v_cvt_pk_bf16_f32 v90, v92, v93
v_cvt_pk_bf16_f32 v91, v94, v95
v_exp_f32 v96, v96
v_exp_f32 v97, v97
v_exp_f32 v98, v98
v_mfma_f32_32x32x16_bf16 v[144:159], v[44:47], v[88:91], v[144:159]
v_exp_f32 v99, v99
v_cvt_pk_bf16_f32 v96, v96, v97
v_exp_f32 v100, v100
v_exp_f32 v101, v101
v_cvt_pk_bf16_f32 v97, v98, v99
v_mfma_f32_32x32x16_bf16 v[112:127], v[36:39], v[24:27], v[112:127]
v_exp_f32 v102, v102
v_exp_f32 v103, v103
v_cvt_pk_bf16_f32 v98, v100, v101
v_cvt_pk_bf16_f32 v99, v102, v103
v_exp_f32 v104, v104
v_exp_f32 v105, v105
v_exp_f32 v106, v106
v_mfma_f32_32x32x16_bf16 v[160:175], v[40:43], v[96:99], v[160:175]
ds_read_b128 v[40:43], v14 offset:15360
v_exp_f32 v107, v107
v_cvt_pk_bf16_f32 v104, v104, v105
v_exp_f32 v108, v108
v_exp_f32 v109, v109
v_cvt_pk_bf16_f32 v105, v106, v107
v_mfma_f32_32x32x16_bf16 v[128:143], v[36:39], v[28:31], v[128:143]
ds_read_b128 v[36:39], v12 offset:15360
v_exp_f32 v110, v110
v_exp_f32 v111, v111
v_cvt_pk_bf16_f32 v106, v108, v109
v_cvt_pk_bf16_f32 v107, v110, v111
v_exp_f32 v112, v112
v_exp_f32 v113, v113
v_exp_f32 v114, v114
v_mfma_f32_32x32x16_bf16 v[160:175], v[44:47], v[104:107], v[160:175]
ds_read_b128 v[44:47], v14 offset:16128
v_exp_f32 v115, v115
v_cvt_pk_bf16_f32 v112, v112, v113
v_exp_f32 v116, v116
v_exp_f32 v117, v117
v_cvt_pk_bf16_f32 v113, v114, v115
v_exp_f32 v118, v118
v_exp_f32 v119, v119
v_cvt_pk_bf16_f32 v114, v116, v117
s_waitcnt lgkmcnt(0)
v_mfma_f32_32x32x4_2b_bf16 v[80:111], v[34:35], v[32:33], 0
ds_read_b64 v[34:35], v13 offset:18432
v_cvt_pk_bf16_f32 v115, v118, v119
v_exp_f32 v120, v120
v_exp_f32 v121, v121
v_exp_f32 v122, v122
v_exp_f32 v123, v123
v_cvt_pk_bf16_f32 v120, v120, v121
v_exp_f32 v124, v124
v_exp_f32 v125, v125
v_mfma_f32_32x32x16_bf16 v[144:159], v[40:43], v[112:115], v[144:159]
v_cvt_pk_bf16_f32 v121, v122, v123
v_exp_f32 v126, v126
v_exp_f32 v127, v127
v_cvt_pk_bf16_f32 v122, v124, v125
v_cvt_pk_bf16_f32 v123, v126, v127
v_exp_f32 v128, v128
v_exp_f32 v129, v129
v_exp_f32 v130, v130
v_mfma_f32_32x32x16_bf16 v[144:159], v[44:47], v[120:123], v[144:159]
v_exp_f32 v131, v131
v_cvt_pk_bf16_f32 v128, v128, v129
v_exp_f32 v132, v132
v_exp_f32 v133, v133
v_cvt_pk_bf16_f32 v129, v130, v131
v_mfma_f32_32x32x16_bf16 v[80:95], v[36:39], v[24:27], v[80:95]
v_exp_f32 v134, v134
v_exp_f32 v135, v135
v_cvt_pk_bf16_f32 v130, v132, v133
v_cvt_pk_bf16_f32 v131, v134, v135
v_exp_f32 v136, v136
v_exp_f32 v137, v137
v_exp_f32 v138, v138
v_mfma_f32_32x32x16_bf16 v[160:175], v[40:43], v[128:131], v[160:175]
ds_read_b128 v[40:43], v14 offset:18432
v_exp_f32 v139, v139
v_cvt_pk_bf16_f32 v136, v136, v137
v_exp_f32 v140, v140
v_exp_f32 v141, v141
v_cvt_pk_bf16_f32 v137, v138, v139
v_mfma_f32_32x32x16_bf16 v[96:111], v[36:39], v[28:31], v[96:111]
ds_read_b128 v[36:39], v12 offset:18432
v_exp_f32 v142, v142
v_exp_f32 v143, v143
v_cvt_pk_bf16_f32 v138, v140, v141
v_cvt_pk_bf16_f32 v139, v142, v143
v_exp_f32 v80, v80
v_exp_f32 v81, v81
v_exp_f32 v82, v82
v_mfma_f32_32x32x16_bf16 v[160:175], v[44:47], v[136:139], v[160:175]
ds_read_b128 v[44:47], v14 offset:19200
v_exp_f32 v83, v83
v_cvt_pk_bf16_f32 v80, v80, v81
v_exp_f32 v84, v84
v_exp_f32 v85, v85
v_cvt_pk_bf16_f32 v81, v82, v83
v_exp_f32 v86, v86
v_exp_f32 v87, v87
v_cvt_pk_bf16_f32 v82, v84, v85
s_waitcnt lgkmcnt(0)
v_mfma_f32_32x32x4_2b_bf16 v[112:143], v[34:35], v[32:33], 0
ds_read_b64 v[34:35], v13 offset:21504
v_cvt_pk_bf16_f32 v83, v86, v87
v_exp_f32 v88, v88
v_exp_f32 v89, v89
v_exp_f32 v90, v90
v_exp_f32 v91, v91
v_cvt_pk_bf16_f32 v88, v88, v89
v_exp_f32 v92, v92
v_exp_f32 v93, v93
v_mfma_f32_32x32x16_bf16 v[144:159], v[40:43], v[80:83], v[144:159]
v_cvt_pk_bf16_f32 v89, v90, v91
v_exp_f32 v94, v94
v_exp_f32 v95, v95
v_cvt_pk_bf16_f32 v90, v92, v93
v_cvt_pk_bf16_f32 v91, v94, v95
v_exp_f32 v96, v96
v_exp_f32 v97, v97
v_exp_f32 v98, v98
v_mfma_f32_32x32x16_bf16 v[144:159], v[44:47], v[88:91], v[144:159]
v_exp_f32 v99, v99
v_cvt_pk_bf16_f32 v96, v96, v97
v_exp_f32 v100, v100
v_exp_f32 v101, v101
v_cvt_pk_bf16_f32 v97, v98, v99
v_mfma_f32_32x32x16_bf16 v[112:127], v[36:39], v[24:27], v[112:127]
v_exp_f32 v102, v102
v_exp_f32 v103, v103
v_cvt_pk_bf16_f32 v98, v100, v101
v_cvt_pk_bf16_f32 v99, v102, v103
v_exp_f32 v104, v104
v_exp_f32 v105, v105
v_exp_f32 v106, v106
v_mfma_f32_32x32x16_bf16 v[160:175], v[40:43], v[96:99], v[160:175]
ds_read_b128 v[40:43], v14 offset:21504
v_exp_f32 v107, v107
v_cvt_pk_bf16_f32 v104, v104, v105
v_exp_f32 v108, v108
v_exp_f32 v109, v109
v_cvt_pk_bf16_f32 v105, v106, v107
v_mfma_f32_32x32x16_bf16 v[128:143], v[36:39], v[28:31], v[128:143]
ds_read_b128 v[36:39], v12 offset:21504
v_exp_f32 v110, v110
v_exp_f32 v111, v111
v_cvt_pk_bf16_f32 v106, v108, v109
v_cvt_pk_bf16_f32 v107, v110, v111
v_exp_f32 v112, v112
v_exp_f32 v113, v113
v_exp_f32 v114, v114
v_mfma_f32_32x32x16_bf16 v[160:175], v[44:47], v[104:107], v[160:175]
ds_read_b128 v[44:47], v14 offset:22272
v_exp_f32 v115, v115
v_cvt_pk_bf16_f32 v112, v112, v113
v_exp_f32 v116, v116
v_exp_f32 v117, v117
v_cvt_pk_bf16_f32 v113, v114, v115
v_exp_f32 v118, v118
v_exp_f32 v119, v119
v_cvt_pk_bf16_f32 v114, v116, v117
s_waitcnt vmcnt(1) lgkmcnt(0)
s_barrier
v_mfma_f32_32x32x4_2b_bf16 v[80:111], v[34:35], v[32:33], 0
ds_read_b64 v[34:35], v13 offset:0
s_waitcnt vmcnt(0)
s_cmp_ge_u32 s21, 960
s_cbranch_scc1 L_jr_b
ds_read_b64_tr_b16 v[212:213], v50 offset:0
ds_read_b64_tr_b16 v[214:215], v50 offset:512
ds_read_b64_tr_b16 v[216:217], v50 offset:32
ds_read_b64_tr_b16 v[218:219], v50 offset:544
ds_read_b64_tr_b16 v[220:221], v50 offset:64
ds_read_b64_tr_b16 v[222:223], v50 offset:576
ds_read_b64_tr_b16 v[224:225], v50 offset:96
ds_read_b64_tr_b16 v[226:227], v50 offset:608
s_branch L_jr_e
L_jr_b:
s_cmp_ge_u32 s21, 1504
s_cbranch_scc1 L_jr_e
ds_read_b64_tr_b16 v[212:213], v50 offset:0
ds_read_b64_tr_b16 v[214:215], v50 offset:640
ds_read_b64_tr_b16 v[216:217], v50 offset:8
ds_read_b64_tr_b16 v[218:219], v50 offset:648
ds_read_b64_tr_b16 v[220:221], v50 offset:64
ds_read_b64_tr_b16 v[222:223], v50 offset:704
ds_read_b64_tr_b16 v[224:225], v50 offset:72
ds_read_b64_tr_b16 v[226:227], v50 offset:712
ds_read_b64_tr_b16 v[228:229], v51 offset:128
ds_read_b64_tr_b16 v[230:231], v51 offset:768
L_jr_e:
s_add_u32 m0, s33, 12288
s_nop 0
buffer_load_dwordx4 v6, s[4:7], s32 offen offset:0 sc1 lds
v_cvt_pk_bf16_f32 v115, v118, v119
v_exp_f32 v120, v120
v_exp_f32 v121, v121
v_exp_f32 v122, v122
v_exp_f32 v123, v123
v_cvt_pk_bf16_f32 v120, v120, v121
v_exp_f32 v124, v124
v_exp_f32 v125, v125
v_mfma_f32_32x32x16_bf16 v[144:159], v[40:43], v[112:115], v[144:159]
s_add_u32 m0, s33, 12288
s_nop 0
buffer_load_dwordx4 v6, s[4:7], s32 offen offset:1024 sc1 lds
v_cvt_pk_bf16_f32 v121, v122, v123
v_exp_f32 v126, v126
v_exp_f32 v127, v127
v_cvt_pk_bf16_f32 v122, v124, v125
v_cvt_pk_bf16_f32 v123, v126, v127
v_exp_f32 v128, v128
v_exp_f32 v129, v129
v_exp_f32 v130, v130
v_mfma_f32_32x32x16_bf16 v[144:159], v[44:47], v[120:123], v[144:159]
s_add_u32 m0, s33, 12288
s_sub_u32 s24, s32, s0
buffer_load_dwordx4 v15, s[4:7], s24 offen offset:2048 sc1 lds
s_add_u32 s32, s32, 12288
v_exp_f32 v131, v131
v_cvt_pk_bf16_f32 v128, v128, v129
v_exp_f32 v132, v132
v_exp_f32 v133, v133
v_cvt_pk_bf16_f32 v129, v130, v131
v_mfma_f32_32x32x16_bf16 v[80:95], v[36:39], v[24:27], v[80:95]
v_exp_f32 v134, v134
v_exp_f32 v135, v135
v_cvt_pk_bf16_f32 v130, v132, v133
v_cvt_pk_bf16_f32 v131, v134, v135
v_exp_f32 v136, v136
v_exp_f32 v137, v137
v_exp_f32 v138, v138
v_mfma_f32_32x32x16_bf16 v[160:175], v[40:43], v[128:131], v[160:175]
ds_read_b128 v[40:43], v14 offset:0
v_exp_f32 v139, v139
v_cvt_pk_bf16_f32 v136, v136, v137
v_exp_f32 v140, v140
v_exp_f32 v141, v141
v_cvt_pk_bf16_f32 v137, v138, v139
v_mfma_f32_32x32x16_bf16 v[96:111], v[36:39], v[28:31], v[96:111]
ds_read_b128 v[36:39], v12 offset:0
v_exp_f32 v142, v142
v_exp_f32 v143, v143
v_cvt_pk_bf16_f32 v138, v140, v141
v_cvt_pk_bf16_f32 v139, v142, v143
v_exp_f32 v80, v80
v_exp_f32 v81, v81
v_exp_f32 v82, v82
v_mfma_f32_32x32x16_bf16 v[160:175], v[44:47], v[136:139], v[160:175]
ds_read_b128 v[44:47], v14 offset:768
v_exp_f32 v83, v83
v_cvt_pk_bf16_f32 v80, v80, v81
v_exp_f32 v84, v84
v_exp_f32 v85, v85
v_cvt_pk_bf16_f32 v81, v82, v83
v_exp_f32 v86, v86
v_exp_f32 v87, v87
v_cvt_pk_bf16_f32 v82, v84, v85
s_waitcnt lgkmcnt(0)
v_mfma_f32_32x32x4_2b_bf16 v[112:143], v[34:35], v[32:33], 0
ds_read_b64 v[34:35], v13 offset:3072
buffer_store_dwordx4 v[212:215], v6, s[4:7], s12 offen sc1
v_cvt_pk_bf16_f32 v83, v86, v87
v_exp_f32 v88, v88
v_exp_f32 v89, v89
v_exp_f32 v90, v90
v_exp_f32 v91, v91
v_cvt_pk_bf16_f32 v88, v88, v89
v_exp_f32 v92, v92
v_exp_f32 v93, v93
v_mfma_f32_32x32x16_bf16 v[144:159], v[40:43], v[80:83], v[144:159]
buffer_store_dwordx4 v[216:219], v6, s[4:7], s13 offen sc1
v_cvt_pk_bf16_f32 v89, v90, v91
v_exp_f32 v94, v94
v_exp_f32 v95, v95
v_cvt_pk_bf16_f32 v90, v92, v93
v_cvt_pk_bf16_f32 v91, v94, v95
v_exp_f32 v96, v96
v_exp_f32 v97, v97
v_exp_f32 v98, v98
v_mfma_f32_32x32x16_bf16 v[144:159], v[44:47], v[88:91], v[144:159]
buffer_store_dwordx4 v[220:223], v6, s[4:7], s14 offen sc1
v_exp_f32 v99, v99
v_cvt_pk_bf16_f32 v96, v96, v97
v_exp_f32 v100, v100
v_exp_f32 v101, v101
v_cvt_pk_bf16_f32 v97, v98, v99
v_mfma_f32_32x32x16_bf16 v[112:127], v[36:39], v[24:27], v[112:127]
buffer_store_dwordx4 v[224:227], v6, s[4:7], s15 offen sc1
v_exp_f32 v102, v102
v_exp_f32 v103, v103
v_cvt_pk_bf16_f32 v98, v100, v101
v_cvt_pk_bf16_f32 v99, v102, v103
v_exp_f32 v104, v104
v_exp_f32 v105, v105
v_exp_f32 v106, v106
v_mfma_f32_32x32x16_bf16 v[160:175], v[40:43], v[96:99], v[160:175]
ds_read_b128 v[40:43], v14 offset:3072
v_exp_f32 v107, v107
v_cvt_pk_bf16_f32 v104, v104, v105
v_exp_f32 v108, v108
v_exp_f32 v109, v109
v_cvt_pk_bf16_f32 v105, v106, v107
v_mfma_f32_32x32x16_bf16 v[128:143], v[36:39], v[28:31], v[128:143]
ds_read_b128 v[36:39], v12 offset:3072
buffer_store_dwordx4 v[228:231], v6, s[4:7], s46 offen sc1
v_exp_f32 v110, v110
v_exp_f32 v111, v111
v_cvt_pk_bf16_f32 v106, v108, v109
v_cvt_pk_bf16_f32 v107, v110, v111
v_exp_f32 v112, v112
v_exp_f32 v113, v113
v_exp_f32 v114, v114
v_mfma_f32_32x32x16_bf16 v[160:175], v[44:47], v[104:107], v[160:175]
ds_read_b128 v[44:47], v14 offset:3840
v_exp_f32 v115, v115
v_cvt_pk_bf16_f32 v112, v112, v113
v_exp_f32 v116, v116
v_exp_f32 v117, v117
v_cvt_pk_bf16_f32 v113, v114, v115
v_exp_f32 v118, v118
v_exp_f32 v119, v119
v_cvt_pk_bf16_f32 v114, v116, v117
s_waitcnt lgkmcnt(0)
v_mfma_f32_32x32x4_2b_bf16 v[80:111], v[34:35], v[32:33], 0
ds_read_b64 v[34:35], v13 offset:6144
v_cvt_pk_bf16_f32 v115, v118, v119
v_exp_f32 v120, v120
v_exp_f32 v121, v121
v_exp_f32 v122, v122
v_exp_f32 v123, v123
v_cvt_pk_bf16_f32 v120, v120, v121
v_exp_f32 v124, v124
v_exp_f32 v125, v125
v_mfma_f32_32x32x16_bf16 v[144:159], v[40:43], v[112:115], v[144:159]
v_cvt_pk_bf16_f32 v121, v122, v123
v_exp_f32 v126, v126
v_exp_f32 v127, v127
v_cvt_pk_bf16_f32 v122, v124, v125
v_cvt_pk_bf16_f32 v123, v126, v127
v_exp_f32 v128, v128
v_exp_f32 v129, v129
v_exp_f32 v130, v130
v_mfma_f32_32x32x16_bf16 v[144:159], v[44:47], v[120:123], v[144:159]
v_exp_f32 v131, v131
v_cvt_pk_bf16_f32 v128, v128, v129
v_exp_f32 v132, v132
v_exp_f32 v133, v133
v_cvt_pk_bf16_f32 v129, v130, v131
v_mfma_f32_32x32x16_bf16 v[80:95], v[36:39], v[24:27], v[80:95]
v_exp_f32 v134, v134
v_exp_f32 v135, v135
v_cvt_pk_bf16_f32 v130, v132, v133
v_cvt_pk_bf16_f32 v131, v134, v135
v_exp_f32 v136, v136
v_exp_f32 v137, v137
v_exp_f32 v138, v138
v_mfma_f32_32x32x16_bf16 v[160:175], v[40:43], v[128:131], v[160:175]
ds_read_b128 v[40:43], v14 offset:6144
v_exp_f32 v139, v139
v_cvt_pk_bf16_f32 v136, v136, v137
v_exp_f32 v140, v140
v_exp_f32 v141, v141
v_cvt_pk_bf16_f32 v137, v138, v139
v_mfma_f32_32x32x16_bf16 v[96:111], v[36:39], v[28:31], v[96:111]
ds_read_b128 v[36:39], v12 offset:6144
v_exp_f32 v142, v142
v_exp_f32 v143, v143
v_cvt_pk_bf16_f32 v138, v140, v141
v_cvt_pk_bf16_f32 v139, v142, v143
v_exp_f32 v80, v80
v_exp_f32 v81, v81
v_exp_f32 v82, v82
v_mfma_f32_32x32x16_bf16 v[160:175], v[44:47], v[136:139], v[160:175]
ds_read_b128 v[44:47], v14 offset:6912
v_exp_f32 v83, v83
v_cvt_pk_bf16_f32 v80, v80, v81
v_exp_f32 v84, v84
v_exp_f32 v85, v85
v_cvt_pk_bf16_f32 v81, v82, v83
v_exp_f32 v86, v86
v_exp_f32 v87, v87
v_cvt_pk_bf16_f32 v82, v84, v85
s_waitcnt lgkmcnt(0)
v_mfma_f32_32x32x4_2b_bf16 v[112:143], v[34:35], v[32:33], 0
ds_read_b64 v[34:35], v13 offset:9216
v_cvt_pk_bf16_f32 v83, v86, v87
v_exp_f32 v88, v88
v_exp_f32 v89, v89
v_exp_f32 v90, v90
v_exp_f32 v91, v91
v_cvt_pk_bf16_f32 v88, v88, v89
v_exp_f32 v92, v92
v_exp_f32 v93, v93
v_mfma_f32_32x32x16_bf16 v[144:159], v[40:43], v[80:83], v[144:159]
v_cvt_pk_bf16_f32 v89, v90, v91
v_exp_f32 v94, v94
v_exp_f32 v95, v95
v_cvt_pk_bf16_f32 v90, v92, v93
v_cvt_pk_bf16_f32 v91, v94, v95
v_exp_f32 v96, v96
v_exp_f32 v97, v97
v_exp_f32 v98, v98
v_mfma_f32_32x32x16_bf16 v[144:159], v[44:47], v[88:91], v[144:159]
v_exp_f32 v99, v99
v_cvt_pk_bf16_f32 v96, v96, v97
v_exp_f32 v100, v100
v_exp_f32 v101, v101
v_cvt_pk_bf16_f32 v97, v98, v99
v_mfma_f32_32x32x16_bf16 v[112:127], v[36:39], v[24:27], v[112:127]
v_exp_f32 v102, v102
v_exp_f32 v103, v103
v_cvt_pk_bf16_f32 v98, v100, v101
v_cvt_pk_bf16_f32 v99, v102, v103
v_exp_f32 v104, v104
v_exp_f32 v105, v105
v_exp_f32 v106, v106
v_mfma_f32_32x32x16_bf16 v[160:175], v[40:43], v[96:99], v[160:175]
ds_read_b128 v[40:43], v14 offset:9216
v_exp_f32 v107, v107
v_cvt_pk_bf16_f32 v104, v104, v105
v_exp_f32 v108, v108
v_exp_f32 v109, v109
v_cvt_pk_bf16_f32 v105, v106, v107
v_mfma_f32_32x32x16_bf16 v[128:143], v[36:39], v[28:31], v[128:143]
ds_read_b128 v[36:39], v12 offset:9216
v_exp_f32 v110, v110
v_exp_f32 v111, v111
v_cvt_pk_bf16_f32 v106, v108, v109
v_cvt_pk_bf16_f32 v107, v110, v111
v_exp_f32 v112, v112
v_exp_f32 v113, v113
v_exp_f32 v114, v114
v_mfma_f32_32x32x16_bf16 v[160:175], v[44:47], v[104:107], v[160:175]
ds_read_b128 v[44:47], v14 offset:9984
v_exp_f32 v115, v115
v_cvt_pk_bf16_f32 v112, v112, v113
v_exp_f32 v116, v116
v_exp_f32 v117, v117
v_cvt_pk_bf16_f32 v113, v114, v115
v_exp_f32 v118, v118
v_exp_f32 v119, v119
v_cvt_pk_bf16_f32 v114, v116, v117
s_waitcnt vmcnt(0) lgkmcnt(0)
s_barrier
v_mfma_f32_32x32x4_2b_bf16 v[80:111], v[34:35], v[32:33], 0
ds_read_b64 v[34:35], v13 offset:12288
s_cmp_lg_u32 s16, 7
s_cbranch_scc1 L_at_nofj
s_lshl_b32 s24, s2, 6
s_add_u32 s24, s24, 28114944
v_mov_b32 v1, s17
v_lshlrev_b32 v2, 2, v0
s_mov_b64 exec, 0xffff
buffer_store_dword v1, v2, s[4:7], s24 offen sc1
s_mov_b64 exec, -1
v_lshlrev_b32 v10, 6, v0
L_at_nofj:
s_lshr_b32 s24, s19, 2
s_mul_i32 s65, s24, 102400
s_lshl_b32 s25, s16, 10
s_add_u32 s65, s65, s25
s_add_u32 s65, s65, 20971520
s_mul_i32 s3, s19, 122880
s_add_u32 s3, s3, s25
s_add_u32 s3, s3, 21790720
s_add_u32 s39, s25, 61440
s_add_u32 m0, s33, 0
s_nop 0
buffer_load_dwordx4 v6, s[4:7], s32 offen offset:0 sc1 lds
v_cvt_pk_bf16_f32 v115, v118, v119
v_exp_f32 v120, v120
v_exp_f32 v121, v121
v_exp_f32 v122, v122
v_exp_f32 v123, v123
v_cvt_pk_bf16_f32 v120, v120, v121
v_exp_f32 v124, v124
v_exp_f32 v125, v125
v_mfma_f32_32x32x16_bf16 v[144:159], v[40:43], v[112:115], v[144:159]
s_add_u32 m0, s33, 0
s_nop 0
buffer_load_dwordx4 v6, s[4:7], s32 offen offset:1024 sc1 lds
v_cvt_pk_bf16_f32 v121, v122, v123
v_exp_f32 v126, v126
v_exp_f32 v127, v127
v_cvt_pk_bf16_f32 v122, v124, v125
v_cvt_pk_bf16_f32 v123, v126, v127
v_exp_f32 v128, v128
v_exp_f32 v129, v129
v_exp_f32 v130, v130
v_mfma_f32_32x32x16_bf16 v[144:159], v[44:47], v[120:123], v[144:159]
s_add_u32 m0, s33, 0
s_sub_u32 s24, s32, s0
buffer_load_dwordx4 v15, s[4:7], s24 offen offset:2048 sc1 lds
s_add_u32 s32, s32, 12288
v_exp_f32 v131, v131
v_cvt_pk_bf16_f32 v128, v128, v129
v_exp_f32 v132, v132
v_exp_f32 v133, v133
v_cvt_pk_bf16_f32 v129, v130, v131
v_mfma_f32_32x32x16_bf16 v[80:95], v[36:39], v[24:27], v[80:95]
v_exp_f32 v134, v134
v_exp_f32 v135, v135
v_cvt_pk_bf16_f32 v130, v132, v133
v_cvt_pk_bf16_f32 v131, v134, v135
v_exp_f32 v136, v136
v_exp_f32 v137, v137
v_exp_f32 v138, v138
v_mfma_f32_32x32x16_bf16 v[160:175], v[40:43], v[128:131], v[160:175]
ds_read_b128 v[40:43], v14 offset:12288
v_exp_f32 v139, v139
v_cvt_pk_bf16_f32 v136, v136, v137
v_exp_f32 v140, v140
v_exp_f32 v141, v141
v_cvt_pk_bf16_f32 v137, v138, v139
v_mfma_f32_32x32x16_bf16 v[96:111], v[36:39], v[28:31], v[96:111]
ds_read_b128 v[36:39], v12 offset:12288
v_exp_f32 v142, v142
v_exp_f32 v143, v143
v_cvt_pk_bf16_f32 v138, v140, v141
v_cvt_pk_bf16_f32 v139, v142, v143
v_exp_f32 v80, v80
v_exp_f32 v81, v81
v_exp_f32 v82, v82
v_mfma_f32_32x32x16_bf16 v[160:175], v[44:47], v[136:139], v[160:175]
ds_read_b128 v[44:47], v14 offset:13056
v_exp_f32 v83, v83
v_cvt_pk_bf16_f32 v80, v80, v81
v_exp_f32 v84, v84
v_exp_f32 v85, v85
v_cvt_pk_bf16_f32 v81, v82, v83
v_exp_f32 v86, v86
v_exp_f32 v87, v87
v_cvt_pk_bf16_f32 v82, v84, v85
s_waitcnt lgkmcnt(0)
v_mfma_f32_32x32x4_2b_bf16 v[112:143], v[34:35], v[32:33], 0
ds_read_b64 v[34:35], v13 offset:15360
v_cvt_pk_bf16_f32 v83, v86, v87
v_exp_f32 v88, v88
v_exp_f32 v89, v89
v_exp_f32 v90, v90
v_exp_f32 v91, v91
v_cvt_pk_bf16_f32 v88, v88, v89
v_exp_f32 v92, v92
v_exp_f32 v93, v93
v_mfma_f32_32x32x16_bf16 v[144:159], v[40:43], v[80:83], v[144:159]
v_cvt_pk_bf16_f32 v89, v90, v91
v_exp_f32 v94, v94
v_exp_f32 v95, v95
v_cvt_pk_bf16_f32 v90, v92, v93
v_cvt_pk_bf16_f32 v91, v94, v95
v_exp_f32 v96, v96
v_exp_f32 v97, v97
v_exp_f32 v98, v98
v_mfma_f32_32x32x16_bf16 v[144:159], v[44:47], v[88:91], v[144:159]
v_exp_f32 v99, v99
v_cvt_pk_bf16_f32 v96, v96, v97
v_exp_f32 v100, v100
v_exp_f32 v101, v101
v_cvt_pk_bf16_f32 v97, v98, v99
v_mfma_f32_32x32x16_bf16 v[112:127], v[36:39], v[24:27], v[112:127]
v_exp_f32 v102, v102
v_exp_f32 v103, v103
v_cvt_pk_bf16_f32 v98, v100, v101
v_cvt_pk_bf16_f32 v99, v102, v103
v_exp_f32 v104, v104
v_exp_f32 v105, v105
v_exp_f32 v106, v106
v_mfma_f32_32x32x16_bf16 v[160:175], v[40:43], v[96:99], v[160:175]
ds_read_b128 v[40:43], v14 offset:15360
v_exp_f32 v107, v107
v_cvt_pk_bf16_f32 v104, v104, v105
v_exp_f32 v108, v108
v_exp_f32 v109, v109
v_cvt_pk_bf16_f32 v105, v106, v107
v_mfma_f32_32x32x16_bf16 v[128:143], v[36:39], v[28:31], v[128:143]
ds_read_b128 v[36:39], v12 offset:15360
v_exp_f32 v110, v110
v_exp_f32 v111, v111
v_cvt_pk_bf16_f32 v106, v108, v109
v_cvt_pk_bf16_f32 v107, v110, v111
v_exp_f32 v112, v112
v_exp_f32 v113, v113
v_exp_f32 v114, v114
v_mfma_f32_32x32x16_bf16 v[160:175], v[44:47], v[104:107], v[160:175]
ds_read_b128 v[44:47], v14 offset:16128
v_exp_f32 v115, v115
v_cvt_pk_bf16_f32 v112, v112, v113
v_exp_f32 v116, v116
v_exp_f32 v117, v117
v_cvt_pk_bf16_f32 v113, v114, v115
v_exp_f32 v118, v118
v_exp_f32 v119, v119
v_cvt_pk_bf16_f32 v114, v116, v117
s_waitcnt lgkmcnt(0)
v_mfma_f32_32x32x4_2b_bf16 v[80:111], v[34:35], v[32:33], 0
ds_read_b64 v[34:35], v13 offset:18432
s_cmp_lg_u32 s16, 7
s_cbranch_scc1 L_at_nofl
s_mov_b32 s25, 28114944
buffer_load_dword v176, v10, s[4:7], s25 offen sc1
s_mov_b32 s25, 28119040
buffer_load_dword v177, v10, s[4:7], s25 offen sc1
s_mov_b32 s25, 28123136
buffer_load_dword v178, v10, s[4:7], s25 offen sc1
s_mov_b32 s25, 28127232
buffer_load_dword v179, v10, s[4:7], s25 offen sc1
L_at_nofl:
v_cvt_pk_bf16_f32 v115, v118, v119
v_exp_f32 v120, v120
v_exp_f32 v121, v121
v_exp_f32 v122, v122
v_exp_f32 v123, v123
v_cvt_pk_bf16_f32 v120, v120, v121
v_exp_f32 v124, v124
v_exp_f32 v125, v125
v_mfma_f32_32x32x16_bf16 v[144:159], v[40:43], v[112:115], v[144:159]
v_cvt_pk_bf16_f32 v121, v122, v123
v_exp_f32 v126, v126
v_exp_f32 v127, v127
v_cvt_pk_bf16_f32 v122, v124, v125
v_cvt_pk_bf16_f32 v123, v126, v127
v_exp_f32 v128, v128
v_exp_f32 v129, v129
v_exp_f32 v130, v130
v_mfma_f32_32x32x16_bf16 v[144:159], v[44:47], v[120:123], v[144:159]
v_exp_f32 v131, v131
v_cvt_pk_bf16_f32 v128, v128, v129
v_exp_f32 v132, v132
v_exp_f32 v133, v133
v_cvt_pk_bf16_f32 v129, v130, v131
v_mfma_f32_32x32x16_bf16 v[80:95], v[36:39], v[24:27], v[80:95]
v_exp_f32 v134, v134
v_exp_f32 v135, v135
v_cvt_pk_bf16_f32 v130, v132, v133
v_cvt_pk_bf16_f32 v131, v134, v135
v_exp_f32 v136, v136
v_exp_f32 v137, v137
v_exp_f32 v138, v138
v_mfma_f32_32x32x16_bf16 v[160:175], v[40:43], v[128:131], v[160:175]
ds_read_b128 v[40:43], v14 offset:18432
v_exp_f32 v139, v139
v_cvt_pk_bf16_f32 v136, v136, v137
v_exp_f32 v140, v140
v_exp_f32 v141, v141
v_cvt_pk_bf16_f32 v137, v138, v139
v_mfma_f32_32x32x16_bf16 v[96:111], v[36:39], v[28:31], v[96:111]
ds_read_b128 v[36:39], v12 offset:18432
v_exp_f32 v142, v142
v_exp_f32 v143, v143
v_cvt_pk_bf16_f32 v138, v140, v141
v_cvt_pk_bf16_f32 v139, v142, v143
v_exp_f32 v80, v80
v_exp_f32 v81, v81
v_exp_f32 v82, v82
v_mfma_f32_32x32x16_bf16 v[160:175], v[44:47], v[136:139], v[160:175]
ds_read_b128 v[44:47], v14 offset:19200
v_exp_f32 v83, v83
v_cvt_pk_bf16_f32 v80, v80, v81
v_exp_f32 v84, v84
v_exp_f32 v85, v85
v_cvt_pk_bf16_f32 v81, v82, v83
v_exp_f32 v86, v86
v_exp_f32 v87, v87
v_cvt_pk_bf16_f32 v82, v84, v85
s_waitcnt lgkmcnt(0)
v_mfma_f32_32x32x4_2b_bf16 v[112:143], v[34:35], v[32:33], 0
ds_read_b64 v[34:35], v13 offset:21504
v_cvt_pk_bf16_f32 v83, v86, v87
v_exp_f32 v88, v88
v_exp_f32 v89, v89
v_exp_f32 v90, v90
v_exp_f32 v91, v91
v_cvt_pk_bf16_f32 v88, v88, v89
v_exp_f32 v92, v92
v_exp_f32 v93, v93
v_mfma_f32_32x32x16_bf16 v[144:159], v[40:43], v[80:83], v[144:159]
v_cvt_pk_bf16_f32 v89, v90, v91
v_exp_f32 v94, v94
v_exp_f32 v95, v95
v_cvt_pk_bf16_f32 v90, v92, v93
v_cvt_pk_bf16_f32 v91, v94, v95
v_exp_f32 v96, v96
v_exp_f32 v97, v97
v_exp_f32 v98, v98
v_mfma_f32_32x32x16_bf16 v[144:159], v[44:47], v[88:91], v[144:159]
v_exp_f32 v99, v99
v_cvt_pk_bf16_f32 v96, v96, v97
v_exp_f32 v100, v100
v_exp_f32 v101, v101
v_cvt_pk_bf16_f32 v97, v98, v99
v_mfma_f32_32x32x16_bf16 v[112:127], v[36:39], v[24:27], v[112:127]
v_exp_f32 v102, v102
v_exp_f32 v103, v103
v_cvt_pk_bf16_f32 v98, v100, v101
v_cvt_pk_bf16_f32 v99, v102, v103
v_exp_f32 v104, v104
v_exp_f32 v105, v105
v_exp_f32 v106, v106
v_mfma_f32_32x32x16_bf16 v[160:175], v[40:43], v[96:99], v[160:175]
ds_read_b128 v[40:43], v14 offset:21504
v_exp_f32 v107, v107
v_cvt_pk_bf16_f32 v104, v104, v105
v_exp_f32 v108, v108
v_exp_f32 v109, v109
v_cvt_pk_bf16_f32 v105, v106, v107
v_mfma_f32_32x32x16_bf16 v[128:143], v[36:39], v[28:31], v[128:143]
ds_read_b128 v[36:39], v12 offset:21504
v_exp_f32 v110, v110
v_exp_f32 v111, v111
v_cvt_pk_bf16_f32 v106, v108, v109
v_cvt_pk_bf16_f32 v107, v110, v111
v_exp_f32 v112, v112
v_exp_f32 v113, v113
v_exp_f32 v114, v114
v_mfma_f32_32x32x16_bf16 v[160:175], v[44:47], v[104:107], v[160:175]
ds_read_b128 v[44:47], v14 offset:22272
v_exp_f32 v115, v115
v_cvt_pk_bf16_f32 v112, v112, v113
v_exp_f32 v116, v116
v_exp_f32 v117, v117
v_cvt_pk_bf16_f32 v113, v114, v115
v_exp_f32 v118, v118
v_exp_f32 v119, v119
v_cvt_pk_bf16_f32 v114, v116, v117
s_waitcnt vmcnt(0) lgkmcnt(0)
s_cmp_lg_u32 s16, 7
s_cbranch_scc1 L_at_nofc
s_movk_i32 s24, 20000
L_at_fj:
s_waitcnt vmcnt(0)
v_xor_b32 v1, s17, v176
v_xor_b32 v2, s17, v177
v_xor_b32 v3, s17, v178
v_xor_b32 v4, s17, v179
v_or3_b32 v1, v1, v2, v3
v_or_b32 v1, v1, v4
v_cmp_ne_u32 vcc, 0, v1
s_cbranch_vccz L_at_fjok
s_sub_u32 s24, s24, 1
s_cbranch_scc1 L_at_fjok
s_mov_b32 s25, 28114944
buffer_load_dword v176, v10, s[4:7], s25 offen sc1
s_mov_b32 s25, 28119040
buffer_load_dword v177, v10, s[4:7], s25 offen sc1
s_mov_b32 s25, 28123136
buffer_load_dword v178, v10, s[4:7], s25 offen sc1
s_mov_b32 s25, 28127232
buffer_load_dword v179, v10, s[4:7], s25 offen sc1
s_branch L_at_fj
L_at_fjok:
L_at_nofc:
s_barrier
v_mfma_f32_32x32x4_2b_bf16 v[80:111], v[34:35], v[32:33], 0
ds_read_b64 v[34:35], v13 offset:0
s_add_u32 m0, s33, 12288
s_nop 0
buffer_load_dwordx4 v6, s[4:7], s32 offen offset:0 sc1 lds
v_cvt_pk_bf16_f32 v115, v118, v119
v_exp_f32 v120, v120
v_exp_f32 v121, v121
v_exp_f32 v122, v122
v_exp_f32 v123, v123
v_cvt_pk_bf16_f32 v120, v120, v121
v_exp_f32 v124, v124
v_exp_f32 v125, v125
v_mfma_f32_32x32x16_bf16 v[144:159], v[40:43], v[112:115], v[144:159]
s_add_u32 m0, s33, 12288
s_nop 0
buffer_load_dwordx4 v6, s[4:7], s32 offen offset:1024 sc1 lds
v_cvt_pk_bf16_f32 v121, v122, v123
v_exp_f32 v126, v126
v_exp_f32 v127, v127
v_cvt_pk_bf16_f32 v122, v124, v125
v_cvt_pk_bf16_f32 v123, v126, v127
v_exp_f32 v128, v128
v_exp_f32 v129, v129
v_exp_f32 v130, v130
v_mfma_f32_32x32x16_bf16 v[144:159], v[44:47], v[120:123], v[144:159]
s_add_u32 m0, s33, 12288
s_sub_u32 s24, s32, s0
buffer_load_dwordx4 v15, s[4:7], s24 offen offset:2048 sc1 lds
s_add_u32 s32, s32, 12288
v_exp_f32 v131, v131
v_cvt_pk_bf16_f32 v128, v128, v129
v_exp_f32 v132, v132
v_exp_f32 v133, v133
v_cvt_pk_bf16_f32 v129, v130, v131
v_mfma_f32_32x32x16_bf16 v[80:95], v[36:39], v[24:27], v[80:95]
v_exp_f32 v134, v134
v_exp_f32 v135, v135
v_cvt_pk_bf16_f32 v130, v132, v133
v_cvt_pk_bf16_f32 v131, v134, v135
v_exp_f32 v136, v136
v_exp_f32 v137, v137
v_exp_f32 v138, v138
v_mfma_f32_32x32x16_bf16 v[160:175], v[40:43], v[128:131], v[160:175]
ds_read_b128 v[40:43], v14 offset:0
v_exp_f32 v139, v139
v_cvt_pk_bf16_f32 v136, v136, v137
v_exp_f32 v140, v140
v_exp_f32 v141, v141
v_cvt_pk_bf16_f32 v137, v138, v139
v_mfma_f32_32x32x16_bf16 v[96:111], v[36:39], v[28:31], v[96:111]
ds_read_b128 v[36:39], v12 offset:0
v_exp_f32 v142, v142
v_exp_f32 v143, v143
v_cvt_pk_bf16_f32 v138, v140, v141
v_cvt_pk_bf16_f32 v139, v142, v143
v_exp_f32 v80, v80
v_exp_f32 v81, v81
v_exp_f32 v82, v82
v_mfma_f32_32x32x16_bf16 v[160:175], v[44:47], v[136:139], v[160:175]
ds_read_b128 v[44:47], v14 offset:768
v_exp_f32 v83, v83
v_cvt_pk_bf16_f32 v80, v80, v81
v_exp_f32 v84, v84
v_exp_f32 v85, v85
v_cvt_pk_bf16_f32 v81, v82, v83
v_exp_f32 v86, v86
v_exp_f32 v87, v87
v_cvt_pk_bf16_f32 v82, v84, v85
s_waitcnt lgkmcnt(0)
v_mfma_f32_32x32x4_2b_bf16 v[112:143], v[34:35], v[32:33], 0
ds_read_b64 v[34:35], v13 offset:3072
s_add_u32 m0, s39, 0
s_nop 0
buffer_load_dwordx4 v6, s[4:7], s65 offen sc1 lds
s_add_u32 s65, s65, 8192
v_cvt_pk_bf16_f32 v83, v86, v87
v_exp_f32 v88, v88
v_exp_f32 v89, v89
v_exp_f32 v90, v90
v_exp_f32 v91, v91
v_cvt_pk_bf16_f32 v88, v88, v89
v_exp_f32 v92, v92
v_exp_f32 v93, v93
v_mfma_f32_32x32x16_bf16 v[144:159], v[40:43], v[80:83], v[144:159]
s_add_u32 m0, s39, 8192
s_nop 0
buffer_load_dwordx4 v6, s[4:7], s65 offen sc1 lds
s_add_u32 s65, s65, 8192
v_cvt_pk_bf16_f32 v89, v90, v91
v_exp_f32 v94, v94
v_exp_f32 v95, v95
v_cvt_pk_bf16_f32 v90, v92, v93
v_cvt_pk_bf16_f32 v91, v94, v95
v_exp_f32 v96, v96
v_exp_f32 v97, v97
v_exp_f32 v98, v98
v_mfma_f32_32x32x16_bf16 v[144:159], v[44:47], v[88:91], v[144:159]
v_exp_f32 v99, v99
v_cvt_pk_bf16_f32 v96, v96, v97
v_exp_f32 v100, v100
v_exp_f32 v101, v101
v_cvt_pk_bf16_f32 v97, v98, v99
v_mfma_f32_32x32x16_bf16 v[112:127], v[36:39], v[24:27], v[112:127]
v_exp_f32 v102, v102
v_exp_f32 v103, v103
v_cvt_pk_bf16_f32 v98, v100, v101
v_cvt_pk_bf16_f32 v99, v102, v103
v_exp_f32 v104, v104
v_exp_f32 v105, v105
v_exp_f32 v106, v106
v_mfma_f32_32x32x16_bf16 v[160:175], v[40:43], v[96:99], v[160:175]
ds_read_b128 v[40:43], v14 offset:3072
v_exp_f32 v107, v107
v_cvt_pk_bf16_f32 v104, v104, v105
v_exp_f32 v108, v108
v_exp_f32 v109, v109
v_cvt_pk_bf16_f32 v105, v106, v107
v_mfma_f32_32x32x16_bf16 v[128:143], v[36:39], v[28:31], v[128:143]
ds_read_b128 v[36:39], v12 offset:3072
v_exp_f32 v110, v110
v_exp_f32 v111, v111
v_cvt_pk_bf16_f32 v106, v108, v109
v_cvt_pk_bf16_f32 v107, v110, v111
v_exp_f32 v112, v112
v_exp_f32 v113, v113
v_exp_f32 v114, v114
v_mfma_f32_32x32x16_bf16 v[160:175], v[44:47], v[104:107], v[160:175]
ds_read_b128 v[44:47], v14 offset:3840
v_exp_f32 v115, v115
v_cvt_pk_bf16_f32 v112, v112, v113
v_exp_f32 v116, v116
v_exp_f32 v117, v117
v_cvt_pk_bf16_f32 v113, v114, v115
v_exp_f32 v118, v118
v_exp_f32 v119, v119
v_cvt_pk_bf16_f32 v114, v116, v117
s_waitcnt lgkmcnt(0)
v_mfma_f32_32x32x4_2b_bf16 v[80:111], v[34:35], v[32:33], 0
ds_read_b64 v[34:35], v13 offset:6144
s_add_u32 m0, s39, 16384
s_nop 0
buffer_load_dwordx4 v6, s[4:7], s65 offen sc1 lds
s_add_u32 s65, s65, 8192
v_cvt_pk_bf16_f32 v115, v118, v119
v_exp_f32 v120, v120
v_exp_f32 v121, v121
v_exp_f32 v122, v122
v_exp_f32 v123, v123
v_cvt_pk_bf16_f32 v120, v120, v121
v_exp_f32 v124, v124
v_exp_f32 v125, v125
v_mfma_f32_32x32x16_bf16 v[144:159], v[40:43], v[112:115], v[144:159]
s_add_u32 m0, s39, 24576
s_nop 0
buffer_load_dwordx4 v6, s[4:7], s65 offen sc1 lds
s_add_u32 s65, s65, 8192
v_cvt_pk_bf16_f32 v121, v122, v123
v_exp_f32 v126, v126
v_exp_f32 v127, v127
v_cvt_pk_bf16_f32 v122, v124, v125
v_cvt_pk_bf16_f32 v123, v126, v127
v_exp_f32 v128, v128
v_exp_f32 v129, v129
v_exp_f32 v130, v130
v_mfma_f32_32x32x16_bf16 v[144:159], v[44:47], v[120:123], v[144:159]
v_exp_f32 v131, v131
v_cvt_pk_bf16_f32 v128, v128, v129
v_exp_f32 v132, v132
v_exp_f32 v133, v133
v_cvt_pk_bf16_f32 v129, v130, v131
v_mfma_f32_32x32x16_bf16 v[80:95], v[36:39], v[24:27], v[80:95]
v_exp_f32 v134, v134
v_exp_f32 v135, v135
v_cvt_pk_bf16_f32 v130, v132, v133
v_cvt_pk_bf16_f32 v131, v134, v135
v_exp_f32 v136, v136
v_exp_f32 v137, v137
v_exp_f32 v138, v138
v_mfma_f32_32x32x16_bf16 v[160:175], v[40:43], v[128:131], v[160:175]
ds_read_b128 v[40:43], v14 offset:6144
v_exp_f32 v139, v139
v_cvt_pk_bf16_f32 v136, v136, v137
v_exp_f32 v140, v140
v_exp_f32 v141, v141
v_cvt_pk_bf16_f32 v137, v138, v139
v_mfma_f32_32x32x16_bf16 v[96:111], v[36:39], v[28:31], v[96:111]
ds_read_b128 v[36:39], v12 offset:6144
v_exp_f32 v142, v142
v_exp_f32 v143, v143
v_cvt_pk_bf16_f32 v138, v140, v141
v_cvt_pk_bf16_f32 v139, v142, v143
v_exp_f32 v80, v80
v_exp_f32 v81, v81
v_exp_f32 v82, v82
v_mfma_f32_32x32x16_bf16 v[160:175], v[44:47], v[136:139], v[160:175]
ds_read_b128 v[44:47], v14 offset:6912
v_exp_f32 v83, v83
v_cvt_pk_bf16_f32 v80, v80, v81
v_exp_f32 v84, v84
v_exp_f32 v85, v85
v_cvt_pk_bf16_f32 v81, v82, v83
v_exp_f32 v86, v86
v_exp_f32 v87, v87
v_cvt_pk_bf16_f32 v82, v84, v85
s_waitcnt lgkmcnt(0)
v_mfma_f32_32x32x4_2b_bf16 v[112:143], v[34:35], v[32:33], 0
ds_read_b64 v[34:35], v13 offset:9216
s_add_u32 m0, s39, 32768
s_nop 0
buffer_load_dwordx4 v6, s[4:7], s65 offen sc1 lds
s_add_u32 s65, s65, 8192
v_cvt_pk_bf16_f32 v83, v86, v87
v_exp_f32 v88, v88
v_exp_f32 v89, v89
v_exp_f32 v90, v90
v_exp_f32 v91, v91
v_cvt_pk_bf16_f32 v88, v88, v89
v_exp_f32 v92, v92
v_exp_f32 v93, v93
v_mfma_f32_32x32x16_bf16 v[144:159], v[40:43], v[80:83], v[144:159]
s_add_u32 m0, s39, 40960
s_nop 0
buffer_load_dwordx4 v6, s[4:7], s65 offen sc1 lds
s_add_u32 s65, s65, 8192
v_cvt_pk_bf16_f32 v89, v90, v91
v_exp_f32 v94, v94
v_exp_f32 v95, v95
v_cvt_pk_bf16_f32 v90, v92, v93
v_cvt_pk_bf16_f32 v91, v94, v95
v_exp_f32 v96, v96
v_exp_f32 v97, v97
v_exp_f32 v98, v98
v_mfma_f32_32x32x16_bf16 v[144:159], v[44:47], v[88:91], v[144:159]
v_exp_f32 v99, v99
v_cvt_pk_bf16_f32 v96, v96, v97
v_exp_f32 v100, v100
v_exp_f32 v101, v101
v_cvt_pk_bf16_f32 v97, v98, v99
v_mfma_f32_32x32x16_bf16 v[112:127], v[36:39], v[24:27], v[112:127]
v_exp_f32 v102, v102
v_exp_f32 v103, v103
v_cvt_pk_bf16_f32 v98, v100, v101
v_cvt_pk_bf16_f32 v99, v102, v103
v_exp_f32 v104, v104
v_exp_f32 v105, v105
v_exp_f32 v106, v106
v_mfma_f32_32x32x16_bf16 v[160:175], v[40:43], v[96:99], v[160:175]
ds_read_b128 v[40:43], v14 offset:9216
v_exp_f32 v107, v107
v_cvt_pk_bf16_f32 v104, v104, v105
v_exp_f32 v108, v108
v_exp_f32 v109, v109
v_cvt_pk_bf16_f32 v105, v106, v107
v_mfma_f32_32x32x16_bf16 v[128:143], v[36:39], v[28:31], v[128:143]
ds_read_b128 v[36:39], v12 offset:9216
v_exp_f32 v110, v110
v_exp_f32 v111, v111
v_cvt_pk_bf16_f32 v106, v108, v109
v_cvt_pk_bf16_f32 v107, v110, v111
v_exp_f32 v112, v112
v_exp_f32 v113, v113
v_exp_f32 v114, v114
v_mfma_f32_32x32x16_bf16 v[160:175], v[44:47], v[104:107], v[160:175]
ds_read_b128 v[44:47], v14 offset:9984
v_exp_f32 v115, v115
v_cvt_pk_bf16_f32 v112, v112, v113
v_exp_f32 v116, v116
v_exp_f32 v117, v117
v_cvt_pk_bf16_f32 v113, v114, v115
v_exp_f32 v118, v118
v_exp_f32 v119, v119
v_cvt_pk_bf16_f32 v114, v116, v117
s_waitcnt vmcnt(6) lgkmcnt(0)
s_barrier
v_mfma_f32_32x32x4_2b_bf16 v[80:111], v[34:35], v[32:33], 0
ds_read_b64 v[34:35], v13 offset:12288
s_add_u32 m0, s33, 0
s_nop 0
buffer_load_dwordx4 v6, s[4:7], s32 offen offset:0 sc1 lds
v_cvt_pk_bf16_f32 v115, v118, v119
v_exp_f32 v120, v120
v_exp_f32 v121, v121
v_exp_f32 v122, v122
v_exp_f32 v123, v123
v_cvt_pk_bf16_f32 v120, v120, v121
v_exp_f32 v124, v124
v_exp_f32 v125, v125
v_mfma_f32_32x32x16_bf16 v[144:159], v[40:43], v[112:115], v[144:159]
s_add_u32 m0, s33, 0
s_nop 0
buffer_load_dwordx4 v6, s[4:7], s32 offen offset:1024 sc1 lds
v_cvt_pk_bf16_f32 v121, v122, v123
v_exp_f32 v126, v126
v_exp_f32 v127, v127
v_cvt_pk_bf16_f32 v122, v124, v125
v_cvt_pk_bf16_f32 v123, v126, v127
v_exp_f32 v128, v128
v_exp_f32 v129, v129
v_exp_f32 v130, v130
v_mfma_f32_32x32x16_bf16 v[144:159], v[44:47], v[120:123], v[144:159]
s_add_u32 m0, s33, 0
s_sub_u32 s24, s32, s0
buffer_load_dwordx4 v15, s[4:7], s24 offen offset:2048 sc1 lds
s_add_u32 s32, s32, 12288
v_exp_f32 v131, v131
v_cvt_pk_bf16_f32 v128, v128, v129
v_exp_f32 v132, v132
v_exp_f32 v133, v133
v_cvt_pk_bf16_f32 v129, v130, v131
v_mfma_f32_32x32x16_bf16 v[80:95], v[36:39], v[24:27], v[80:95]
s_add_u32 m0, s39, 49152
s_nop 0
buffer_load_dwordx4 v6, s[4:7], s65 offen sc1 lds
s_add_u32 s65, s65, 8192
v_exp_f32 v134, v134
v_exp_f32 v135, v135
v_cvt_pk_bf16_f32 v130, v132, v133
v_cvt_pk_bf16_f32 v131, v134, v135
v_exp_f32 v136, v136
v_exp_f32 v137, v137
v_exp_f32 v138, v138
v_mfma_f32_32x32x16_bf16 v[160:175], v[40:43], v[128:131], v[160:175]
ds_read_b128 v[40:43], v14 offset:12288
v_exp_f32 v139, v139
v_cvt_pk_bf16_f32 v136, v136, v137
v_exp_f32 v140, v140
v_exp_f32 v141, v141
v_cvt_pk_bf16_f32 v137, v138, v139
v_mfma_f32_32x32x16_bf16 v[96:111], v[36:39], v[28:31], v[96:111]
ds_read_b128 v[36:39], v12 offset:12288
s_add_u32 m0, s39, 57344
s_nop 0
buffer_load_dwordx4 v6, s[4:7], s65 offen sc1 lds
s_add_u32 s65, s65, 8192
v_exp_f32 v142, v142
v_exp_f32 v143, v143
v_cvt_pk_bf16_f32 v138, v140, v141
v_cvt_pk_bf16_f32 v139, v142, v143
v_exp_f32 v80, v80
v_exp_f32 v81, v81
v_exp_f32 v82, v82
v_mfma_f32_32x32x16_bf16 v[160:175], v[44:47], v[136:139], v[160:175]
ds_read_b128 v[44:47], v14 offset:13056
v_exp_f32 v83, v83
v_cvt_pk_bf16_f32 v80, v80, v81
v_exp_f32 v84, v84
v_exp_f32 v85, v85
v_cvt_pk_bf16_f32 v81, v82, v83
v_exp_f32 v86, v86
v_exp_f32 v87, v87
v_cvt_pk_bf16_f32 v82, v84, v85
s_waitcnt lgkmcnt(0)
v_mfma_f32_32x32x4_2b_bf16 v[112:143], v[34:35], v[32:33], 0
ds_read_b64 v[34:35], v13 offset:15360
s_add_u32 m0, s39, 65536
s_nop 0
buffer_load_dwordx4 v6, s[4:7], s65 offen sc1 lds
s_add_u32 s65, s65, 8192
v_cvt_pk_bf16_f32 v83, v86, v87
v_exp_f32 v88, v88
v_exp_f32 v89, v89
v_exp_f32 v90, v90
v_exp_f32 v91, v91
v_cvt_pk_bf16_f32 v88, v88, v89
v_exp_f32 v92, v92
v_exp_f32 v93, v93
v_mfma_f32_32x32x16_bf16 v[144:159], v[40:43], v[80:83], v[144:159]
s_add_u32 m0, s39, 73728
s_nop 0
buffer_load_dwordx4 v6, s[4:7], s65 offen sc1 lds
s_add_u32 s65, s65, 8192
v_cvt_pk_bf16_f32 v89, v90, v91
v_exp_f32 v94, v94
v_exp_f32 v95, v95
v_cvt_pk_bf16_f32 v90, v92, v93
v_cvt_pk_bf16_f32 v91, v94, v95
v_exp_f32 v96, v96
v_exp_f32 v97, v97
v_exp_f32 v98, v98
v_mfma_f32_32x32x16_bf16 v[144:159], v[44:47], v[88:91], v[144:159]
v_exp_f32 v99, v99
v_cvt_pk_bf16_f32 v96, v96, v97
v_exp_f32 v100, v100
v_exp_f32 v101, v101
v_cvt_pk_bf16_f32 v97, v98, v99
v_mfma_f32_32x32x16_bf16 v[112:127], v[36:39], v[24:27], v[112:127]
v_exp_f32 v102, v102
v_exp_f32 v103, v103
v_cvt_pk_bf16_f32 v98, v100, v101
v_cvt_pk_bf16_f32 v99, v102, v103
v_exp_f32 v104, v104
v_exp_f32 v105, v105
v_exp_f32 v106, v106
v_mfma_f32_32x32x16_bf16 v[160:175], v[40:43], v[96:99], v[160:175]
ds_read_b128 v[40:43], v14 offset:15360
v_exp_f32 v107, v107
v_cvt_pk_bf16_f32 v104, v104, v105
v_exp_f32 v108, v108
v_exp_f32 v109, v109
v_cvt_pk_bf16_f32 v105, v106, v107
v_mfma_f32_32x32x16_bf16 v[128:143], v[36:39], v[28:31], v[128:143]
ds_read_b128 v[36:39], v12 offset:15360
v_exp_f32 v110, v110
v_exp_f32 v111, v111
v_cvt_pk_bf16_f32 v106, v108, v109
v_cvt_pk_bf16_f32 v107, v110, v111
v_exp_f32 v112, v112
v_exp_f32 v113, v113
v_exp_f32 v114, v114
v_mfma_f32_32x32x16_bf16 v[160:175], v[44:47], v[104:107], v[160:175]
ds_read_b128 v[44:47], v14 offset:16128
v_exp_f32 v115, v115
v_cvt_pk_bf16_f32 v112, v112, v113
v_exp_f32 v116, v116
v_exp_f32 v117, v117
v_cvt_pk_bf16_f32 v113, v114, v115
v_exp_f32 v118, v118
v_exp_f32 v119, v119
v_cvt_pk_bf16_f32 v114, v116, v117
s_waitcnt lgkmcnt(0)
v_mfma_f32_32x32x4_2b_bf16 v[80:111], v[34:35], v[32:33], 0
ds_read_b64 v[34:35], v13 offset:18432
s_add_u32 m0, s39, 81920
s_nop 0
buffer_load_dwordx4 v6, s[4:7], s65 offen sc1 lds
s_add_u32 s65, s65, 8192
v_cvt_pk_bf16_f32 v115, v118, v119
v_exp_f32 v120, v120
v_exp_f32 v121, v121
v_exp_f32 v122, v122
v_exp_f32 v123, v123
v_cvt_pk_bf16_f32 v120, v120, v121
v_exp_f32 v124, v124
v_exp_f32 v125, v125
v_mfma_f32_32x32x16_bf16 v[144:159], v[40:43], v[112:115], v[144:159]
s_add_u32 m0, s39, 90112
s_nop 0
buffer_load_dwordx4 v6, s[4:7], s65 offen sc1 lds
s_add_u32 s65, s65, 8192
v_cvt_pk_bf16_f32 v121, v122, v123
v_exp_f32 v126, v126
v_exp_f32 v127, v127
v_cvt_pk_bf16_f32 v122, v124, v125
v_cvt_pk_bf16_f32 v123, v126, v127
v_exp_f32 v128, v128
v_exp_f32 v129, v129
v_exp_f32 v130, v130
v_mfma_f32_32x32x16_bf16 v[144:159], v[44:47], v[120:123], v[144:159]
v_exp_f32 v131, v131
v_cvt_pk_bf16_f32 v128, v128, v129
v_exp_f32 v132, v132
v_exp_f32 v133, v133
v_cvt_pk_bf16_f32 v129, v130, v131
v_mfma_f32_32x32x16_bf16 v[80:95], v[36:39], v[24:27], v[80:95]
v_exp_f32 v134, v134
v_exp_f32 v135, v135
v_cvt_pk_bf16_f32 v130, v132, v133
v_cvt_pk_bf16_f32 v131, v134, v135
v_exp_f32 v136, v136
v_exp_f32 v137, v137
v_exp_f32 v138, v138
v_mfma_f32_32x32x16_bf16 v[160:175], v[40:43], v[128:131], v[160:175]
ds_read_b128 v[40:43], v14 offset:18432
v_exp_f32 v139, v139
v_cvt_pk_bf16_f32 v136, v136, v137
v_exp_f32 v140, v140
v_exp_f32 v141, v141
v_cvt_pk_bf16_f32 v137, v138, v139
v_mfma_f32_32x32x16_bf16 v[96:111], v[36:39], v[28:31], v[96:111]
ds_read_b128 v[36:39], v12 offset:18432
v_exp_f32 v142, v142
v_exp_f32 v143, v143
v_cvt_pk_bf16_f32 v138, v140, v141
v_cvt_pk_bf16_f32 v139, v142, v143
v_exp_f32 v80, v80
v_exp_f32 v81, v81
v_exp_f32 v82, v82
v_mfma_f32_32x32x16_bf16 v[160:175], v[44:47], v[136:139], v[160:175]
ds_read_b128 v[44:47], v14 offset:19200
v_exp_f32 v83, v83
v_cvt_pk_bf16_f32 v80, v80, v81
v_exp_f32 v84, v84
v_exp_f32 v85, v85
v_cvt_pk_bf16_f32 v81, v82, v83
v_exp_f32 v86, v86
v_exp_f32 v87, v87
v_cvt_pk_bf16_f32 v82, v84, v85
s_waitcnt lgkmcnt(0)
v_mfma_f32_32x32x4_2b_bf16 v[112:143], v[34:35], v[32:33], 0
ds_read_b64 v[34:35], v13 offset:21504
s_cmp_ge_u32 s16, 4
s_cbranch_scc1 L_at_no12
s_add_u32 m0, s39, 98304
s_nop 0
buffer_load_dwordx4 v6, s[4:7], s65 offen sc1 lds
L_at_no12:
v_cvt_pk_bf16_f32 v83, v86, v87
v_exp_f32 v88, v88
v_exp_f32 v89, v89
v_exp_f32 v90, v90
v_exp_f32 v91, v91
v_cvt_pk_bf16_f32 v88, v88, v89
v_exp_f32 v92, v92
v_exp_f32 v93, v93
v_mfma_f32_32x32x16_bf16 v[144:159], v[40:43], v[80:83], v[144:159]
buffer_load_dwordx4 v[212:215], v6, s[4:7], s3 offen sc1
s_add_u32 s3, s3, 8192
v_cvt_pk_bf16_f32 v89, v90, v91
v_exp_f32 v94, v94
v_exp_f32 v95, v95
v_cvt_pk_bf16_f32 v90, v92, v93
v_cvt_pk_bf16_f32 v91, v94, v95
v_exp_f32 v96, v96
v_exp_f32 v97, v97
v_exp_f32 v98, v98
v_mfma_f32_32x32x16_bf16 v[144:159], v[44:47], v[88:91], v[144:159]
buffer_load_dwordx4 v[216:219], v6, s[4:7], s3 offen sc1
s_add_u32 s3, s3, 8192
v_exp_f32 v99, v99
v_cvt_pk_bf16_f32 v96, v96, v97
v_exp_f32 v100, v100
v_exp_f32 v101, v101
v_cvt_pk_bf16_f32 v97, v98, v99
v_mfma_f32_32x32x16_bf16 v[112:127], v[36:39], v[24:27], v[112:127]
v_exp_f32 v102, v102
v_exp_f32 v103, v103
v_cvt_pk_bf16_f32 v98, v100, v101
v_cvt_pk_bf16_f32 v99, v102, v103
v_exp_f32 v104, v104
v_exp_f32 v105, v105
v_exp_f32 v106, v106
v_mfma_f32_32x32x16_bf16 v[160:175], v[40:43], v[96:99], v[160:175]
ds_read_b128 v[40:43], v14 offset:21504
v_exp_f32 v107, v107
v_cvt_pk_bf16_f32 v104, v104, v105
v_exp_f32 v108, v108
v_exp_f32 v109, v109
v_cvt_pk_bf16_f32 v105, v106, v107
v_mfma_f32_32x32x16_bf16 v[128:143], v[36:39], v[28:31], v[128:143]
ds_read_b128 v[36:39], v12 offset:21504
v_exp_f32 v110, v110
v_exp_f32 v111, v111
v_cvt_pk_bf16_f32 v106, v108, v109
v_cvt_pk_bf16_f32 v107, v110, v111
v_exp_f32 v112, v112
v_exp_f32 v113, v113
v_exp_f32 v114, v114
v_mfma_f32_32x32x16_bf16 v[160:175], v[44:47], v[104:107], v[160:175]
ds_read_b128 v[44:47], v14 offset:22272
v_exp_f32 v115, v115
v_cvt_pk_bf16_f32 v112, v112, v113
v_exp_f32 v116, v116
v_exp_f32 v117, v117
v_cvt_pk_bf16_f32 v113, v114, v115
v_exp_f32 v118, v118
v_exp_f32 v119, v119
v_cvt_pk_bf16_f32 v114, v116, v117
s_waitcnt vmcnt(8) lgkmcnt(0)
s_barrier
v_mfma_f32_32x32x4_2b_bf16 v[80:111], v[34:35], v[32:33], 0
ds_read_b64 v[34:35], v13 offset:0
s_add_u32 m0, s33, 12288
s_nop 0
buffer_load_dwordx4 v6, s[4:7], s32 offen offset:0 sc1 lds
v_cvt_pk_bf16_f32 v115, v118, v119
v_exp_f32 v120, v120
v_exp_f32 v121, v121
v_exp_f32 v122, v122
v_exp_f32 v123, v123
v_cvt_pk_bf16_f32 v120, v120, v121
v_exp_f32 v124, v124
v_exp_f32 v125, v125
v_mfma_f32_32x32x16_bf16 v[144:159], v[40:43], v[112:115], v[144:159]
s_add_u32 m0, s33, 12288
s_nop 0
buffer_load_dwordx4 v6, s[4:7], s32 offen offset:1024 sc1 lds
v_cvt_pk_bf16_f32 v121, v122, v123
v_exp_f32 v126, v126
v_exp_f32 v127, v127
v_cvt_pk_bf16_f32 v122, v124, v125
v_cvt_pk_bf16_f32 v123, v126, v127
v_exp_f32 v128, v128
v_exp_f32 v129, v129
v_exp_f32 v130, v130
v_mfma_f32_32x32x16_bf16 v[144:159], v[44:47], v[120:123], v[144:159]
s_add_u32 m0, s33, 12288
s_sub_u32 s24, s32, s0
buffer_load_dwordx4 v15, s[4:7], s24 offen offset:2048 sc1 lds
s_add_u32 s32, s32, 12288
v_exp_f32 v131, v131
v_cvt_pk_bf16_f32 v128, v128, v129
v_exp_f32 v132, v132
v_exp_f32 v133, v133
v_cvt_pk_bf16_f32 v129, v130, v131
v_mfma_f32_32x32x16_bf16 v[80:95], v[36:39], v[24:27], v[80:95]
buffer_load_dwordx4 v[220:223], v6, s[4:7], s3 offen sc1
s_add_u32 s3, s3, 8192
v_exp_f32 v134, v134
v_exp_f32 v135, v135
v_cvt_pk_bf16_f32 v130, v132, v133
v_cvt_pk_bf16_f32 v131, v134, v135
v_exp_f32 v136, v136
v_exp_f32 v137, v137
v_exp_f32 v138, v138
v_mfma_f32_32x32x16_bf16 v[160:175], v[40:43], v[128:131], v[160:175]
ds_read_b128 v[40:43], v14 offset:0
v_exp_f32 v139, v139
v_cvt_pk_bf16_f32 v136, v136, v137
v_exp_f32 v140, v140
v_exp_f32 v141, v141
v_cvt_pk_bf16_f32 v137, v138, v139
v_mfma_f32_32x32x16_bf16 v[96:111], v[36:39], v[28:31], v[96:111]
ds_read_b128 v[36:39], v12 offset:0
buffer_load_dwordx4 v[224:227], v6, s[4:7], s3 offen sc1
s_add_u32 s3, s3, 8192
v_exp_f32 v142, v142
v_exp_f32 v143, v143
v_cvt_pk_bf16_f32 v138, v140, v141
v_cvt_pk_bf16_f32 v139, v142, v143
v_exp_f32 v80, v80
v_exp_f32 v81, v81
v_exp_f32 v82, v82
v_mfma_f32_32x32x16_bf16 v[160:175], v[44:47], v[136:139], v[160:175]
ds_read_b128 v[44:47], v14 offset:768
v_exp_f32 v83, v83
v_cvt_pk_bf16_f32 v80, v80, v81
v_exp_f32 v84, v84
v_exp_f32 v85, v85
v_cvt_pk_bf16_f32 v81, v82, v83
v_exp_f32 v86, v86
v_exp_f32 v87, v87
v_cvt_pk_bf16_f32 v82, v84, v85
s_waitcnt lgkmcnt(0)
v_mfma_f32_32x32x4_2b_bf16 v[112:143], v[34:35], v[32:33], 0
ds_read_b64 v[34:35], v13 offset:3072
buffer_load_dwordx4 v[228:231], v6, s[4:7], s3 offen sc1
s_add_u32 s3, s3, 8192
v_cvt_pk_bf16_f32 v83, v86, v87
v_exp_f32 v88, v88
v_exp_f32 v89, v89
v_exp_f32 v90, v90
v_exp_f32 v91, v91
v_cvt_pk_bf16_f32 v88, v88, v89
v_exp_f32 v92, v92
v_exp_f32 v93, v93
v_mfma_f32_32x32x16_bf16 v[144:159], v[40:43], v[80:83], v[144:159]
buffer_load_dwordx4 v[232:235], v6, s[4:7], s3 offen sc1
s_add_u32 s3, s3, 8192
v_cvt_pk_bf16_f32 v89, v90, v91
v_exp_f32 v94, v94
v_exp_f32 v95, v95
v_cvt_pk_bf16_f32 v90, v92, v93
v_cvt_pk_bf16_f32 v91, v94, v95
v_exp_f32 v96, v96
v_exp_f32 v97, v97
v_exp_f32 v98, v98
v_mfma_f32_32x32x16_bf16 v[144:159], v[44:47], v[88:91], v[144:159]
v_exp_f32 v99, v99
v_cvt_pk_bf16_f32 v96, v96, v97
v_exp_f32 v100, v100
v_exp_f32 v101, v101
v_cvt_pk_bf16_f32 v97, v98, v99
v_mfma_f32_32x32x16_bf16 v[112:127], v[36:39], v[24:27], v[112:127]
v_exp_f32 v102, v102
v_exp_f32 v103, v103
v_cvt_pk_bf16_f32 v98, v100, v101
v_cvt_pk_bf16_f32 v99, v102, v103
v_exp_f32 v104, v104
v_exp_f32 v105, v105
v_exp_f32 v106, v106
v_mfma_f32_32x32x16_bf16 v[160:175], v[40:43], v[96:99], v[160:175]
ds_read_b128 v[40:43], v14 offset:3072
v_exp_f32 v107, v107
v_cvt_pk_bf16_f32 v104, v104, v105
v_exp_f32 v108, v108
v_exp_f32 v109, v109
v_cvt_pk_bf16_f32 v105, v106, v107
v_mfma_f32_32x32x16_bf16 v[128:143], v[36:39], v[28:31], v[128:143]
ds_read_b128 v[36:39], v12 offset:3072
v_exp_f32 v110, v110
v_exp_f32 v111, v111
v_cvt_pk_bf16_f32 v106, v108, v109
v_cvt_pk_bf16_f32 v107, v110, v111
v_exp_f32 v112, v112
v_exp_f32 v113, v113
v_exp_f32 v114, v114
v_mfma_f32_32x32x16_bf16 v[160:175], v[44:47], v[104:107], v[160:175]
ds_read_b128 v[44:47], v14 offset:3840
v_exp_f32 v115, v115
v_cvt_pk_bf16_f32 v112, v112, v113
v_exp_f32 v116, v116
v_exp_f32 v117, v117
v_cvt_pk_bf16_f32 v113, v114, v115
v_exp_f32 v118, v118
v_exp_f32 v119, v119
v_cvt_pk_bf16_f32 v114, v116, v117
s_waitcnt lgkmcnt(0)
v_mfma_f32_32x32x4_2b_bf16 v[80:111], v[34:35], v[32:33], 0
ds_read_b64 v[34:35], v13 offset:6144
buffer_load_dwordx4 v[236:239], v6, s[4:7], s3 offen sc1
s_add_u32 s3, s3, 8192
v_cvt_pk_bf16_f32 v115, v118, v119
v_exp_f32 v120, v120
v_exp_f32 v121, v121
v_exp_f32 v122, v122
v_exp_f32 v123, v123
v_cvt_pk_bf16_f32 v120, v120, v121
v_exp_f32 v124, v124
v_exp_f32 v125, v125
v_mfma_f32_32x32x16_bf16 v[144:159], v[40:43], v[112:115], v[144:159]
buffer_load_dwordx4 v[240:243], v6, s[4:7], s3 offen sc1
s_add_u32 s3, s3, 8192
v_cvt_pk_bf16_f32 v121, v122, v123
v_exp_f32 v126, v126
v_exp_f32 v127, v127
v_cvt_pk_bf16_f32 v122, v124, v125
v_cvt_pk_bf16_f32 v123, v126, v127
v_exp_f32 v128, v128
v_exp_f32 v129, v129
v_exp_f32 v130, v130
v_mfma_f32_32x32x16_bf16 v[144:159], v[44:47], v[120:123], v[144:159]
v_exp_f32 v131, v131
v_cvt_pk_bf16_f32 v128, v128, v129
v_exp_f32 v132, v132
v_exp_f32 v133, v133
v_cvt_pk_bf16_f32 v129, v130, v131
v_mfma_f32_32x32x16_bf16 v[80:95], v[36:39], v[24:27], v[80:95]
v_exp_f32 v134, v134
v_exp_f32 v135, v135
v_cvt_pk_bf16_f32 v130, v132, v133
v_cvt_pk_bf16_f32 v131, v134, v135
v_exp_f32 v136, v136
v_exp_f32 v137, v137
v_exp_f32 v138, v138
v_mfma_f32_32x32x16_bf16 v[160:175], v[40:43], v[128:131], v[160:175]
ds_read_b128 v[40:43], v14 offset:6144
v_exp_f32 v139, v139
v_cvt_pk_bf16_f32 v136, v136, v137
v_exp_f32 v140, v140
v_exp_f32 v141, v141
v_cvt_pk_bf16_f32 v137, v138, v139
v_mfma_f32_32x32x16_bf16 v[96:111], v[36:39], v[28:31], v[96:111]
ds_read_b128 v[36:39], v12 offset:6144
v_exp_f32 v142, v142
v_exp_f32 v143, v143
v_cvt_pk_bf16_f32 v138, v140, v141
v_cvt_pk_bf16_f32 v139, v142, v143
v_exp_f32 v80, v80
v_exp_f32 v81, v81
v_exp_f32 v82, v82
v_mfma_f32_32x32x16_bf16 v[160:175], v[44:47], v[136:139], v[160:175]
ds_read_b128 v[44:47], v14 offset:6912
v_exp_f32 v83, v83
v_cvt_pk_bf16_f32 v80, v80, v81
v_exp_f32 v84, v84
v_exp_f32 v85, v85
v_cvt_pk_bf16_f32 v81, v82, v83
v_exp_f32 v86, v86
v_exp_f32 v87, v87
v_cvt_pk_bf16_f32 v82, v84, v85
s_waitcnt lgkmcnt(0)
v_mfma_f32_32x32x4_2b_bf16 v[112:143], v[34:35], v[32:33], 0
ds_read_b64 v[34:35], v13 offset:9216
buffer_load_dwordx4 v[244:247], v6, s[4:7], s3 offen sc1
s_add_u32 s3, s3, 8192
v_cvt_pk_bf16_f32 v83, v86, v87
v_exp_f32 v88, v88
v_exp_f32 v89, v89
v_exp_f32 v90, v90
v_exp_f32 v91, v91
v_cvt_pk_bf16_f32 v88, v88, v89
v_exp_f32 v92, v92
v_exp_f32 v93, v93
v_mfma_f32_32x32x16_bf16 v[144:159], v[40:43], v[80:83], v[144:159]
buffer_load_dwordx4 v[248:251], v6, s[4:7], s3 offen sc1
s_add_u32 s3, s3, 8192
v_cvt_pk_bf16_f32 v89, v90, v91
v_exp_f32 v94, v94
v_exp_f32 v95, v95
v_cvt_pk_bf16_f32 v90, v92, v93
v_cvt_pk_bf16_f32 v91, v94, v95
v_exp_f32 v96, v96
v_exp_f32 v97, v97
v_exp_f32 v98, v98
v_mfma_f32_32x32x16_bf16 v[144:159], v[44:47], v[88:91], v[144:159]
v_exp_f32 v99, v99
v_cvt_pk_bf16_f32 v96, v96, v97
v_exp_f32 v100, v100
v_exp_f32 v101, v101
v_cvt_pk_bf16_f32 v97, v98, v99
v_mfma_f32_32x32x16_bf16 v[112:127], v[36:39], v[24:27], v[112:127]
v_exp_f32 v102, v102
v_exp_f32 v103, v103
v_cvt_pk_bf16_f32 v98, v100, v101
v_cvt_pk_bf16_f32 v99, v102, v103
v_exp_f32 v104, v104
v_exp_f32 v105, v105
v_exp_f32 v106, v106
v_mfma_f32_32x32x16_bf16 v[160:175], v[40:43], v[96:99], v[160:175]
ds_read_b128 v[40:43], v14 offset:9216
v_exp_f32 v107, v107
v_cvt_pk_bf16_f32 v104, v104, v105
v_exp_f32 v108, v108
v_exp_f32 v109, v109
v_cvt_pk_bf16_f32 v105, v106, v107
v_mfma_f32_32x32x16_bf16 v[128:143], v[36:39], v[28:31], v[128:143]
ds_read_b128 v[36:39], v12 offset:9216
v_exp_f32 v110, v110
v_exp_f32 v111, v111
v_cvt_pk_bf16_f32 v106, v108, v109
v_cvt_pk_bf16_f32 v107, v110, v111
v_exp_f32 v112, v112
v_exp_f32 v113, v113
v_exp_f32 v114, v114
v_mfma_f32_32x32x16_bf16 v[160:175], v[44:47], v[104:107], v[160:175]
ds_read_b128 v[44:47], v14 offset:9984
v_exp_f32 v115, v115
v_cvt_pk_bf16_f32 v112, v112, v113
v_exp_f32 v116, v116
v_exp_f32 v117, v117
v_cvt_pk_bf16_f32 v113, v114, v115
v_exp_f32 v118, v118
v_exp_f32 v119, v119
v_cvt_pk_bf16_f32 v114, v116, v117
s_waitcnt vmcnt(8) lgkmcnt(0)
s_barrier
v_mfma_f32_32x32x4_2b_bf16 v[80:111], v[34:35], v[32:33], 0
ds_read_b64 v[34:35], v13 offset:12288
buffer_load_dwordx4 v[252:255], v6, s[4:7], s3 offen sc1
s_add_u32 s3, s3, 8192
v_cvt_pk_bf16_f32 v115, v118, v119
v_exp_f32 v120, v120
v_exp_f32 v121, v121
v_exp_f32 v122, v122
v_exp_f32 v123, v123
v_cvt_pk_bf16_f32 v120, v120, v121
v_exp_f32 v124, v124
v_exp_f32 v125, v125
v_mfma_f32_32x32x16_bf16 v[144:159], v[40:43], v[112:115], v[144:159]
buffer_load_dwordx4 v[180:183], v6, s[4:7], s3 offen sc1
s_add_u32 s3, s3, 8192
v_cvt_pk_bf16_f32 v121, v122, v123
v_exp_f32 v126, v126
v_exp_f32 v127, v127
v_cvt_pk_bf16_f32 v122, v124, v125
v_cvt_pk_bf16_f32 v123, v126, v127
v_exp_f32 v128, v128
v_exp_f32 v129, v129
v_exp_f32 v130, v130
v_mfma_f32_32x32x16_bf16 v[144:159], v[44:47], v[120:123], v[144:159]
v_exp_f32 v131, v131
v_cvt_pk_bf16_f32 v128, v128, v129
v_exp_f32 v132, v132
v_exp_f32 v133, v133
v_cvt_pk_bf16_f32 v129, v130, v131
v_mfma_f32_32x32x16_bf16 v[80:95], v[36:39], v[24:27], v[80:95]
v_exp_f32 v134, v134
v_exp_f32 v135, v135
v_cvt_pk_bf16_f32 v130, v132, v133
v_cvt_pk_bf16_f32 v131, v134, v135
v_exp_f32 v136, v136
v_exp_f32 v137, v137
v_exp_f32 v138, v138
v_mfma_f32_32x32x16_bf16 v[160:175], v[40:43], v[128:131], v[160:175]
ds_read_b128 v[40:43], v14 offset:12288
v_exp_f32 v139, v139
v_cvt_pk_bf16_f32 v136, v136, v137
v_exp_f32 v140, v140
v_exp_f32 v141, v141
v_cvt_pk_bf16_f32 v137, v138, v139
v_mfma_f32_32x32x16_bf16 v[96:111], v[36:39], v[28:31], v[96:111]
ds_read_b128 v[36:39], v12 offset:12288
v_exp_f32 v142, v142
v_exp_f32 v143, v143
v_cvt_pk_bf16_f32 v138, v140, v141
v_cvt_pk_bf16_f32 v139, v142, v143
v_exp_f32 v80, v80
v_exp_f32 v81, v81
v_exp_f32 v82, v82
v_mfma_f32_32x32x16_bf16 v[160:175], v[44:47], v[136:139], v[160:175]
ds_read_b128 v[44:47], v14 offset:13056
v_exp_f32 v83, v83
v_cvt_pk_bf16_f32 v80, v80, v81
v_exp_f32 v84, v84
v_exp_f32 v85, v85
v_cvt_pk_bf16_f32 v81, v82, v83
v_exp_f32 v86, v86
v_exp_f32 v87, v87
v_cvt_pk_bf16_f32 v82, v84, v85
s_waitcnt lgkmcnt(0)
v_mfma_f32_32x32x4_2b_bf16 v[112:143], v[34:35], v[32:33], 0
ds_read_b64 v[34:35], v13 offset:15360
buffer_load_dwordx4 v[184:187], v6, s[4:7], s3 offen sc1
s_add_u32 s3, s3, 8192
v_cvt_pk_bf16_f32 v83, v86, v87
v_exp_f32 v88, v88
v_exp_f32 v89, v89
v_exp_f32 v90, v90
v_exp_f32 v91, v91
v_cvt_pk_bf16_f32 v88, v88, v89
v_exp_f32 v92, v92
v_exp_f32 v93, v93
v_mfma_f32_32x32x16_bf16 v[144:159], v[40:43], v[80:83], v[144:159]
buffer_load_dwordx4 v[188:191], v6, s[4:7], s3 offen sc1
s_add_u32 s3, s3, 8192
v_cvt_pk_bf16_f32 v89, v90, v91
v_exp_f32 v94, v94
v_exp_f32 v95, v95
v_cvt_pk_bf16_f32 v90, v92, v93
v_cvt_pk_bf16_f32 v91, v94, v95
v_exp_f32 v96, v96
v_exp_f32 v97, v97
v_exp_f32 v98, v98
v_mfma_f32_32x32x16_bf16 v[144:159], v[44:47], v[88:91], v[144:159]
buffer_load_dwordx4 v[192:195], v6, s[4:7], s3 offen sc1
s_add_u32 s3, s3, 8192
v_exp_f32 v99, v99
v_cvt_pk_bf16_f32 v96, v96, v97
v_exp_f32 v100, v100
v_exp_f32 v101, v101
v_cvt_pk_bf16_f32 v97, v98, v99
v_mfma_f32_32x32x16_bf16 v[112:127], v[36:39], v[24:27], v[112:127]
v_exp_f32 v102, v102
v_exp_f32 v103, v103
v_cvt_pk_bf16_f32 v98, v100, v101
v_cvt_pk_bf16_f32 v99, v102, v103
v_exp_f32 v104, v104
v_exp_f32 v105, v105
v_exp_f32 v106, v106
v_mfma_f32_32x32x16_bf16 v[160:175], v[40:43], v[96:99], v[160:175]
ds_read_b128 v[40:43], v14 offset:15360
v_exp_f32 v107, v107
v_cvt_pk_bf16_f32 v104, v104, v105
v_exp_f32 v108, v108
v_exp_f32 v109, v109
v_cvt_pk_bf16_f32 v105, v106, v107
v_mfma_f32_32x32x16_bf16 v[128:143], v[36:39], v[28:31], v[128:143]
ds_read_b128 v[36:39], v12 offset:15360
v_exp_f32 v110, v110
v_exp_f32 v111, v111
v_cvt_pk_bf16_f32 v106, v108, v109
v_cvt_pk_bf16_f32 v107, v110, v111
v_exp_f32 v112, v112
v_exp_f32 v113, v113
v_exp_f32 v114, v114
v_mfma_f32_32x32x16_bf16 v[160:175], v[44:47], v[104:107], v[160:175]
ds_read_b128 v[44:47], v14 offset:16128
v_exp_f32 v115, v115
v_cvt_pk_bf16_f32 v112, v112, v113
v_exp_f32 v116, v116
v_exp_f32 v117, v117
v_cvt_pk_bf16_f32 v113, v114, v115
v_exp_f32 v118, v118
v_exp_f32 v119, v119
v_cvt_pk_bf16_f32 v114, v116, v117
s_waitcnt lgkmcnt(0)
v_mfma_f32_32x32x4_2b_bf16 v[80:111], v[34:35], v[32:33], 0
ds_read_b64 v[34:35], v13 offset:18432
v_cvt_pk_bf16_f32 v115, v118, v119
v_exp_f32 v120, v120
v_exp_f32 v121, v121
v_exp_f32 v122, v122
v_exp_f32 v123, v123
v_cvt_pk_bf16_f32 v120, v120, v121
v_exp_f32 v124, v124
v_exp_f32 v125, v125
v_mfma_f32_32x32x16_bf16 v[144:159], v[40:43], v[112:115], v[144:159]
v_cvt_pk_bf16_f32 v121, v122, v123
v_exp_f32 v126, v126
v_exp_f32 v127, v127
v_cvt_pk_bf16_f32 v122, v124, v125
v_cvt_pk_bf16_f32 v123, v126, v127
v_exp_f32 v128, v128
v_exp_f32 v129, v129
v_exp_f32 v130, v130
v_mfma_f32_32x32x16_bf16 v[144:159], v[44:47], v[120:123], v[144:159]
v_exp_f32 v131, v131
v_cvt_pk_bf16_f32 v128, v128, v129
v_exp_f32 v132, v132
v_exp_f32 v133, v133
v_cvt_pk_bf16_f32 v129, v130, v131
v_mfma_f32_32x32x16_bf16 v[80:95], v[36:39], v[24:27], v[80:95]
v_exp_f32 v134, v134
v_exp_f32 v135, v135
v_cvt_pk_bf16_f32 v130, v132, v133
v_cvt_pk_bf16_f32 v131, v134, v135
v_exp_f32 v136, v136
v_exp_f32 v137, v137
v_exp_f32 v138, v138
v_mfma_f32_32x32x16_bf16 v[160:175], v[40:43], v[128:131], v[160:175]
ds_read_b128 v[40:43], v14 offset:18432
v_exp_f32 v139, v139
v_cvt_pk_bf16_f32 v136, v136, v137
v_exp_f32 v140, v140
v_exp_f32 v141, v141
v_cvt_pk_bf16_f32 v137, v138, v139
v_mfma_f32_32x32x16_bf16 v[96:111], v[36:39], v[28:31], v[96:111]
ds_read_b128 v[36:39], v12 offset:18432
v_exp_f32 v142, v142
v_exp_f32 v143, v143
v_cvt_pk_bf16_f32 v138, v140, v141
v_cvt_pk_bf16_f32 v139, v142, v143
v_exp_f32 v80, v80
v_exp_f32 v81, v81
v_exp_f32 v82, v82
v_mfma_f32_32x32x16_bf16 v[160:175], v[44:47], v[136:139], v[160:175]
ds_read_b128 v[44:47], v14 offset:19200
v_exp_f32 v83, v83
v_cvt_pk_bf16_f32 v80, v80, v81
v_exp_f32 v84, v84
v_exp_f32 v85, v85
v_cvt_pk_bf16_f32 v81, v82, v83
v_exp_f32 v86, v86
v_exp_f32 v87, v87
v_cvt_pk_bf16_f32 v82, v84, v85
s_waitcnt lgkmcnt(0)
v_mfma_f32_32x32x4_2b_bf16 v[112:143], v[34:35], v[32:33], 0
ds_read_b64 v[34:35], v13 offset:21504
v_cvt_pk_bf16_f32 v83, v86, v87
v_exp_f32 v88, v88
v_exp_f32 v89, v89
v_exp_f32 v90, v90
v_exp_f32 v91, v91
v_cvt_pk_bf16_f32 v88, v88, v89
v_exp_f32 v92, v92
v_exp_f32 v93, v93
v_mfma_f32_32x32x16_bf16 v[144:159], v[40:43], v[80:83], v[144:159]
v_cvt_pk_bf16_f32 v89, v90, v91
v_exp_f32 v94, v94
v_exp_f32 v95, v95
v_cvt_pk_bf16_f32 v90, v92, v93
v_cvt_pk_bf16_f32 v91, v94, v95
v_exp_f32 v96, v96
v_exp_f32 v97, v97
v_exp_f32 v98, v98
v_mfma_f32_32x32x16_bf16 v[144:159], v[44:47], v[88:91], v[144:159]
v_exp_f32 v99, v99
v_cvt_pk_bf16_f32 v96, v96, v97
v_exp_f32 v100, v100
v_exp_f32 v101, v101
v_cvt_pk_bf16_f32 v97, v98, v99
v_mfma_f32_32x32x16_bf16 v[112:127], v[36:39], v[24:27], v[112:127]
v_exp_f32 v102, v102
v_exp_f32 v103, v103
v_cvt_pk_bf16_f32 v98, v100, v101
v_cvt_pk_bf16_f32 v99, v102, v103
v_exp_f32 v104, v104
v_exp_f32 v105, v105
v_exp_f32 v106, v106
v_mfma_f32_32x32x16_bf16 v[160:175], v[40:43], v[96:99], v[160:175]
ds_read_b128 v[40:43], v14 offset:21504
v_exp_f32 v107, v107
v_cvt_pk_bf16_f32 v104, v104, v105
v_exp_f32 v108, v108
v_exp_f32 v109, v109
v_cvt_pk_bf16_f32 v105, v106, v107
v_mfma_f32_32x32x16_bf16 v[128:143], v[36:39], v[28:31], v[128:143]
ds_read_b128 v[36:39], v12 offset:21504
v_exp_f32 v110, v110
v_exp_f32 v111, v111
v_cvt_pk_bf16_f32 v106, v108, v109
v_cvt_pk_bf16_f32 v107, v110, v111
v_exp_f32 v112, v112
v_exp_f32 v113, v113
v_exp_f32 v114, v114
v_mfma_f32_32x32x16_bf16 v[160:175], v[44:47], v[104:107], v[160:175]
ds_read_b128 v[44:47], v14 offset:22272
v_exp_f32 v115, v115
v_cvt_pk_bf16_f32 v112, v112, v113
v_exp_f32 v116, v116
v_exp_f32 v117, v117
v_cvt_pk_bf16_f32 v113, v114, v115
v_exp_f32 v118, v118
v_exp_f32 v119, v119
v_cvt_pk_bf16_f32 v114, v116, v117
s_waitcnt lgkmcnt(0)
s_barrier
v_cvt_pk_bf16_f32 v115, v118, v119
v_exp_f32 v120, v120
v_exp_f32 v121, v121
v_exp_f32 v122, v122
v_exp_f32 v123, v123
v_cvt_pk_bf16_f32 v120, v120, v121
v_exp_f32 v124, v124
v_exp_f32 v125, v125
v_mfma_f32_32x32x16_bf16 v[144:159], v[40:43], v[112:115], v[144:159]
v_cvt_pk_bf16_f32 v121, v122, v123
v_exp_f32 v126, v126
v_exp_f32 v127, v127
v_cvt_pk_bf16_f32 v122, v124, v125
v_cvt_pk_bf16_f32 v123, v126, v127
v_exp_f32 v128, v128
v_exp_f32 v129, v129
v_exp_f32 v130, v130
v_mfma_f32_32x32x16_bf16 v[144:159], v[44:47], v[120:123], v[144:159]
v_exp_f32 v131, v131
v_cvt_pk_bf16_f32 v128, v128, v129
v_exp_f32 v132, v132
v_exp_f32 v133, v133
v_cvt_pk_bf16_f32 v129, v130, v131
v_exp_f32 v134, v134
v_exp_f32 v135, v135
v_cvt_pk_bf16_f32 v130, v132, v133
v_cvt_pk_bf16_f32 v131, v134, v135
v_exp_f32 v136, v136
v_exp_f32 v137, v137
v_exp_f32 v138, v138
v_mfma_f32_32x32x16_bf16 v[160:175], v[40:43], v[128:131], v[160:175]
v_exp_f32 v139, v139
v_cvt_pk_bf16_f32 v136, v136, v137
v_exp_f32 v140, v140
v_exp_f32 v141, v141
v_cvt_pk_bf16_f32 v137, v138, v139
v_exp_f32 v142, v142
v_exp_f32 v143, v143
v_cvt_pk_bf16_f32 v138, v140, v141
v_cvt_pk_bf16_f32 v139, v142, v143
L_at_end:
s_mul_i32 s24, s16, 3072
v_add_u32 v1, s24, v6
v_mfma_f32_32x32x16_bf16 v[160:175], v[44:47], v[136:139], v[160:175]
ds_write_b128 v1, v[144:147] offset:0
ds_write_b128 v1, v[148:151] offset:1024
ds_write_b128 v1, v[152:155] offset:2048
s_xor_b32 s25, s16, 4
s_mul_i32 s25, s25, 3072
v_add_u32 v4, s25, v6
s_lshl_b32 s24, s16, 2
s_add_u32 s24, s24, 51200
v_mov_b32 v5, s24
v_and_b32 v1, 7, v0
v_lshlrev_b32 v1, 2, v1
s_nop 0
v_min_f32 v3, v152, v168
v_add_f32 v2, v152, v168
v_cmp_nlt_f32 vcc, 0x12800000, v3
s_nop 0
s_mov_b32 s67, vcc_hi
v_cmp_ngt_f32 vcc, 0x53800000, v2
s_nop 0
s_or_b32 s67, s67, vcc_hi
v_mov_b32 v3, s67
ds_write_b32 v5, v3
s_waitcnt lgkmcnt(0)
s_barrier
ds_read_b32 v3, v1 offset:51200
ds_read_b128 v[152:155], v4 offset:2048
ds_read_b128 v[144:147], v4 offset:0
ds_read_b128 v[148:151], v4 offset:1024
s_waitcnt lgkmcnt(3)
v_cmp_ne_u32 vcc, 0, v3
s_cmp_lg_u32 s34, 0
s_cbranch_scc1 L_at_fin
s_cbranch_vccnz L_at_slow
L_at_fin:
s_waitcnt lgkmcnt(2)
v_pk_add_f32 v[168:169], v[168:169], v[152:153]
v_pk_add_f32 v[170:171], v[170:171], v[154:155]
v_mov_b32 v3, v168
v_mov_b32 v156, v168
s_waitcnt lgkmcnt(0)
v_pk_add_f32 v[160:161], v[160:161], v[144:145]
v_permlane32_swap_b32 v3, v156
v_pk_add_f32 v[162:163], v[162:163], v[146:147]
v_rcp_f32 v156, v156
v_pk_add_f32 v[164:165], v[164:165], v[148:149]
v_pk_add_f32 v[166:167], v[166:167], v[150:151]
v_pk_mul_f32 v[160:161], v[160:161], v[156:157] op_sel_hi:[1,0]
v_pk_mul_f32 v[162:163], v[162:163], v[156:157] op_sel_hi:[1,0]
v_pk_mul_f32 v[164:165], v[164:165], v[156:157] op_sel_hi:[1,0]
v_pk_mul_f32 v[166:167], v[166:167], v[156:157] op_sel_hi:[1,0]
v_pk_mul_f32 v[168:169], v[168:169], v[156:157] op_sel_hi:[1,0]
v_pk_mul_f32 v[170:171], v[170:171], v[156:157] op_sel_hi:[1,0]
v_cvt_pk_bf16_f32 v144, v160, v161
v_cvt_pk_bf16_f32 v145, v162, v163
v_cvt_pk_bf16_f32 v146, v164, v165
v_cvt_pk_bf16_f32 v147, v166, v167
v_cvt_pk_bf16_f32 v148, v168, v169
v_cvt_pk_bf16_f32 v149, v170, v171
buffer_store_dwordx4 v[144:147], v18, s[4:7], 0 offen sc1
s_mov_b32 exec_hi, 0
buffer_store_dwordx2 v[148:149], v19, s[4:7], 0 offen sc1
s_mov_b64 exec, -1
s_and_b32 s32, s19, 3
s_lshr_b32 s33, s19, 2
s_and_b32 s34, s16, 1
s_bfe_u32 s35, s16, 0x10001
s_lshl_b32 s39, s18, 4
s_lshl_b32 s24, s32, 2
s_add_u32 s39, s39, s24
s_lshl_b32 s24, s34, 1
s_add_u32 s39, s39, s24
s_add_u32 s39, s39, s35
s_xor_b32 s24, s39, 1
s_mul_i32 s36, s39, 20480
s_mul_i32 s37, s24, 20480
s_mul_i32 s24, s35, 8192
s_add_u32 s24, s24, 9437184
s_add_u32 s36, s36, s24
s_add_u32 s37, s37, s24
s_mul_i32 s24, s35, 51200
s_add_u32 s24, s24, 61440
v_add_u32 v12, s24, v6
v_add_u32 v13, 40960, v12
s_mov_b32 s8, s40
s_mov_b32 s9, s41
s_mov_b32 s10, 0x280000
s_mov_b32 s11, 0x20000
v_and_b32 v1, 15, v0
v_lshrrev_b32 v2, 4, v0
s_lshl_b32 s24, s39, 4
v_add_u32 v3, s24, v1
v_mul_u32_u24 v3, 1280, v3
s_mul_i32 s24, s33, 160
v_add_u32 v3, s24, v3
v_lshl_add_u32 v210, v2, 4, v3
v_lshl_add_u32 v211, v2, 3, v3
s_mul_i32 s24, s39, 20480
s_mul_i32 s25, s33, 2560
s_add_u32 s24, s24, s25
s_add_u32 s24, s24, 12058624
v_lshl_add_u32 v3, v1, 4, s24
v_lshl_add_u32 v14, v2, 8, v3
v_lshl_add_u32 v3, v7, 8, v3
v_add_u32 v15, 2048, v3
v_lshlrev_b32 v16, 8, v2
v_lshl_add_u32 v16, v1, 3, v16
s_mul_i32 s24, s35, 6144
s_sub_u32 s24, 8192, s24
v_add_u32 v16, s24, v16
s_lshl_b32 s24, s39, 10
s_lshl_b32 s25, s33, 7
s_add_u32 s24, s24, s25
s_add_u32 s24, s24, 27688960
v_lshl_add_u32 v17, v1, 3, s24
s_lshl_b32 s25, s31, 10
v_lshlrev_b32 v10, 13, v0
s_lshl_b32 s24, s30, 2
s_add_u32 s24, s24, s25
s_add_u32 s47, s24, 27853184
v_mov_b32 v9, s17
s_waitcnt vmcnt(0) lgkmcnt(0)
s_barrier
s_cmp_lt_u32 s16, 4
s_cbranch_scc1 L_p3_cons0
s_cmp_eq_u32 s16, 7
s_cbranch_scc1 L_p3_sync
s_mov_b32 s27, 0x3f803f80
v_mov_b32 v196, 0
v_mov_b32 v197, 0
v_mov_b32 v198, 0
v_dot2_f32_bf16 v196, v212, s27, v196
v_dot2_f32_bf16 v196, v213, s27, v196
v_dot2_f32_bf16 v196, v214, s27, v196
v_dot2_f32_bf16 v196, v215, s27, v196
v_dot2_f32_bf16 v197, v216, s27, v197
v_dot2_f32_bf16 v197, v217, s27, v197
v_dot2_f32_bf16 v197, v218, s27, v197
v_dot2_f32_bf16 v197, v219, s27, v197
v_dot2_f32_bf16 v198, v220, s27, v198
v_dot2_f32_bf16 v198, v221, s27, v198
v_dot2_f32_bf16 v198, v222, s27, v198
v_dot2_f32_bf16 v198, v223, s27, v198
v_dot2_f32_bf16 v196, v224, s27, v196
v_dot2_f32_bf16 v196, v225, s27, v196
v_dot2_f32_bf16 v196, v226, s27, v196
v_dot2_f32_bf16 v196, v227, s27, v196
v_dot2_f32_bf16 v197, v228, s27, v197
v_dot2_f32_bf16 v197, v229, s27, v197
v_dot2_f32_bf16 v197, v230, s27, v197
v_dot2_f32_bf16 v197, v231, s27, v197
v_dot2_f32_bf16 v198, v232, s27, v198
v_dot2_f32_bf16 v198, v233, s27, v198
v_dot2_f32_bf16 v198, v234, s27, v198
v_dot2_f32_bf16 v198, v235, s27, v198
v_dot2_f32_bf16 v196, v236, s27, v196
v_dot2_f32_bf16 v196, v237, s27, v196
v_dot2_f32_bf16 v196, v238, s27, v196
v_dot2_f32_bf16 v196, v239, s27, v196
v_dot2_f32_bf16 v197, v240, s27, v197
v_dot2_f32_bf16 v197, v241, s27, v197
v_dot2_f32_bf16 v197, v242, s27, v197
v_dot2_f32_bf16 v197, v243, s27, v197
v_dot2_f32_bf16 v198, v244, s27, v198
v_dot2_f32_bf16 v198, v245, s27, v198
v_dot2_f32_bf16 v198, v246, s27, v198
v_dot2_f32_bf16 v198, v247, s27, v198
v_dot2_f32_bf16 v196, v248, s27, v196
v_dot2_f32_bf16 v196, v249, s27, v196
v_dot2_f32_bf16 v196, v250, s27, v196
v_dot2_f32_bf16 v196, v251, s27, v196
v_dot2_f32_bf16 v197, v252, s27, v197
v_dot2_f32_bf16 v197, v253, s27, v197
v_dot2_f32_bf16 v197, v254, s27, v197
v_dot2_f32_bf16 v197, v255, s27, v197
v_dot2_f32_bf16 v198, v180, s27, v198
v_dot2_f32_bf16 v198, v181, s27, v198
v_dot2_f32_bf16 v198, v182, s27, v198
v_dot2_f32_bf16 v198, v183, s27, v198
v_dot2_f32_bf16 v196, v184, s27, v196
v_dot2_f32_bf16 v196, v185, s27, v196
v_dot2_f32_bf16 v196, v186, s27, v196
v_dot2_f32_bf16 v196, v187, s27, v196
v_dot2_f32_bf16 v197, v188, s27, v197
v_dot2_f32_bf16 v197, v189, s27, v197
v_dot2_f32_bf16 v197, v190, s27, v197
v_dot2_f32_bf16 v197, v191, s27, v197
v_dot2_f32_bf16 v198, v192, s27, v198
v_dot2_f32_bf16 v198, v193, s27, v198
v_dot2_f32_bf16 v198, v194, s27, v198
v_dot2_f32_bf16 v198, v195, s27, v198
s_branch L_p3_go
L_p3_sync:
s_mov_b32 exec_hi, 0
buffer_atomic_swap v9, v10, s[4:7], s47 offen sc1
s_lshl_b32 s25, s2, 10
s_add_u32 s25, s25, 27853184
v_lshlrev_b32 v10, 2, v0
s_movk_i32 s24, 20000
L_poll_9:
v_mov_b32 v1, 0
buffer_atomic_or v1, v10, s[4:7], s25 offen sc0 sc1
s_sub_u32 s24, s24, 1
s_cbranch_scc1 L_pollok_10
s_waitcnt vmcnt(0)
v_cmp_ne_u32 vcc, s17, v1
s_cbranch_vccnz L_poll_9
L_pollok_10:
s_waitcnt vmcnt(0)
s_mov_b64 exec, -1
s_branch L_p3_go
L_p3_cons0:
buffer_load_dwordx4 v[200:203], v210, s[8:11], 0 offen
buffer_load_dwordx4 v[204:207], v210, s[8:11], 0 offen offset:64
buffer_load_dwordx2 v[208:209], v211, s[8:11], 0 offen offset:128
s_mov_b32 s27, 0x3f803f80
v_mov_b32 v196, 0
v_mov_b32 v197, 0
v_mov_b32 v198, 0
v_dot2_f32_bf16 v196, v212, s27, v196
v_dot2_f32_bf16 v196, v213, s27, v196
v_dot2_f32_bf16 v196, v214, s27, v196
v_dot2_f32_bf16 v196, v215, s27, v196
v_dot2_f32_bf16 v197, v216, s27, v197
v_dot2_f32_bf16 v197, v217, s27, v197
v_dot2_f32_bf16 v197, v218, s27, v197
v_dot2_f32_bf16 v197, v219, s27, v197
v_dot2_f32_bf16 v198, v220, s27, v198
v_dot2_f32_bf16 v198, v221, s27, v198
v_dot2_f32_bf16 v198, v222, s27, v198
v_dot2_f32_bf16 v198, v223, s27, v198
v_dot2_f32_bf16 v196, v224, s27, v196
v_dot2_f32_bf16 v196, v225, s27, v196
v_dot2_f32_bf16 v196, v226, s27, v196
v_dot2_f32_bf16 v196, v227, s27, v196
v_dot2_f32_bf16 v197, v228, s27, v197
v_dot2_f32_bf16 v197, v229, s27, v197
v_dot2_f32_bf16 v197, v230, s27, v197
v_dot2_f32_bf16 v197, v231, s27, v197
v_dot2_f32_bf16 v198, v232, s27, v198
v_dot2_f32_bf16 v198, v233, s27, v198
v_dot2_f32_bf16 v198, v234, s27, v198
v_dot2_f32_bf16 v198, v235, s27, v198
v_dot2_f32_bf16 v196, v236, s27, v196
v_dot2_f32_bf16 v196, v237, s27, v196
v_dot2_f32_bf16 v196, v238, s27, v196
v_dot2_f32_bf16 v196, v239, s27, v196
v_dot2_f32_bf16 v197, v240, s27, v197
v_dot2_f32_bf16 v197, v241, s27, v197
v_dot2_f32_bf16 v197, v242, s27, v197
v_dot2_f32_bf16 v197, v243, s27, v197
v_dot2_f32_bf16 v198, v244, s27, v198
v_dot2_f32_bf16 v198, v245, s27, v198
v_dot2_f32_bf16 v198, v246, s27, v198
v_dot2_f32_bf16 v198, v247, s27, v198
v_dot2_f32_bf16 v196, v248, s27, v196
v_dot2_f32_bf16 v196, v249, s27, v196
v_dot2_f32_bf16 v196, v250, s27, v196
v_dot2_f32_bf16 v196, v251, s27, v196
v_dot2_f32_bf16 v197, v252, s27, v197
v_dot2_f32_bf16 v197, v253, s27, v197
v_dot2_f32_bf16 v197, v254, s27, v197
v_dot2_f32_bf16 v197, v255, s27, v197
v_dot2_f32_bf16 v198, v180, s27, v198
v_dot2_f32_bf16 v198, v181, s27, v198
v_dot2_f32_bf16 v198, v182, s27, v198
v_dot2_f32_bf16 v198, v183, s27, v198
v_dot2_f32_bf16 v196, v184, s27, v196
v_dot2_f32_bf16 v196, v185, s27, v196
v_dot2_f32_bf16 v196, v186, s27, v196
v_dot2_f32_bf16 v196, v187, s27, v196
v_dot2_f32_bf16 v197, v188, s27, v197
v_dot2_f32_bf16 v197, v189, s27, v197
v_dot2_f32_bf16 v197, v190, s27, v197
v_dot2_f32_bf16 v197, v191, s27, v197
v_dot2_f32_bf16 v198, v192, s27, v198
v_dot2_f32_bf16 v198, v193, s27, v198
v_dot2_f32_bf16 v198, v194, s27, v198
v_dot2_f32_bf16 v198, v195, s27, v198
s_waitcnt vmcnt(0)
v_lshlrev_b32 v20, 16, v200
v_and_b32 v21, s20, v200
v_lshlrev_b32 v22, 16, v201
v_and_b32 v23, s20, v201
v_lshlrev_b32 v24, 16, v202
v_and_b32 v25, s20, v202
v_lshlrev_b32 v26, 16, v203
v_and_b32 v27, s20, v203
v_lshlrev_b32 v28, 16, v204
v_and_b32 v29, s20, v204
v_lshlrev_b32 v30, 16, v205
v_and_b32 v31, s20, v205
v_lshlrev_b32 v32, 16, v206
v_and_b32 v33, s20, v206
v_lshlrev_b32 v34, 16, v207
v_and_b32 v35, s20, v207
v_lshlrev_b32 v36, 16, v208
v_and_b32 v37, s20, v208
v_lshlrev_b32 v38, 16, v209
v_and_b32 v39, s20, v209
L_p3_go:
s_barrier
s_cmp_ge_u32 s16, 4
s_cbranch_scc1 L_p3_help
buffer_load_dwordx4 v[100:103], v6, s[4:7], s36 offen offset:0 sc1
buffer_load_dwordx4 v[104:107], v6, s[4:7], s37 offen offset:0 sc1
buffer_load_dwordx4 v[108:111], v6, s[4:7], s36 offen offset:1024 sc1
buffer_load_dwordx4 v[112:115], v6, s[4:7], s37 offen offset:1024 sc1
buffer_load_dwordx4 v[116:119], v6, s[4:7], s36 offen offset:2048 sc1
buffer_load_dwordx4 v[120:123], v6, s[4:7], s37 offen offset:2048 sc1
buffer_load_dwordx4 v[124:127], v6, s[4:7], s36 offen offset:3072 sc1
buffer_load_dwordx4 v[128:131], v6, s[4:7], s37 offen offset:3072 sc1
s_add_u32 s36, s36, 4096
s_add_u32 s37, s37, 4096
ds_read_b128 v[60:63], v12 offset:0
ds_read_b128 v[64:67], v12 offset:1024
ds_read_b128 v[68:71], v12 offset:2048
ds_read_b128 v[72:75], v12 offset:3072
ds_read_b128 v[76:79], v12 offset:4096
s_waitcnt vmcnt(6) lgkmcnt(0)
v_mfma_f32_16x16x32_bf16 v[20:23], v[60:63], v[100:103], v[20:23]
ds_read_b128 v[80:83], v12 offset:5120
v_mfma_f32_16x16x32_bf16 v[40:43], v[60:63], v[104:107], 0
ds_read_b128 v[84:87], v12 offset:6144
v_mfma_f32_16x16x32_bf16 v[24:27], v[64:67], v[100:103], v[24:27]
ds_read_b128 v[88:91], v12 offset:7168
v_mfma_f32_16x16x32_bf16 v[44:47], v[64:67], v[104:107], 0
ds_read_b128 v[92:95], v12 offset:8192
v_mfma_f32_16x16x32_bf16 v[28:31], v[68:71], v[100:103], v[28:31]
ds_read_b128 v[96:99], v12 offset:9216
v_mfma_f32_16x16x32_bf16 v[48:51], v[68:71], v[104:107], 0
buffer_load_dwordx4 v[132:135], v6, s[4:7], s36 offen offset:0 sc1
buffer_load_dwordx4 v[136:139], v6, s[4:7], s37 offen offset:0 sc1
v_mfma_f32_16x16x32_bf16 v[32:35], v[72:75], v[100:103], v[32:35]
v_mfma_f32_16x16x32_bf16 v[52:55], v[72:75], v[104:107], 0
buffer_load_dwordx4 v[140:143], v6, s[4:7], s36 offen offset:1024 sc1
buffer_load_dwordx4 v[144:147], v6, s[4:7], s37 offen offset:1024 sc1
v_mfma_f32_16x16x32_bf16 v[36:39], v[76:79], v[100:103], v[36:39]
v_mfma_f32_16x16x32_bf16 v[56:59], v[76:79], v[104:107], 0
s_waitcnt vmcnt(8) lgkmcnt(0)
v_mfma_f32_16x16x32_bf16 v[20:23], v[80:83], v[108:111], v[20:23]
ds_read_b128 v[60:63], v12 offset:10240
v_mfma_f32_16x16x32_bf16 v[40:43], v[80:83], v[112:115], v[40:43]
ds_read_b128 v[64:67], v12 offset:11264
v_mfma_f32_16x16x32_bf16 v[24:27], v[84:87], v[108:111], v[24:27]
ds_read_b128 v[68:71], v12 offset:12288
v_mfma_f32_16x16x32_bf16 v[44:47], v[84:87], v[112:115], v[44:47]
ds_read_b128 v[72:75], v12 offset:13312
v_mfma_f32_16x16x32_bf16 v[28:31], v[88:91], v[108:111], v[28:31]
ds_read_b128 v[76:79], v12 offset:14336
v_mfma_f32_16x16x32_bf16 v[48:51], v[88:91], v[112:115], v[48:51]
buffer_load_dwordx4 v[148:151], v6, s[4:7], s36 offen offset:2048 sc1
buffer_load_dwordx4 v[152:155], v6, s[4:7], s37 offen offset:2048 sc1
v_mfma_f32_16x16x32_bf16 v[32:35], v[92:95], v[108:111], v[32:35]
v_mfma_f32_16x16x32_bf16 v[52:55], v[92:95], v[112:115], v[52:55]
buffer_load_dwordx4 v[156:159], v6, s[4:7], s36 offen offset:3072 sc1
buffer_load_dwordx4 v[160:163], v6, s[4:7], s37 offen offset:3072 sc1
s_add_u32 s36, s36, 4096
s_add_u32 s37, s37, 4096
v_mfma_f32_16x16x32_bf16 v[36:39], v[96:99], v[108:111], v[36:39]
v_mfma_f32_16x16x32_bf16 v[56:59], v[96:99], v[112:115], v[56:59]
s_waitcnt vmcnt(10) lgkmcnt(0)
v_mfma_f32_16x16x32_bf16 v[20:23], v[60:63], v[116:119], v[20:23]
ds_read_b128 v[80:83], v12 offset:15360
v_mfma_f32_16x16x32_bf16 v[40:43], v[60:63], v[120:123], v[40:43]
ds_read_b128 v[84:87], v12 offset:16384
v_mfma_f32_16x16x32_bf16 v[24:27], v[64:67], v[116:119], v[24:27]
ds_read_b128 v[88:91], v12 offset:17408
v_mfma_f32_16x16x32_bf16 v[44:47], v[64:67], v[120:123], v[44:47]
ds_read_b128 v[92:95], v12 offset:18432
v_mfma_f32_16x16x32_bf16 v[28:31], v[68:71], v[116:119], v[28:31]
ds_read_b128 v[96:99], v12 offset:19456
v_mfma_f32_16x16x32_bf16 v[48:51], v[68:71], v[120:123], v[48:51]
buffer_load_dwordx2 v[164:165], v16, s[4:7], s36 offen offset:0 sc1
buffer_load_dwordx2 v[166:167], v16, s[4:7], s36 offen offset:128 sc1
buffer_load_dwordx2 v[168:169], v16, s[4:7], s37 offen offset:0 sc1
buffer_load_dwordx2 v[170:171], v16, s[4:7], s37 offen offset:128 sc1
v_mfma_f32_16x16x32_bf16 v[32:35], v[72:75], v[116:119], v[32:35]
v_mfma_f32_16x16x32_bf16 v[52:55], v[72:75], v[120:123], v[52:55]
buffer_load_dwordx2 v[172:173], v16, s[4:7], s36 offen offset:1024 sc1
buffer_load_dwordx2 v[174:175], v16, s[4:7], s36 offen offset:1152 sc1
buffer_load_dwordx2 v[176:177], v16, s[4:7], s37 offen offset:1024 sc1
buffer_load_dwordx2 v[178:179], v16, s[4:7], s37 offen offset:1152 sc1
v_mfma_f32_16x16x32_bf16 v[36:39], v[76:79], v[116:119], v[36:39]
v_mfma_f32_16x16x32_bf16 v[56:59], v[76:79], v[120:123], v[56:59]
s_waitcnt vmcnt(16) lgkmcnt(0)
v_mfma_f32_16x16x32_bf16 v[20:23], v[80:83], v[124:127], v[20:23]
ds_read_b128 v[60:63], v12 offset:20480
v_mfma_f32_16x16x32_bf16 v[40:43], v[80:83], v[128:131], v[40:43]
ds_read_b128 v[64:67], v12 offset:21504
v_mfma_f32_16x16x32_bf16 v[24:27], v[84:87], v[124:127], v[24:27]
ds_read_b128 v[68:71], v12 offset:22528
v_mfma_f32_16x16x32_bf16 v[44:47], v[84:87], v[128:131], v[44:47]
ds_read_b128 v[72:75], v12 offset:23552
v_mfma_f32_16x16x32_bf16 v[28:31], v[88:91], v[124:127], v[28:31]
ds_read_b128 v[76:79], v12 offset:24576
v_mfma_f32_16x16x32_bf16 v[48:51], v[88:91], v[128:131], v[48:51]
v_mfma_f32_16x16x32_bf16 v[32:35], v[92:95], v[124:127], v[32:35]
v_mfma_f32_16x16x32_bf16 v[52:55], v[92:95], v[128:131], v[52:55]
v_mfma_f32_16x16x32_bf16 v[36:39], v[96:99], v[124:127], v[36:39]
v_mfma_f32_16x16x32_bf16 v[56:59], v[96:99], v[128:131], v[56:59]
s_waitcnt vmcnt(14) lgkmcnt(0)
v_mfma_f32_16x16x32_bf16 v[20:23], v[60:63], v[132:135], v[20:23]
ds_read_b128 v[80:83], v12 offset:25600
v_mfma_f32_16x16x32_bf16 v[40:43], v[60:63], v[136:139], v[40:43]
ds_read_b128 v[84:87], v12 offset:26624
v_mfma_f32_16x16x32_bf16 v[24:27], v[64:67], v[132:135], v[24:27]
ds_read_b128 v[88:91], v12 offset:27648
v_mfma_f32_16x16x32_bf16 v[44:47], v[64:67], v[136:139], v[44:47]
ds_read_b128 v[92:95], v12 offset:28672
v_mfma_f32_16x16x32_bf16 v[28:31], v[68:71], v[132:135], v[28:31]
ds_read_b128 v[96:99], v12 offset:29696
v_mfma_f32_16x16x32_bf16 v[48:51], v[68:71], v[136:139], v[48:51]
v_mfma_f32_16x16x32_bf16 v[32:35], v[72:75], v[132:135], v[32:35]
v_mfma_f32_16x16x32_bf16 v[52:55], v[72:75], v[136:139], v[52:55]
v_mfma_f32_16x16x32_bf16 v[36:39], v[76:79], v[132:135], v[36:39]
v_mfma_f32_16x16x32_bf16 v[56:59], v[76:79], v[136:139], v[56:59]
s_waitcnt vmcnt(12) lgkmcnt(0)
v_mfma_f32_16x16x32_bf16 v[20:23], v[80:83], v[140:143], v[20:23]
ds_read_b128 v[60:63], v12 offset:30720
v_mfma_f32_16x16x32_bf16 v[40:43], v[80:83], v[144:147], v[40:43]
ds_read_b128 v[64:67], v12 offset:31744
v_mfma_f32_16x16x32_bf16 v[24:27], v[84:87], v[140:143], v[24:27]
ds_read_b128 v[68:71], v12 offset:32768
v_mfma_f32_16x16x32_bf16 v[44:47], v[84:87], v[144:147], v[44:47]
ds_read_b128 v[72:75], v12 offset:33792
v_mfma_f32_16x16x32_bf16 v[28:31], v[88:91], v[140:143], v[28:31]
ds_read_b128 v[76:79], v12 offset:34816
v_mfma_f32_16x16x32_bf16 v[48:51], v[88:91], v[144:147], v[48:51]
v_mfma_f32_16x16x32_bf16 v[32:35], v[92:95], v[140:143], v[32:35]
v_mfma_f32_16x16x32_bf16 v[52:55], v[92:95], v[144:147], v[52:55]
v_mfma_f32_16x16x32_bf16 v[36:39], v[96:99], v[140:143], v[36:39]
v_mfma_f32_16x16x32_bf16 v[56:59], v[96:99], v[144:147], v[56:59]
s_waitcnt vmcnt(10) lgkmcnt(0)
v_mfma_f32_16x16x32_bf16 v[20:23], v[60:63], v[148:151], v[20:23]
ds_read_b128 v[80:83], v12 offset:35840
v_mfma_f32_16x16x32_bf16 v[40:43], v[60:63], v[152:155], v[40:43]
ds_read_b128 v[84:87], v12 offset:36864
v_mfma_f32_16x16x32_bf16 v[24:27], v[64:67], v[148:151], v[24:27]
ds_read_b128 v[88:91], v12 offset:37888
v_mfma_f32_16x16x32_bf16 v[44:47], v[64:67], v[152:155], v[44:47]
ds_read_b128 v[92:95], v12 offset:38912
v_mfma_f32_16x16x32_bf16 v[28:31], v[68:71], v[148:151], v[28:31]
ds_read_b128 v[96:99], v12 offset:39936
v_mfma_f32_16x16x32_bf16 v[48:51], v[68:71], v[152:155], v[48:51]
v_mfma_f32_16x16x32_bf16 v[32:35], v[72:75], v[148:151], v[32:35]
v_mfma_f32_16x16x32_bf16 v[52:55], v[72:75], v[152:155], v[52:55]
v_mfma_f32_16x16x32_bf16 v[36:39], v[76:79], v[148:151], v[36:39]
v_mfma_f32_16x16x32_bf16 v[56:59], v[76:79], v[152:155], v[56:59]
s_waitcnt vmcnt(8) lgkmcnt(0)
v_mfma_f32_16x16x32_bf16 v[20:23], v[80:83], v[156:159], v[20:23]
ds_read_b128 v[60:63], v13 offset:0
v_mfma_f32_16x16x32_bf16 v[40:43], v[80:83], v[160:163], v[40:43]
ds_read_b128 v[64:67], v13 offset:1024
v_mfma_f32_16x16x32_bf16 v[24:27], v[84:87], v[156:159], v[24:27]
ds_read_b128 v[68:71], v13 offset:2048
v_mfma_f32_16x16x32_bf16 v[44:47], v[84:87], v[160:163], v[44:47]
ds_read_b128 v[72:75], v13 offset:3072
v_mfma_f32_16x16x32_bf16 v[28:31], v[88:91], v[156:159], v[28:31]
ds_read_b128 v[76:79], v13 offset:4096
v_mfma_f32_16x16x32_bf16 v[48:51], v[88:91], v[160:163], v[48:51]
v_mfma_f32_16x16x32_bf16 v[32:35], v[92:95], v[156:159], v[32:35]
v_mfma_f32_16x16x32_bf16 v[52:55], v[92:95], v[160:163], v[52:55]
v_mfma_f32_16x16x32_bf16 v[36:39], v[96:99], v[156:159], v[36:39]
v_mfma_f32_16x16x32_bf16 v[56:59], v[96:99], v[160:163], v[56:59]
s_waitcnt vmcnt(4) lgkmcnt(0)
v_mfma_f32_16x16x32_bf16 v[20:23], v[60:63], v[164:167], v[20:23]
ds_read_b128 v[80:83], v13 offset:5120
v_mfma_f32_16x16x32_bf16 v[40:43], v[60:63], v[168:171], v[40:43]
ds_read_b128 v[84:87], v13 offset:6144
v_mfma_f32_16x16x32_bf16 v[24:27], v[64:67], v[164:167], v[24:27]
ds_read_b128 v[88:91], v13 offset:7168
v_mfma_f32_16x16x32_bf16 v[44:47], v[64:67], v[168:171], v[44:47]
ds_read_b128 v[92:95], v13 offset:8192
v_mfma_f32_16x16x32_bf16 v[28:31], v[68:71], v[164:167], v[28:31]
ds_read_b128 v[96:99], v13 offset:9216
v_mfma_f32_16x16x32_bf16 v[48:51], v[68:71], v[168:171], v[48:51]
v_mfma_f32_16x16x32_bf16 v[32:35], v[72:75], v[164:167], v[32:35]
v_mfma_f32_16x16x32_bf16 v[52:55], v[72:75], v[168:171], v[52:55]
v_mfma_f32_16x16x32_bf16 v[36:39], v[76:79], v[164:167], v[36:39]
v_mfma_f32_16x16x32_bf16 v[56:59], v[76:79], v[168:171], v[56:59]
s_waitcnt vmcnt(0) lgkmcnt(0)
v_mfma_f32_16x16x32_bf16 v[20:23], v[80:83], v[172:175], v[20:23]
v_mfma_f32_16x16x32_bf16 v[40:43], v[80:83], v[176:179], v[40:43]
v_mfma_f32_16x16x32_bf16 v[24:27], v[84:87], v[172:175], v[24:27]
v_mfma_f32_16x16x32_bf16 v[44:47], v[84:87], v[176:179], v[44:47]
v_mfma_f32_16x16x32_bf16 v[28:31], v[88:91], v[172:175], v[28:31]
v_mfma_f32_16x16x32_bf16 v[48:51], v[88:91], v[176:179], v[48:51]
v_mfma_f32_16x16x32_bf16 v[32:35], v[92:95], v[172:175], v[32:35]
v_mfma_f32_16x16x32_bf16 v[52:55], v[92:95], v[176:179], v[52:55]
v_mfma_f32_16x16x32_bf16 v[36:39], v[96:99], v[172:175], v[36:39]
v_mfma_f32_16x16x32_bf16 v[56:59], v[96:99], v[176:179], v[56:59]
s_mul_i32 s24, s16, 5120
s_add_u32 s24, s24, 0
v_add_u32 v1, s24, v6
s_xor_b32 s25, s16, 2
s_mul_i32 s25, s25, 5120
s_add_u32 s25, s25, 0
v_add_u32 v2, s25, v6
ds_write_b128 v1, v[40:43] offset:0
ds_write_b128 v1, v[44:47] offset:1024
ds_write_b128 v1, v[48:51] offset:2048
ds_write_b128 v1, v[52:55] offset:3072
ds_write_b128 v1, v[56:59] offset:4096
s_waitcnt lgkmcnt(0)
s_barrier
ds_read_b128 v[40:43], v2 offset:0
ds_read_b128 v[44:47], v2 offset:1024
ds_read_b128 v[48:51], v2 offset:2048
ds_read_b128 v[52:55], v2 offset:3072
ds_read_b128 v[56:59], v2 offset:4096
s_waitcnt lgkmcnt(4)
v_pk_add_f32 v[20:21], v[20:21], v[40:41]
v_pk_add_f32 v[22:23], v[22:23], v[42:43]
v_cvt_pk_bf16_f32 v200, v20, v21
v_cvt_pk_bf16_f32 v201, v22, v23
s_waitcnt lgkmcnt(3)
v_pk_add_f32 v[24:25], v[24:25], v[44:45]
v_pk_add_f32 v[26:27], v[26:27], v[46:47]
v_cvt_pk_bf16_f32 v202, v24, v25
v_cvt_pk_bf16_f32 v203, v26, v27
s_waitcnt lgkmcnt(2)
v_pk_add_f32 v[28:29], v[28:29], v[48:49]
v_pk_add_f32 v[30:31], v[30:31], v[50:51]
v_cvt_pk_bf16_f32 v204, v28, v29
v_cvt_pk_bf16_f32 v205, v30, v31
s_waitcnt lgkmcnt(1)
v_pk_add_f32 v[32:33], v[32:33], v[52:53]
v_pk_add_f32 v[34:35], v[34:35], v[54:55]
v_cvt_pk_bf16_f32 v206, v32, v33
v_cvt_pk_bf16_f32 v207, v34, v35
s_waitcnt lgkmcnt(0)
v_pk_add_f32 v[36:37], v[36:37], v[56:57]
v_pk_add_f32 v[38:39], v[38:39], v[58:59]
v_cvt_pk_bf16_f32 v208, v36, v37
v_cvt_pk_bf16_f32 v209, v38, v39
buffer_store_dwordx4 v[200:203], v14, s[4:7], 0 offen sc1
buffer_store_dwordx4 v[204:207], v14, s[4:7], 0 offen offset:1024 sc1
v_mov_b32 v100, v208
v_mov_b32 v101, v209
v_mov_b32 v102, v208
v_mov_b32 v103, v209
s_mov_b32 s26, 0xffff
s_mov_b32 s27, 0xffff
v_permlane16_swap_b32 v100, v102
v_permlane16_swap_b32 v101, v103
s_mov_b64 exec, s[26:27]
buffer_store_dwordx4 v[100:103], v15, s[4:7], 0 offen sc1
s_mov_b64 exec, -1
v_pk_add_f32 v[60:61], v[20:21], v[22:23]
v_pk_mul_f32 v[62:63], v[20:21], v[20:21]
v_pk_fma_f32 v[62:63], v[22:23], v[22:23], v[62:63]
v_pk_add_f32 v[60:61], v[60:61], v[24:25]
v_pk_fma_f32 v[62:63], v[24:25], v[24:25], v[62:63]
v_pk_add_f32 v[60:61], v[60:61], v[26:27]
v_pk_fma_f32 v[62:63], v[26:27], v[26:27], v[62:63]
v_pk_add_f32 v[60:61], v[60:61], v[28:29]
v_pk_fma_f32 v[62:63], v[28:29], v[28:29], v[62:63]
v_pk_add_f32 v[60:61], v[60:61], v[30:31]
v_pk_fma_f32 v[62:63], v[30:31], v[30:31], v[62:63]
v_pk_add_f32 v[60:61], v[60:61], v[32:33]
v_pk_fma_f32 v[62:63], v[32:33], v[32:33], v[62:63]
v_pk_add_f32 v[60:61], v[60:61], v[34:35]
v_pk_fma_f32 v[62:63], v[34:35], v[34:35], v[62:63]
v_pk_add_f32 v[60:61], v[60:61], v[36:37]
v_pk_fma_f32 v[62:63], v[36:37], v[36:37], v[62:63]
v_pk_add_f32 v[60:61], v[60:61], v[38:39]
v_pk_fma_f32 v[62:63], v[38:39], v[38:39], v[62:63]
v_add_f32 v60, v60, v61
v_add_f32 v62, v62, v63
s_nop 1
v_permlane16_swap_b32 v60, v62
v_add_f32 v60, v60, v62
v_mov_b32 v62, v60
s_nop 1
v_permlane32_swap_b32 v60, v62
v_add_f32 v60, v60, v62
v_mov_b32 v61, v60
s_nop 1
v_permlane16_swap_b32 v60, v61
s_mov_b64 exec, 0xffff
buffer_store_dwordx2 v[60:61], v17, s[4:7], 0 offen sc1
s_mov_b64 exec, -1
s_branch L_p3_done
L_p3_help:
s_cmp_eq_u32 s16, 7
s_cbranch_scc1 L_p3_h7
v_mov_b32 v20, v212
v_mov_b32 v21, v213
v_mov_b32 v22, v214
v_mov_b32 v23, v215
v_mov_b32 v24, v216
v_mov_b32 v25, v217
v_mov_b32 v26, v218
v_mov_b32 v27, v219
v_mov_b32 v28, v220
v_mov_b32 v29, v221
v_mov_b32 v30, v222
v_mov_b32 v31, v223
v_mov_b32 v32, v224
v_mov_b32 v33, v225
v_mov_b32 v34, v226
v_mov_b32 v35, v227
v_mov_b32 v36, v228
v_mov_b32 v37, v229
v_mov_b32 v38, v230
v_mov_b32 v39, v231
v_mov_b32 v40, v232
v_mov_b32 v41, v233
v_mov_b32 v42, v234
v_mov_b32 v43, v235
v_mov_b32 v44, v236
v_mov_b32 v45, v237
v_mov_b32 v46, v238
v_mov_b32 v47, v239
v_mov_b32 v48, v240
v_mov_b32 v49, v241
v_mov_b32 v50, v242
v_mov_b32 v51, v243
v_mov_b32 v52, v244
v_mov_b32 v53, v245
v_mov_b32 v54, v246
v_mov_b32 v55, v247
v_mov_b32 v56, v248
v_mov_b32 v57, v249
v_mov_b32 v58, v250
v_mov_b32 v59, v251
v_mov_b32 v60, v252
v_mov_b32 v61, v253
v_mov_b32 v62, v254
v_mov_b32 v63, v255
v_mov_b32 v64, v180
v_mov_b32 v65, v181
v_mov_b32 v66, v182
v_mov_b32 v67, v183
v_mov_b32 v68, v184
v_mov_b32 v69, v185
v_mov_b32 v70, v186
v_mov_b32 v71, v187
v_mov_b32 v72, v188
v_mov_b32 v73, v189
v_mov_b32 v74, v190
v_mov_b32 v75, v191
v_mov_b32 v76, v192
v_mov_b32 v77, v193
v_mov_b32 v78, v194
v_mov_b32 v79, v195
s_lshr_b32 s24, s19, 2
s_mul_i32 s3, s24, 245760
s_lshl_b32 s25, s16, 10
s_add_u32 s3, s3, s25
s_add_u32 s3, s3, 25863168
buffer_load_dwordx4 v[168:171], v6, s[4:7], s3 offen sc1
s_add_u32 s3, s3, 3072
buffer_load_dwordx4 v[172:175], v6, s[4:7], s3 offen sc1
s_add_u32 s3, s3, 3072
buffer_load_dwordx4 v[176:179], v6, s[4:7], s3 offen sc1
s_add_u32 s3, s3, 3072
buffer_load_dwordx4 v[180:183], v6, s[4:7], s3 offen sc1
s_add_u32 s3, s3, 3072
buffer_load_dwordx4 v[184:187], v6, s[4:7], s3 offen sc1
s_add_u32 s3, s3, 3072
buffer_load_dwordx4 v[188:191], v6, s[4:7], s3 offen sc1
s_add_u32 s3, s3, 3072
buffer_load_dwordx4 v[192:195], v6, s[4:7], s3 offen sc1
s_add_u32 s3, s3, 3072
buffer_load_dwordx4 v[200:203], v6, s[4:7], s3 offen sc1
s_add_u32 s3, s3, 3072
buffer_load_dwordx4 v[204:207], v6, s[4:7], s3 offen sc1
s_add_u32 s3, s3, 3072
buffer_load_dwordx4 v[208:211], v6, s[4:7], s3 offen sc1
s_add_u32 s3, s3, 3072
buffer_load_dwordx4 v[212:215], v6, s[4:7], s3 offen sc1
s_add_u32 s3, s3, 3072
buffer_load_dwordx4 v[216:219], v6, s[4:7], s3 offen sc1
s_add_u32 s3, s3, 3072
buffer_load_dwordx4 v[220:223], v6, s[4:7], s3 offen sc1
s_add_u32 s3, s3, 3072
buffer_load_dwordx4 v[224:227], v6, s[4:7], s3 offen sc1
s_add_u32 s3, s3, 3072
buffer_load_dwordx4 v[228:231], v6, s[4:7], s3 offen sc1
s_add_u32 s3, s3, 3072
buffer_load_dwordx4 v[232:235], v6, s[4:7], s3 offen sc1
s_add_u32 s3, s3, 3072
buffer_load_dwordx4 v[236:239], v6, s[4:7], s3 offen sc1
s_add_u32 s3, s3, 3072
buffer_load_dwordx4 v[240:243], v6, s[4:7], s3 offen sc1
s_add_u32 s3, s3, 3072
s_barrier
s_lshl_b32 s24, s16, 10
s_add_u32 s24, s24, 20480
v_add_u32 v1, s24, v6
v_add_u32 v2, 65536, v1
ds_write_b128 v1, v[20:23] offset:0
ds_write_b128 v1, v[24:27] offset:8192
ds_write_b128 v1, v[28:31] offset:16384
ds_write_b128 v1, v[32:35] offset:24576
ds_write_b128 v1, v[36:39] offset:32768
ds_write_b128 v1, v[40:43] offset:40960
ds_write_b128 v1, v[44:47] offset:49152
ds_write_b128 v1, v[48:51] offset:57344
ds_write_b128 v2, v[52:55] offset:0
ds_write_b128 v2, v[56:59] offset:8192
ds_write_b128 v2, v[60:63] offset:16384
ds_write_b128 v2, v[64:67] offset:24576
ds_write_b128 v2, v[68:71] offset:32768
ds_write_b128 v2, v[72:75] offset:40960
ds_write_b128 v2, v[76:79] offset:49152
s_branch L_p3_done
L_p3_h7:
s_barrier
s_lshl_b32 s24, s16, 10
s_add_u32 s24, s24, 20480
v_add_u32 v1, s24, v6
v_add_u32 v2, 65536, v1
ds_write_b128 v1, v[212:215] offset:0
ds_write_b128 v1, v[216:219] offset:8192
ds_write_b128 v1, v[220:223] offset:16384
ds_write_b128 v1, v[224:227] offset:24576
ds_write_b128 v1, v[228:231] offset:32768
ds_write_b128 v1, v[232:235] offset:40960
ds_write_b128 v1, v[236:239] offset:49152
ds_write_b128 v1, v[240:243] offset:57344
ds_write_b128 v2, v[244:247] offset:0
ds_write_b128 v2, v[248:251] offset:8192
ds_write_b128 v2, v[252:255] offset:16384
ds_write_b128 v2, v[180:183] offset:24576
ds_write_b128 v2, v[184:187] offset:32768
ds_write_b128 v2, v[188:191] offset:40960
ds_write_b128 v2, v[192:195] offset:49152
s_mov_b32 s27, 0x3f803f80
v_mov_b32 v196, 0
v_mov_b32 v197, 0
v_mov_b32 v198, 0
v_dot2_f32_bf16 v196, v212, s27, v196
v_dot2_f32_bf16 v196, v213, s27, v196
v_dot2_f32_bf16 v196, v214, s27, v196
v_dot2_f32_bf16 v196, v215, s27, v196
v_dot2_f32_bf16 v197, v216, s27, v197
v_dot2_f32_bf16 v197, v217, s27, v197
v_dot2_f32_bf16 v197, v218, s27, v197
v_dot2_f32_bf16 v197, v219, s27, v197
v_dot2_f32_bf16 v198, v220, s27, v198
v_dot2_f32_bf16 v198, v221, s27, v198
v_dot2_f32_bf16 v198, v222, s27, v198
v_dot2_f32_bf16 v198, v223, s27, v198
v_dot2_f32_bf16 v196, v224, s27, v196
v_dot2_f32_bf16 v196, v225, s27, v196
v_dot2_f32_bf16 v196, v226, s27, v196
v_dot2_f32_bf16 v196, v227, s27, v196
v_dot2_f32_bf16 v197, v228, s27, v197
v_dot2_f32_bf16 v197, v229, s27, v197
v_dot2_f32_bf16 v197, v230, s27, v197
v_dot2_f32_bf16 v197, v231, s27, v197
v_dot2_f32_bf16 v198, v232, s27, v198
v_dot2_f32_bf16 v198, v233, s27, v198
v_dot2_f32_bf16 v198, v234, s27, v198
v_dot2_f32_bf16 v198, v235, s27, v198
v_dot2_f32_bf16 v196, v236, s27, v196
v_dot2_f32_bf16 v196, v237, s27, v196
v_dot2_f32_bf16 v196, v238, s27, v196
v_dot2_f32_bf16 v196, v239, s27, v196
v_dot2_f32_bf16 v197, v240, s27, v197
v_dot2_f32_bf16 v197, v241, s27, v197
v_dot2_f32_bf16 v197, v242, s27, v197
v_dot2_f32_bf16 v197, v243, s27, v197
v_dot2_f32_bf16 v198, v244, s27, v198
v_dot2_f32_bf16 v198, v245, s27, v198
v_dot2_f32_bf16 v198, v246, s27, v198
v_dot2_f32_bf16 v198, v247, s27, v198
v_dot2_f32_bf16 v196, v248, s27, v196
v_dot2_f32_bf16 v196, v249, s27, v196
v_dot2_f32_bf16 v196, v250, s27, v196
v_dot2_f32_bf16 v196, v251, s27, v196
v_dot2_f32_bf16 v197, v252, s27, v197
v_dot2_f32_bf16 v197, v253, s27, v197
v_dot2_f32_bf16 v197, v254, s27, v197
v_dot2_f32_bf16 v197, v255, s27, v197
v_dot2_f32_bf16 v198, v180, s27, v198
v_dot2_f32_bf16 v198, v181, s27, v198
v_dot2_f32_bf16 v198, v182, s27, v198
v_dot2_f32_bf16 v198, v183, s27, v198
v_dot2_f32_bf16 v196, v184, s27, v196
v_dot2_f32_bf16 v196, v185, s27, v196
v_dot2_f32_bf16 v196, v186, s27, v196
v_dot2_f32_bf16 v196, v187, s27, v196
v_dot2_f32_bf16 v197, v188, s27, v197
v_dot2_f32_bf16 v197, v189, s27, v197
v_dot2_f32_bf16 v197, v190, s27, v197
v_dot2_f32_bf16 v197, v191, s27, v197
v_dot2_f32_bf16 v198, v192, s27, v198
v_dot2_f32_bf16 v198, v193, s27, v198
v_dot2_f32_bf16 v198, v194, s27, v198
v_dot2_f32_bf16 v198, v195, s27, v198
L_p3_done:
s_lshr_b32 s25, s16, 1
s_lshl_b32 s25, s25, 8
s_add_u32 s25, s25, 155648
v_lshl_add_u32 v1, v0, 2, s25
s_mov_b32 s24, s16
s_cmp_ge_u32 s24, 6
s_cselect_b32 s25, 6, 0
s_sub_u32 s24, s24, s25
s_lshl_b32 s25, s24, 10
v_add_u32 v2, s25, v1
ds_write_b32 v2, v196
s_add_u32 s24, s24, 2
s_cmp_ge_u32 s24, 6
s_cselect_b32 s25, 6, 0
s_sub_u32 s24, s24, s25
s_lshl_b32 s25, s24, 10
v_add_u32 v2, s25, v1
ds_write_b32 v2, v197
s_add_u32 s24, s24, 2
s_cmp_ge_u32 s24, 6
s_cselect_b32 s25, 6, 0
s_sub_u32 s24, s24, s25
s_lshl_b32 s25, s24, 10
v_add_u32 v2, s25, v1
ds_write_b32 v2, v198
s_add_u32 s24, s24, 2
s_lshl_b32 s26, s18, 3
s_add_u32 s26, s26, s16
s_mul_i32 s28, s26, 40960
s_add_u32 s28, s28, 12058624
s_add_u32 s29, s28, 20480
v_and_b32 v3, 15, v0
v_lshrrev_b32 v4, 4, v0
v_lshlrev_b32 v16, 3, v3
v_lshl_add_u32 v16, v4, 8, v16
s_lshl_b32 s30, s26, 11
s_add_u32 s30, s30, 27688960
v_add_u32 v12, 20480, v6
v_add_u32 v13, 81920, v6
v_bfe_u32 v2, v0, 4, 1
v_mul_u32_u24 v2, 49152, v2
v_lshl_add_u32 v2, v3, 4, v2
v_lshl_add_u32 v2, v7, 8, v2
s_mul_i32 s24, s26, 98304
s_mul_i32 s25, s19, 1536
s_add_u32 s24, s24, s25
s_add_u32 s24, s24, 14680064
v_add_u32 v15, s24, v2
v_lshlrev_b32 v17, 4, v4
v_add_u32 v17, 161792, v17
s_lshl_b32 s25, s18, 10
v_lshlrev_b32 v10, 13, v0
s_lshl_b32 s24, s19, 2
s_add_u32 s24, s24, s25
s_add_u32 s47, s24, 27853312
v_mov_b32 v9, s17
s_cmp_ge_u32 s16, 4
s_cbranch_scc1 L_p4_c1
s_waitcnt vmcnt(0) lgkmcnt(0)
L_p4_c1:
s_waitcnt lgkmcnt(0)
s_barrier
s_cmp_lg_u32 s16, 7
s_cbranch_scc1 L_p4_nosync
s_mov_b32 exec_hi, 0
buffer_atomic_swap v9, v10, s[4:7], s47 offen sc1
s_lshl_b32 s25, s2, 10
s_add_u32 s25, s25, 27853312
v_lshlrev_b32 v10, 2, v0
s_movk_i32 s24, 20000
L_poll_11:
v_mov_b32 v1, 0
buffer_atomic_or v1, v10, s[4:7], s25 offen sc0 sc1
s_sub_u32 s24, s24, 1
s_cbranch_scc1 L_pollok_12
s_waitcnt vmcnt(0)
v_cmp_ne_u32 vcc, s17, v1
s_cbranch_vccnz L_poll_11
L_pollok_12:
s_waitcnt vmcnt(0)
s_mov_b64 exec, -1
s_branch L_p4_go
L_p4_nosync:
s_cmp_eq_u32 s16, 6
s_cbranch_scc1 L_p4_go
s_lshl_b32 s24, s16, 10
s_add_u32 s24, s24, 155648
v_lshl_add_u32 v1, v0, 2, s24
ds_read_b32 v116, v1 offset:0
ds_read_b32 v117, v1 offset:256
ds_read_b32 v118, v1 offset:512
ds_read_b32 v119, v1 offset:768
s_lshl_b32 s24, s16, 6
s_add_u32 s24, s24, 161792
v_lshl_add_u32 v1, v3, 2, s24
s_waitcnt lgkmcnt(0)
v_add_f32 v116, v116, v117
v_add_f32 v118, v118, v119
v_add_f32 v116, v116, v118
v_mov_b32 v117, v116
s_nop 1
v_permlane32_swap_b32 v116, v117
v_add_f32 v116, v116, v117
v_mov_b32 v117, v116
s_nop 1
v_permlane16_swap_b32 v116, v117
v_add_f32 v116, v116, v117
ds_write_b32 v1, v116
s_cmp_ge_u32 s16, 4
s_cbranch_scc1 L_p4_wait
s_lshl_b32 s24, s16, 10
s_add_u32 s24, s24, 20480
v_add_u32 v1, s24, v6
v_add_u32 v2, 65536, v1
ds_write_b128 v1, v[212:215] offset:0
ds_write_b128 v1, v[216:219] offset:8192
ds_write_b128 v1, v[220:223] offset:16384
ds_write_b128 v1, v[224:227] offset:24576
ds_write_b128 v1, v[228:231] offset:32768
ds_write_b128 v1, v[232:235] offset:40960
ds_write_b128 v1, v[236:239] offset:49152
ds_write_b128 v1, v[240:243] offset:57344
ds_write_b128 v2, v[244:247] offset:0
ds_write_b128 v2, v[248:251] offset:8192
ds_write_b128 v2, v[252:255] offset:16384
ds_write_b128 v2, v[180:183] offset:24576
ds_write_b128 v2, v[184:187] offset:32768
ds_write_b128 v2, v[188:191] offset:40960
ds_write_b128 v2, v[192:195] offset:49152
L_p4_wait:
s_waitcnt lgkmcnt(0)
L_p4_go:
s_barrier
s_cmp_ge_u32 s16, 4
s_cbranch_scc1 L_p4_pk
s_setprio 1
buffer_load_dwordx4 v[116:119], v6, s[4:7], s28 offen offset:0 sc1
buffer_load_dwordx4 v[120:123], v6, s[4:7], s29 offen offset:0 sc1
buffer_load_dwordx4 v[124:127], v6, s[4:7], s28 offen offset:1024 sc1
buffer_load_dwordx4 v[128:131], v6, s[4:7], s29 offen offset:1024 sc1
buffer_load_dwordx4 v[132:135], v6, s[4:7], s28 offen offset:2048 sc1
buffer_load_dwordx4 v[136:139], v6, s[4:7], s29 offen offset:2048 sc1
buffer_load_dwordx4 v[140:143], v6, s[4:7], s28 offen offset:3072 sc1
s_add_u32 s28, s28, 4096
buffer_load_dwordx4 v[144:147], v6, s[4:7], s29 offen offset:3072 sc1
s_add_u32 s29, s29, 4096
ds_read_b128 v[68:71], v12 offset:0
ds_read_b128 v[72:75], v12 offset:1024
ds_read_b128 v[76:79], v12 offset:2048
ds_read_b128 v[80:83], v12 offset:3072
ds_read_b128 v[84:87], v12 offset:4096
ds_read_b128 v[88:91], v12 offset:5120
s_waitcnt vmcnt(6) lgkmcnt(0)
v_mfma_f32_16x16x32_bf16 v[20:23], v[68:71], v[116:119], 0
ds_read_b128 v[92:95], v12 offset:6144
v_mfma_f32_16x16x32_bf16 v[24:27], v[68:71], v[120:123], 0
ds_read_b128 v[96:99], v12 offset:7168
v_mfma_f32_16x16x32_bf16 v[28:31], v[72:75], v[116:119], 0
ds_read_b128 v[100:103], v12 offset:8192
v_mfma_f32_16x16x32_bf16 v[32:35], v[72:75], v[120:123], 0
ds_read_b128 v[104:107], v12 offset:9216
v_mfma_f32_16x16x32_bf16 v[36:39], v[76:79], v[116:119], 0
ds_read_b128 v[108:111], v12 offset:10240
v_mfma_f32_16x16x32_bf16 v[40:43], v[76:79], v[120:123], 0
ds_read_b128 v[112:115], v12 offset:11264
v_mfma_f32_16x16x32_bf16 v[44:47], v[80:83], v[116:119], 0
buffer_load_dwordx4 v[148:151], v6, s[4:7], s28 offen offset:0 sc1
v_mfma_f32_16x16x32_bf16 v[48:51], v[80:83], v[120:123], 0
v_mfma_f32_16x16x32_bf16 v[52:55], v[84:87], v[116:119], 0
buffer_load_dwordx4 v[152:155], v6, s[4:7], s29 offen offset:0 sc1
v_mfma_f32_16x16x32_bf16 v[56:59], v[84:87], v[120:123], 0
v_mfma_f32_16x16x32_bf16 v[60:63], v[88:91], v[116:119], 0
buffer_load_dwordx4 v[156:159], v6, s[4:7], s28 offen offset:1024 sc1
v_mfma_f32_16x16x32_bf16 v[64:67], v[88:91], v[120:123], 0
s_waitcnt vmcnt(7) lgkmcnt(0)
v_mfma_f32_16x16x32_bf16 v[20:23], v[92:95], v[124:127], v[20:23]
ds_read_b128 v[68:71], v12 offset:12288
v_mfma_f32_16x16x32_bf16 v[24:27], v[92:95], v[128:131], v[24:27]
ds_read_b128 v[72:75], v12 offset:13312
v_mfma_f32_16x16x32_bf16 v[28:31], v[96:99], v[124:127], v[28:31]
ds_read_b128 v[76:79], v12 offset:14336
v_mfma_f32_16x16x32_bf16 v[32:35], v[96:99], v[128:131], v[32:35]
ds_read_b128 v[80:83], v12 offset:15360
v_mfma_f32_16x16x32_bf16 v[36:39], v[100:103], v[124:127], v[36:39]
ds_read_b128 v[84:87], v12 offset:16384
v_mfma_f32_16x16x32_bf16 v[40:43], v[100:103], v[128:131], v[40:43]
ds_read_b128 v[88:91], v12 offset:17408
v_mfma_f32_16x16x32_bf16 v[44:47], v[104:107], v[124:127], v[44:47]
buffer_load_dwordx4 v[160:163], v6, s[4:7], s29 offen offset:1024 sc1
v_mfma_f32_16x16x32_bf16 v[48:51], v[104:107], v[128:131], v[48:51]
v_mfma_f32_16x16x32_bf16 v[52:55], v[108:111], v[124:127], v[52:55]
buffer_load_dwordx4 v[116:119], v6, s[4:7], s28 offen offset:2048 sc1
v_mfma_f32_16x16x32_bf16 v[56:59], v[108:111], v[128:131], v[56:59]
v_mfma_f32_16x16x32_bf16 v[60:63], v[112:115], v[124:127], v[60:63]
buffer_load_dwordx4 v[120:123], v6, s[4:7], s29 offen offset:2048 sc1
v_mfma_f32_16x16x32_bf16 v[64:67], v[112:115], v[128:131], v[64:67]
s_waitcnt vmcnt(8) lgkmcnt(0)
v_mfma_f32_16x16x32_bf16 v[20:23], v[68:71], v[132:135], v[20:23]
ds_read_b128 v[92:95], v12 offset:18432
v_mfma_f32_16x16x32_bf16 v[24:27], v[68:71], v[136:139], v[24:27]
ds_read_b128 v[96:99], v12 offset:19456
v_mfma_f32_16x16x32_bf16 v[28:31], v[72:75], v[132:135], v[28:31]
ds_read_b128 v[100:103], v12 offset:20480
v_mfma_f32_16x16x32_bf16 v[32:35], v[72:75], v[136:139], v[32:35]
ds_read_b128 v[104:107], v12 offset:21504
v_mfma_f32_16x16x32_bf16 v[36:39], v[76:79], v[132:135], v[36:39]
ds_read_b128 v[108:111], v12 offset:22528
v_mfma_f32_16x16x32_bf16 v[40:43], v[76:79], v[136:139], v[40:43]
ds_read_b128 v[112:115], v12 offset:23552
v_mfma_f32_16x16x32_bf16 v[44:47], v[80:83], v[132:135], v[44:47]
buffer_load_dwordx4 v[124:127], v6, s[4:7], s28 offen offset:3072 sc1
s_add_u32 s28, s28, 4096
v_mfma_f32_16x16x32_bf16 v[48:51], v[80:83], v[136:139], v[48:51]
v_mfma_f32_16x16x32_bf16 v[52:55], v[84:87], v[132:135], v[52:55]
buffer_load_dwordx4 v[128:131], v6, s[4:7], s29 offen offset:3072 sc1
s_add_u32 s29, s29, 4096
v_mfma_f32_16x16x32_bf16 v[56:59], v[84:87], v[136:139], v[56:59]
v_mfma_f32_16x16x32_bf16 v[60:63], v[88:91], v[132:135], v[60:63]
v_mfma_f32_16x16x32_bf16 v[64:67], v[88:91], v[136:139], v[64:67]
s_waitcnt vmcnt(8) lgkmcnt(0)
v_mfma_f32_16x16x32_bf16 v[20:23], v[92:95], v[140:143], v[20:23]
ds_read_b128 v[68:71], v12 offset:24576
v_mfma_f32_16x16x32_bf16 v[24:27], v[92:95], v[144:147], v[24:27]
ds_read_b128 v[72:75], v12 offset:25600
v_mfma_f32_16x16x32_bf16 v[28:31], v[96:99], v[140:143], v[28:31]
ds_read_b128 v[76:79], v12 offset:26624
v_mfma_f32_16x16x32_bf16 v[32:35], v[96:99], v[144:147], v[32:35]
ds_read_b128 v[80:83], v12 offset:27648
v_mfma_f32_16x16x32_bf16 v[36:39], v[100:103], v[140:143], v[36:39]
ds_read_b128 v[84:87], v12 offset:28672
v_mfma_f32_16x16x32_bf16 v[40:43], v[100:103], v[144:147], v[40:43]
ds_read_b128 v[88:91], v12 offset:29696
v_mfma_f32_16x16x32_bf16 v[44:47], v[104:107], v[140:143], v[44:47]
buffer_load_dwordx4 v[132:135], v6, s[4:7], s28 offen offset:0 sc1
v_mfma_f32_16x16x32_bf16 v[48:51], v[104:107], v[144:147], v[48:51]
v_mfma_f32_16x16x32_bf16 v[52:55], v[108:111], v[140:143], v[52:55]
buffer_load_dwordx4 v[136:139], v6, s[4:7], s29 offen offset:0 sc1
v_mfma_f32_16x16x32_bf16 v[56:59], v[108:111], v[144:147], v[56:59]
v_mfma_f32_16x16x32_bf16 v[60:63], v[112:115], v[140:143], v[60:63]
v_mfma_f32_16x16x32_bf16 v[64:67], v[112:115], v[144:147], v[64:67]
s_waitcnt vmcnt(8) lgkmcnt(0)
v_mfma_f32_16x16x32_bf16 v[20:23], v[68:71], v[148:151], v[20:23]
ds_read_b128 v[92:95], v12 offset:30720
v_mfma_f32_16x16x32_bf16 v[24:27], v[68:71], v[152:155], v[24:27]
ds_read_b128 v[96:99], v12 offset:31744
v_mfma_f32_16x16x32_bf16 v[28:31], v[72:75], v[148:151], v[28:31]
ds_read_b128 v[100:103], v12 offset:32768
v_mfma_f32_16x16x32_bf16 v[32:35], v[72:75], v[152:155], v[32:35]
ds_read_b128 v[104:107], v12 offset:33792
v_mfma_f32_16x16x32_bf16 v[36:39], v[76:79], v[148:151], v[36:39]
ds_read_b128 v[108:111], v12 offset:34816
v_mfma_f32_16x16x32_bf16 v[40:43], v[76:79], v[152:155], v[40:43]
ds_read_b128 v[112:115], v12 offset:35840
v_mfma_f32_16x16x32_bf16 v[44:47], v[80:83], v[148:151], v[44:47]
buffer_load_dwordx4 v[140:143], v6, s[4:7], s28 offen offset:1024 sc1
v_mfma_f32_16x16x32_bf16 v[48:51], v[80:83], v[152:155], v[48:51]
v_mfma_f32_16x16x32_bf16 v[52:55], v[84:87], v[148:151], v[52:55]
buffer_load_dwordx4 v[144:147], v6, s[4:7], s29 offen offset:1024 sc1
v_mfma_f32_16x16x32_bf16 v[56:59], v[84:87], v[152:155], v[56:59]
v_mfma_f32_16x16x32_bf16 v[60:63], v[88:91], v[148:151], v[60:63]
v_mfma_f32_16x16x32_bf16 v[64:67], v[88:91], v[152:155], v[64:67]
s_waitcnt vmcnt(8) lgkmcnt(0)
v_mfma_f32_16x16x32_bf16 v[20:23], v[92:95], v[156:159], v[20:23]
ds_read_b128 v[68:71], v12 offset:36864
v_mfma_f32_16x16x32_bf16 v[24:27], v[92:95], v[160:163], v[24:27]
ds_read_b128 v[72:75], v12 offset:37888
v_mfma_f32_16x16x32_bf16 v[28:31], v[96:99], v[156:159], v[28:31]
ds_read_b128 v[76:79], v12 offset:38912
v_mfma_f32_16x16x32_bf16 v[32:35], v[96:99], v[160:163], v[32:35]
ds_read_b128 v[80:83], v12 offset:39936
v_mfma_f32_16x16x32_bf16 v[36:39], v[100:103], v[156:159], v[36:39]
ds_read_b128 v[84:87], v12 offset:40960
v_mfma_f32_16x16x32_bf16 v[40:43], v[100:103], v[160:163], v[40:43]
ds_read_b128 v[88:91], v12 offset:41984
v_mfma_f32_16x16x32_bf16 v[44:47], v[104:107], v[156:159], v[44:47]
buffer_load_dwordx4 v[148:151], v6, s[4:7], s28 offen offset:2048 sc1
v_mfma_f32_16x16x32_bf16 v[48:51], v[104:107], v[160:163], v[48:51]
v_mfma_f32_16x16x32_bf16 v[52:55], v[108:111], v[156:159], v[52:55]
buffer_load_dwordx4 v[152:155], v6, s[4:7], s29 offen offset:2048 sc1
v_mfma_f32_16x16x32_bf16 v[56:59], v[108:111], v[160:163], v[56:59]
v_mfma_f32_16x16x32_bf16 v[60:63], v[112:115], v[156:159], v[60:63]
v_mfma_f32_16x16x32_bf16 v[64:67], v[112:115], v[160:163], v[64:67]
s_waitcnt vmcnt(8) lgkmcnt(0)
v_mfma_f32_16x16x32_bf16 v[20:23], v[68:71], v[116:119], v[20:23]
ds_read_b128 v[92:95], v12 offset:43008
v_mfma_f32_16x16x32_bf16 v[24:27], v[68:71], v[120:123], v[24:27]
ds_read_b128 v[96:99], v12 offset:44032
v_mfma_f32_16x16x32_bf16 v[28:31], v[72:75], v[116:119], v[28:31]
ds_read_b128 v[100:103], v12 offset:45056
v_mfma_f32_16x16x32_bf16 v[32:35], v[72:75], v[120:123], v[32:35]
ds_read_b128 v[104:107], v12 offset:46080
v_mfma_f32_16x16x32_bf16 v[36:39], v[76:79], v[116:119], v[36:39]
ds_read_b128 v[108:111], v12 offset:47104
v_mfma_f32_16x16x32_bf16 v[40:43], v[76:79], v[120:123], v[40:43]
ds_read_b128 v[112:115], v12 offset:48128
v_mfma_f32_16x16x32_bf16 v[44:47], v[80:83], v[116:119], v[44:47]
buffer_load_dwordx4 v[156:159], v6, s[4:7], s28 offen offset:3072 sc1
s_add_u32 s28, s28, 4096
v_mfma_f32_16x16x32_bf16 v[48:51], v[80:83], v[120:123], v[48:51]
v_mfma_f32_16x16x32_bf16 v[52:55], v[84:87], v[116:119], v[52:55]
buffer_load_dwordx4 v[160:163], v6, s[4:7], s29 offen offset:3072 sc1
s_add_u32 s29, s29, 4096
v_mfma_f32_16x16x32_bf16 v[56:59], v[84:87], v[120:123], v[56:59]
v_mfma_f32_16x16x32_bf16 v[60:63], v[88:91], v[116:119], v[60:63]
v_mfma_f32_16x16x32_bf16 v[64:67], v[88:91], v[120:123], v[64:67]
s_waitcnt vmcnt(8) lgkmcnt(0)
v_mfma_f32_16x16x32_bf16 v[20:23], v[92:95], v[124:127], v[20:23]
ds_read_b128 v[68:71], v12 offset:49152
v_mfma_f32_16x16x32_bf16 v[24:27], v[92:95], v[128:131], v[24:27]
ds_read_b128 v[72:75], v12 offset:50176
v_mfma_f32_16x16x32_bf16 v[28:31], v[96:99], v[124:127], v[28:31]
ds_read_b128 v[76:79], v12 offset:51200
v_mfma_f32_16x16x32_bf16 v[32:35], v[96:99], v[128:131], v[32:35]
ds_read_b128 v[80:83], v12 offset:52224
v_mfma_f32_16x16x32_bf16 v[36:39], v[100:103], v[124:127], v[36:39]
ds_read_b128 v[84:87], v12 offset:53248
v_mfma_f32_16x16x32_bf16 v[40:43], v[100:103], v[128:131], v[40:43]
ds_read_b128 v[88:91], v12 offset:54272
v_mfma_f32_16x16x32_bf16 v[44:47], v[104:107], v[124:127], v[44:47]
buffer_load_dwordx4 v[116:119], v6, s[4:7], s28 offen offset:0 sc1
v_mfma_f32_16x16x32_bf16 v[48:51], v[104:107], v[128:131], v[48:51]
v_mfma_f32_16x16x32_bf16 v[52:55], v[108:111], v[124:127], v[52:55]
buffer_load_dwordx4 v[120:123], v6, s[4:7], s29 offen offset:0 sc1
v_mfma_f32_16x16x32_bf16 v[56:59], v[108:111], v[128:131], v[56:59]
v_mfma_f32_16x16x32_bf16 v[60:63], v[112:115], v[124:127], v[60:63]
v_mfma_f32_16x16x32_bf16 v[64:67], v[112:115], v[128:131], v[64:67]
s_waitcnt vmcnt(8) lgkmcnt(0)
v_mfma_f32_16x16x32_bf16 v[20:23], v[68:71], v[132:135], v[20:23]
ds_read_b128 v[92:95], v12 offset:55296
v_mfma_f32_16x16x32_bf16 v[24:27], v[68:71], v[136:139], v[24:27]
ds_read_b128 v[96:99], v12 offset:56320
v_mfma_f32_16x16x32_bf16 v[28:31], v[72:75], v[132:135], v[28:31]
ds_read_b128 v[100:103], v12 offset:57344
v_mfma_f32_16x16x32_bf16 v[32:35], v[72:75], v[136:139], v[32:35]
ds_read_b128 v[104:107], v12 offset:58368
v_mfma_f32_16x16x32_bf16 v[36:39], v[76:79], v[132:135], v[36:39]
ds_read_b128 v[108:111], v12 offset:59392
v_mfma_f32_16x16x32_bf16 v[40:43], v[76:79], v[136:139], v[40:43]
ds_read_b128 v[112:115], v12 offset:60416
v_mfma_f32_16x16x32_bf16 v[44:47], v[80:83], v[132:135], v[44:47]
buffer_load_dwordx4 v[124:127], v6, s[4:7], s28 offen offset:1024 sc1
v_mfma_f32_16x16x32_bf16 v[48:51], v[80:83], v[136:139], v[48:51]
v_mfma_f32_16x16x32_bf16 v[52:55], v[84:87], v[132:135], v[52:55]
buffer_load_dwordx4 v[128:131], v6, s[4:7], s29 offen offset:1024 sc1
v_mfma_f32_16x16x32_bf16 v[56:59], v[84:87], v[136:139], v[56:59]
v_mfma_f32_16x16x32_bf16 v[60:63], v[88:91], v[132:135], v[60:63]
v_mfma_f32_16x16x32_bf16 v[64:67], v[88:91], v[136:139], v[64:67]
s_waitcnt vmcnt(8) lgkmcnt(0)
v_mfma_f32_16x16x32_bf16 v[20:23], v[92:95], v[140:143], v[20:23]
ds_read_b128 v[68:71], v13 offset:0
v_mfma_f32_16x16x32_bf16 v[24:27], v[92:95], v[144:147], v[24:27]
ds_read_b128 v[72:75], v13 offset:1024
v_mfma_f32_16x16x32_bf16 v[28:31], v[96:99], v[140:143], v[28:31]
ds_read_b128 v[76:79], v13 offset:2048
v_mfma_f32_16x16x32_bf16 v[32:35], v[96:99], v[144:147], v[32:35]
ds_read_b128 v[80:83], v13 offset:3072
v_mfma_f32_16x16x32_bf16 v[36:39], v[100:103], v[140:143], v[36:39]
ds_read_b128 v[84:87], v13 offset:4096
v_mfma_f32_16x16x32_bf16 v[40:43], v[100:103], v[144:147], v[40:43]
ds_read_b128 v[88:91], v13 offset:5120
v_mfma_f32_16x16x32_bf16 v[44:47], v[104:107], v[140:143], v[44:47]
buffer_load_dwordx4 v[132:135], v6, s[4:7], s28 offen offset:2048 sc1
v_mfma_f32_16x16x32_bf16 v[48:51], v[104:107], v[144:147], v[48:51]
v_mfma_f32_16x16x32_bf16 v[52:55], v[108:111], v[140:143], v[52:55]
buffer_load_dwordx4 v[136:139], v6, s[4:7], s29 offen offset:2048 sc1
v_mfma_f32_16x16x32_bf16 v[56:59], v[108:111], v[144:147], v[56:59]
v_mfma_f32_16x16x32_bf16 v[60:63], v[112:115], v[140:143], v[60:63]
v_mfma_f32_16x16x32_bf16 v[64:67], v[112:115], v[144:147], v[64:67]
s_waitcnt vmcnt(8) lgkmcnt(0)
v_mfma_f32_16x16x32_bf16 v[20:23], v[68:71], v[148:151], v[20:23]
ds_read_b128 v[92:95], v13 offset:6144
v_mfma_f32_16x16x32_bf16 v[24:27], v[68:71], v[152:155], v[24:27]
ds_read_b128 v[96:99], v13 offset:7168
v_mfma_f32_16x16x32_bf16 v[28:31], v[72:75], v[148:151], v[28:31]
ds_read_b128 v[100:103], v13 offset:8192
v_mfma_f32_16x16x32_bf16 v[32:35], v[72:75], v[152:155], v[32:35]
ds_read_b128 v[104:107], v13 offset:9216
v_mfma_f32_16x16x32_bf16 v[36:39], v[76:79], v[148:151], v[36:39]
ds_read_b128 v[108:111], v13 offset:10240
v_mfma_f32_16x16x32_bf16 v[40:43], v[76:79], v[152:155], v[40:43]
ds_read_b128 v[112:115], v13 offset:11264
v_mfma_f32_16x16x32_bf16 v[44:47], v[80:83], v[148:151], v[44:47]
buffer_load_dwordx4 v[140:143], v6, s[4:7], s28 offen offset:3072 sc1
s_add_u32 s28, s28, 4096
v_mfma_f32_16x16x32_bf16 v[48:51], v[80:83], v[152:155], v[48:51]
v_mfma_f32_16x16x32_bf16 v[52:55], v[84:87], v[148:151], v[52:55]
buffer_load_dwordx4 v[144:147], v6, s[4:7], s29 offen offset:3072 sc1
s_add_u32 s29, s29, 4096
v_mfma_f32_16x16x32_bf16 v[56:59], v[84:87], v[152:155], v[56:59]
v_mfma_f32_16x16x32_bf16 v[60:63], v[88:91], v[148:151], v[60:63]
v_mfma_f32_16x16x32_bf16 v[64:67], v[88:91], v[152:155], v[64:67]
s_waitcnt vmcnt(8) lgkmcnt(0)
v_mfma_f32_16x16x32_bf16 v[20:23], v[92:95], v[156:159], v[20:23]
ds_read_b128 v[68:71], v13 offset:12288
v_mfma_f32_16x16x32_bf16 v[24:27], v[92:95], v[160:163], v[24:27]
ds_read_b128 v[72:75], v13 offset:13312
v_mfma_f32_16x16x32_bf16 v[28:31], v[96:99], v[156:159], v[28:31]
ds_read_b128 v[76:79], v13 offset:14336
v_mfma_f32_16x16x32_bf16 v[32:35], v[96:99], v[160:163], v[32:35]
ds_read_b128 v[80:83], v13 offset:15360
v_mfma_f32_16x16x32_bf16 v[36:39], v[100:103], v[156:159], v[36:39]
ds_read_b128 v[84:87], v13 offset:16384
v_mfma_f32_16x16x32_bf16 v[40:43], v[100:103], v[160:163], v[40:43]
ds_read_b128 v[88:91], v13 offset:17408
v_mfma_f32_16x16x32_bf16 v[44:47], v[104:107], v[156:159], v[44:47]
buffer_load_dwordx4 v[148:151], v6, s[4:7], s28 offen offset:0 sc1
v_mfma_f32_16x16x32_bf16 v[48:51], v[104:107], v[160:163], v[48:51]
v_mfma_f32_16x16x32_bf16 v[52:55], v[108:111], v[156:159], v[52:55]
buffer_load_dwordx4 v[152:155], v6, s[4:7], s29 offen offset:0 sc1
v_mfma_f32_16x16x32_bf16 v[56:59], v[108:111], v[160:163], v[56:59]
v_mfma_f32_16x16x32_bf16 v[60:63], v[112:115], v[156:159], v[60:63]
v_mfma_f32_16x16x32_bf16 v[64:67], v[112:115], v[160:163], v[64:67]
s_waitcnt vmcnt(8) lgkmcnt(0)
v_mfma_f32_16x16x32_bf16 v[20:23], v[68:71], v[116:119], v[20:23]
ds_read_b128 v[92:95], v13 offset:18432
v_mfma_f32_16x16x32_bf16 v[24:27], v[68:71], v[120:123], v[24:27]
ds_read_b128 v[96:99], v13 offset:19456
v_mfma_f32_16x16x32_bf16 v[28:31], v[72:75], v[116:119], v[28:31]
ds_read_b128 v[100:103], v13 offset:20480
v_mfma_f32_16x16x32_bf16 v[32:35], v[72:75], v[120:123], v[32:35]
ds_read_b128 v[104:107], v13 offset:21504
v_mfma_f32_16x16x32_bf16 v[36:39], v[76:79], v[116:119], v[36:39]
ds_read_b128 v[108:111], v13 offset:22528
v_mfma_f32_16x16x32_bf16 v[40:43], v[76:79], v[120:123], v[40:43]
ds_read_b128 v[112:115], v13 offset:23552
v_mfma_f32_16x16x32_bf16 v[44:47], v[80:83], v[116:119], v[44:47]
buffer_load_dwordx4 v[156:159], v6, s[4:7], s28 offen offset:1024 sc1
v_mfma_f32_16x16x32_bf16 v[48:51], v[80:83], v[120:123], v[48:51]
v_mfma_f32_16x16x32_bf16 v[52:55], v[84:87], v[116:119], v[52:55]
buffer_load_dwordx4 v[160:163], v6, s[4:7], s29 offen offset:1024 sc1
v_mfma_f32_16x16x32_bf16 v[56:59], v[84:87], v[120:123], v[56:59]
v_mfma_f32_16x16x32_bf16 v[60:63], v[88:91], v[116:119], v[60:63]
v_mfma_f32_16x16x32_bf16 v[64:67], v[88:91], v[120:123], v[64:67]
s_waitcnt vmcnt(8) lgkmcnt(0)
v_mfma_f32_16x16x32_bf16 v[20:23], v[92:95], v[124:127], v[20:23]
ds_read_b128 v[68:71], v13 offset:24576
v_mfma_f32_16x16x32_bf16 v[24:27], v[92:95], v[128:131], v[24:27]
ds_read_b128 v[72:75], v13 offset:25600
v_mfma_f32_16x16x32_bf16 v[28:31], v[96:99], v[124:127], v[28:31]
ds_read_b128 v[76:79], v13 offset:26624
v_mfma_f32_16x16x32_bf16 v[32:35], v[96:99], v[128:131], v[32:35]
ds_read_b128 v[80:83], v13 offset:27648
v_mfma_f32_16x16x32_bf16 v[36:39], v[100:103], v[124:127], v[36:39]
ds_read_b128 v[84:87], v13 offset:28672
v_mfma_f32_16x16x32_bf16 v[40:43], v[100:103], v[128:131], v[40:43]
ds_read_b128 v[88:91], v13 offset:29696
v_mfma_f32_16x16x32_bf16 v[44:47], v[104:107], v[124:127], v[44:47]
buffer_load_dwordx4 v[116:119], v6, s[4:7], s28 offen offset:2048 sc1
v_mfma_f32_16x16x32_bf16 v[48:51], v[104:107], v[128:131], v[48:51]
v_mfma_f32_16x16x32_bf16 v[52:55], v[108:111], v[124:127], v[52:55]
buffer_load_dwordx4 v[120:123], v6, s[4:7], s29 offen offset:2048 sc1
v_mfma_f32_16x16x32_bf16 v[56:59], v[108:111], v[128:131], v[56:59]
v_mfma_f32_16x16x32_bf16 v[60:63], v[112:115], v[124:127], v[60:63]
v_mfma_f32_16x16x32_bf16 v[64:67], v[112:115], v[128:131], v[64:67]
s_waitcnt vmcnt(8) lgkmcnt(0)
v_mfma_f32_16x16x32_bf16 v[20:23], v[68:71], v[132:135], v[20:23]
ds_read_b128 v[92:95], v13 offset:30720
v_mfma_f32_16x16x32_bf16 v[24:27], v[68:71], v[136:139], v[24:27]
ds_read_b128 v[96:99], v13 offset:31744
v_mfma_f32_16x16x32_bf16 v[28:31], v[72:75], v[132:135], v[28:31]
ds_read_b128 v[100:103], v13 offset:32768
v_mfma_f32_16x16x32_bf16 v[32:35], v[72:75], v[136:139], v[32:35]
ds_read_b128 v[104:107], v13 offset:33792
v_mfma_f32_16x16x32_bf16 v[36:39], v[76:79], v[132:135], v[36:39]
ds_read_b128 v[108:111], v13 offset:34816
v_mfma_f32_16x16x32_bf16 v[40:43], v[76:79], v[136:139], v[40:43]
ds_read_b128 v[112:115], v13 offset:35840
v_mfma_f32_16x16x32_bf16 v[44:47], v[80:83], v[132:135], v[44:47]
buffer_load_dwordx4 v[124:127], v6, s[4:7], s28 offen offset:3072 sc1
s_add_u32 s28, s28, 4096
v_mfma_f32_16x16x32_bf16 v[48:51], v[80:83], v[136:139], v[48:51]
v_mfma_f32_16x16x32_bf16 v[52:55], v[84:87], v[132:135], v[52:55]
buffer_load_dwordx4 v[128:131], v6, s[4:7], s29 offen offset:3072 sc1
s_add_u32 s29, s29, 4096
v_mfma_f32_16x16x32_bf16 v[56:59], v[84:87], v[136:139], v[56:59]
v_mfma_f32_16x16x32_bf16 v[60:63], v[88:91], v[132:135], v[60:63]
v_mfma_f32_16x16x32_bf16 v[64:67], v[88:91], v[136:139], v[64:67]
s_waitcnt vmcnt(8) lgkmcnt(0)
v_mfma_f32_16x16x32_bf16 v[20:23], v[92:95], v[140:143], v[20:23]
ds_read_b128 v[68:71], v13 offset:36864
v_mfma_f32_16x16x32_bf16 v[24:27], v[92:95], v[144:147], v[24:27]
ds_read_b128 v[72:75], v13 offset:37888
v_mfma_f32_16x16x32_bf16 v[28:31], v[96:99], v[140:143], v[28:31]
ds_read_b128 v[76:79], v13 offset:38912
v_mfma_f32_16x16x32_bf16 v[32:35], v[96:99], v[144:147], v[32:35]
ds_read_b128 v[80:83], v13 offset:39936
v_mfma_f32_16x16x32_bf16 v[36:39], v[100:103], v[140:143], v[36:39]
ds_read_b128 v[84:87], v13 offset:40960
v_mfma_f32_16x16x32_bf16 v[40:43], v[100:103], v[144:147], v[40:43]
ds_read_b128 v[88:91], v13 offset:41984
v_mfma_f32_16x16x32_bf16 v[44:47], v[104:107], v[140:143], v[44:47]
v_mfma_f32_16x16x32_bf16 v[48:51], v[104:107], v[144:147], v[48:51]
v_mfma_f32_16x16x32_bf16 v[52:55], v[108:111], v[140:143], v[52:55]
v_mfma_f32_16x16x32_bf16 v[56:59], v[108:111], v[144:147], v[56:59]
v_mfma_f32_16x16x32_bf16 v[60:63], v[112:115], v[140:143], v[60:63]
v_mfma_f32_16x16x32_bf16 v[64:67], v[112:115], v[144:147], v[64:67]
buffer_load_dwordx2 v[132:133], v16, s[4:7], s30 offen offset:0 sc1
buffer_load_dwordx2 v[134:135], v16, s[4:7], s30 offen offset:128 sc1
buffer_load_dwordx2 v[136:137], v16, s[4:7], s30 offen offset:1024 sc1
buffer_load_dwordx2 v[138:139], v16, s[4:7], s30 offen offset:1152 sc1
s_waitcnt vmcnt(10) lgkmcnt(0)
v_mfma_f32_16x16x32_bf16 v[20:23], v[68:71], v[148:151], v[20:23]
ds_read_b128 v[92:95], v13 offset:43008
v_mfma_f32_16x16x32_bf16 v[24:27], v[68:71], v[152:155], v[24:27]
ds_read_b128 v[96:99], v13 offset:44032
v_mfma_f32_16x16x32_bf16 v[28:31], v[72:75], v[148:151], v[28:31]
ds_read_b128 v[100:103], v13 offset:45056
v_mfma_f32_16x16x32_bf16 v[32:35], v[72:75], v[152:155], v[32:35]
ds_read_b128 v[104:107], v13 offset:46080
v_mfma_f32_16x16x32_bf16 v[36:39], v[76:79], v[148:151], v[36:39]
ds_read_b128 v[108:111], v13 offset:47104
v_mfma_f32_16x16x32_bf16 v[40:43], v[76:79], v[152:155], v[40:43]
ds_read_b128 v[112:115], v13 offset:48128
v_mfma_f32_16x16x32_bf16 v[44:47], v[80:83], v[148:151], v[44:47]
v_mfma_f32_16x16x32_bf16 v[48:51], v[80:83], v[152:155], v[48:51]
v_mfma_f32_16x16x32_bf16 v[52:55], v[84:87], v[148:151], v[52:55]
v_mfma_f32_16x16x32_bf16 v[56:59], v[84:87], v[152:155], v[56:59]
v_mfma_f32_16x16x32_bf16 v[60:63], v[88:91], v[148:151], v[60:63]
v_mfma_f32_16x16x32_bf16 v[64:67], v[88:91], v[152:155], v[64:67]
s_waitcnt vmcnt(8) lgkmcnt(0)
v_mfma_f32_16x16x32_bf16 v[20:23], v[92:95], v[156:159], v[20:23]
ds_read_b128 v[68:71], v13 offset:49152
v_mfma_f32_16x16x32_bf16 v[24:27], v[92:95], v[160:163], v[24:27]
ds_read_b128 v[72:75], v13 offset:50176
v_mfma_f32_16x16x32_bf16 v[28:31], v[96:99], v[156:159], v[28:31]
ds_read_b128 v[76:79], v13 offset:51200
v_mfma_f32_16x16x32_bf16 v[32:35], v[96:99], v[160:163], v[32:35]
ds_read_b128 v[80:83], v13 offset:52224
v_mfma_f32_16x16x32_bf16 v[36:39], v[100:103], v[156:159], v[36:39]
ds_read_b128 v[84:87], v13 offset:53248
v_mfma_f32_16x16x32_bf16 v[40:43], v[100:103], v[160:163], v[40:43]
ds_read_b128 v[88:91], v13 offset:54272
v_mfma_f32_16x16x32_bf16 v[44:47], v[104:107], v[156:159], v[44:47]
v_mfma_f32_16x16x32_bf16 v[48:51], v[104:107], v[160:163], v[48:51]
v_mfma_f32_16x16x32_bf16 v[52:55], v[108:111], v[156:159], v[52:55]
v_mfma_f32_16x16x32_bf16 v[56:59], v[108:111], v[160:163], v[56:59]
v_mfma_f32_16x16x32_bf16 v[60:63], v[112:115], v[156:159], v[60:63]
v_mfma_f32_16x16x32_bf16 v[64:67], v[112:115], v[160:163], v[64:67]
s_waitcnt vmcnt(6) lgkmcnt(0)
v_mfma_f32_16x16x32_bf16 v[20:23], v[68:71], v[116:119], v[20:23]
ds_read_b128 v[92:95], v13 offset:55296
v_mfma_f32_16x16x32_bf16 v[24:27], v[68:71], v[120:123], v[24:27]
ds_read_b128 v[96:99], v13 offset:56320
v_mfma_f32_16x16x32_bf16 v[28:31], v[72:75], v[116:119], v[28:31]
ds_read_b128 v[100:103], v13 offset:57344
v_mfma_f32_16x16x32_bf16 v[32:35], v[72:75], v[120:123], v[32:35]
ds_read_b128 v[104:107], v13 offset:58368
v_mfma_f32_16x16x32_bf16 v[36:39], v[76:79], v[116:119], v[36:39]
ds_read_b128 v[108:111], v13 offset:59392
v_mfma_f32_16x16x32_bf16 v[40:43], v[76:79], v[120:123], v[40:43]
ds_read_b128 v[112:115], v13 offset:60416
v_mfma_f32_16x16x32_bf16 v[44:47], v[80:83], v[116:119], v[44:47]
v_mfma_f32_16x16x32_bf16 v[48:51], v[80:83], v[120:123], v[48:51]
v_mfma_f32_16x16x32_bf16 v[52:55], v[84:87], v[116:119], v[52:55]
v_mfma_f32_16x16x32_bf16 v[56:59], v[84:87], v[120:123], v[56:59]
v_mfma_f32_16x16x32_bf16 v[60:63], v[88:91], v[116:119], v[60:63]
v_mfma_f32_16x16x32_bf16 v[64:67], v[88:91], v[120:123], v[64:67]
s_waitcnt vmcnt(4) lgkmcnt(0)
v_mfma_f32_16x16x32_bf16 v[20:23], v[92:95], v[124:127], v[20:23]
ds_read_b128 v[68:71], v17 offset:0
v_mfma_f32_16x16x32_bf16 v[24:27], v[92:95], v[128:131], v[24:27]
ds_read_b128 v[72:75], v17 offset:64
v_mfma_f32_16x16x32_bf16 v[28:31], v[96:99], v[124:127], v[28:31]
ds_read_b128 v[76:79], v17 offset:128
v_mfma_f32_16x16x32_bf16 v[32:35], v[96:99], v[128:131], v[32:35]
ds_read_b128 v[80:83], v17 offset:192
v_mfma_f32_16x16x32_bf16 v[36:39], v[100:103], v[124:127], v[36:39]
ds_read_b128 v[84:87], v17 offset:256
v_mfma_f32_16x16x32_bf16 v[40:43], v[100:103], v[128:131], v[40:43]
ds_read_b128 v[88:91], v17 offset:320
v_mfma_f32_16x16x32_bf16 v[44:47], v[104:107], v[124:127], v[44:47]
v_mfma_f32_16x16x32_bf16 v[48:51], v[104:107], v[128:131], v[48:51]
v_mfma_f32_16x16x32_bf16 v[52:55], v[108:111], v[124:127], v[52:55]
v_mfma_f32_16x16x32_bf16 v[56:59], v[108:111], v[128:131], v[56:59]
v_mfma_f32_16x16x32_bf16 v[60:63], v[112:115], v[124:127], v[60:63]
v_mfma_f32_16x16x32_bf16 v[64:67], v[112:115], v[128:131], v[64:67]
s_setprio 0
s_waitcnt vmcnt(0)
v_add_f32 v132, v132, v134
v_add_f32 v133, v133, v135
v_add_f32 v136, v136, v138
v_add_f32 v137, v137, v139
v_mov_b32 v134, v132
v_mov_b32 v135, v133
v_mov_b32 v138, v136
v_mov_b32 v139, v137
v_permlane32_swap_b32 v132, v134
v_permlane32_swap_b32 v133, v135
v_permlane32_swap_b32 v136, v138
v_permlane32_swap_b32 v137, v139
v_add_f32 v132, v132, v134
v_add_f32 v133, v133, v135
v_add_f32 v136, v136, v138
v_add_f32 v137, v137, v139
v_mov_b32 v134, v132
v_mov_b32 v135, v133
v_mov_b32 v138, v136
v_mov_b32 v139, v137
v_permlane16_swap_b32 v132, v134
v_permlane16_swap_b32 v133, v135
v_permlane16_swap_b32 v136, v138
v_permlane16_swap_b32 v137, v139
v_add_f32 v132, v132, v134
v_add_f32 v133, v133, v135
v_add_f32 v136, v136, v138
v_add_f32 v137, v137, v139
v_mul_f32 v132, 0x3acccccd, v132
v_mul_f32 v133, 0x3acccccd, v133
v_mul_f32 v136, 0x3acccccd, v136
v_mul_f32 v137, 0x3acccccd, v137
v_fma_f32 v133, -v132, v132, v133
v_fma_f32 v137, -v136, v136, v137
v_max_f32 v133, 0, v133
v_max_f32 v137, 0, v137
v_add_f32 v142, 0x3727c5ac, v133
v_add_f32 v146, 0x3727c5ac, v137
v_rsq_f32 v141, v142
v_rsq_f32 v145, v146
v_sub_f32 v140, 0, v132
v_sub_f32 v144, 0, v136
v_mul_f32 v141, 0xbfb8aa3b, v141
v_mul_f32 v145, 0xbfb8aa3b, v145
s_waitcnt lgkmcnt(0)
v_fmac_f32 v20, v68, v140
v_fmac_f32 v21, v69, v140
v_fmac_f32 v22, v70, v140
s_lshr_b32 s24, s19, 2
s_mul_i32 s3, s24, 245760
s_lshl_b32 s25, s16, 10
s_add_u32 s3, s3, s25
s_add_u32 s3, s3, 25722880
buffer_load_dwordx4 v[168:171], v6, s[4:7], s3 offen sc1
s_add_u32 s3, s3, 4096
v_fmac_f32 v23, v71, v140
v_fmac_f32 v24, v68, v144
v_fmac_f32 v25, v69, v144
buffer_load_dwordx4 v[172:175], v6, s[4:7], s3 offen sc1
s_add_u32 s3, s3, 4096
v_fmac_f32 v26, v70, v144
v_fmac_f32 v27, v71, v144
v_mul_f32 v116, v20, v141
v_mul_f32 v117, v21, v141
v_mul_f32 v118, v22, v141
buffer_load_dwordx4 v[176:179], v6, s[4:7], s3 offen sc1
s_add_u32 s3, s3, 4096
v_mul_f32 v119, v23, v141
v_mul_f32 v120, v24, v145
v_mul_f32 v121, v25, v145
buffer_load_dwordx4 v[180:183], v6, s[4:7], s3 offen sc1
s_add_u32 s3, s3, 4096
v_mul_f32 v122, v26, v145
v_mul_f32 v123, v27, v145
v_exp_f32 v116, v116
v_exp_f32 v117, v117
v_exp_f32 v118, v118
buffer_load_dwordx4 v[184:187], v6, s[4:7], s3 offen sc1
s_add_u32 s3, s3, 4096
v_exp_f32 v119, v119
v_exp_f32 v120, v120
v_exp_f32 v121, v121
buffer_load_dwordx4 v[188:191], v6, s[4:7], s3 offen sc1
s_add_u32 s3, s3, 4096
v_exp_f32 v122, v122
v_exp_f32 v123, v123
v_fmac_f32 v28, v72, v140
v_fmac_f32 v29, v73, v140
v_fmac_f32 v30, v74, v140
buffer_load_dwordx4 v[192:195], v6, s[4:7], s3 offen sc1
s_add_u32 s3, s3, 4096
v_fmac_f32 v31, v75, v140
v_fmac_f32 v32, v72, v144
v_fmac_f32 v33, v73, v144
buffer_load_dwordx4 v[196:199], v6, s[4:7], s3 offen sc1
s_add_u32 s3, s3, 4096
v_fmac_f32 v34, v74, v144
v_fmac_f32 v35, v75, v144
v_fma_f32 v116, v116, v142, v142
v_fma_f32 v117, v117, v142, v142
v_fma_f32 v118, v118, v142, v142
buffer_load_dwordx4 v[212:215], v6, s[4:7], s3 offen sc1
s_add_u32 s3, s3, 4096
v_fma_f32 v119, v119, v142, v142
v_fma_f32 v120, v120, v146, v146
v_fma_f32 v121, v121, v146, v146
buffer_load_dwordx4 v[216:219], v6, s[4:7], s3 offen sc1
s_add_u32 s3, s3, 4096
v_fma_f32 v122, v122, v146, v146
v_fma_f32 v123, v123, v146, v146
v_rcp_f32 v116, v116
v_rcp_f32 v117, v117
v_rcp_f32 v118, v118
buffer_load_dwordx4 v[220:223], v6, s[4:7], s3 offen sc1
s_add_u32 s3, s3, 4096
v_rcp_f32 v119, v119
v_rcp_f32 v120, v120
v_rcp_f32 v121, v121
buffer_load_dwordx4 v[224:227], v6, s[4:7], s3 offen sc1
s_add_u32 s3, s3, 4096
v_rcp_f32 v122, v122
v_rcp_f32 v123, v123
v_mul_f32 v20, v20, v28
v_mul_f32 v21, v21, v29
v_mul_f32 v22, v22, v30
buffer_load_dwordx4 v[228:231], v6, s[4:7], s3 offen sc1
s_add_u32 s3, s3, 4096
v_mul_f32 v23, v23, v31
v_mul_f32 v24, v24, v32
v_mul_f32 v25, v25, v33
buffer_load_dwordx4 v[232:235], v6, s[4:7], s3 offen sc1
s_add_u32 s3, s3, 4096
v_mul_f32 v26, v26, v34
v_mul_f32 v27, v27, v35
v_mul_f32 v20, v20, v116
v_mul_f32 v21, v21, v117
v_mul_f32 v22, v22, v118
buffer_load_dwordx4 v[236:239], v6, s[4:7], s3 offen sc1
s_add_u32 s3, s3, 4096
v_mul_f32 v23, v23, v119
v_mul_f32 v24, v24, v120
v_mul_f32 v25, v25, v121
buffer_load_dwordx4 v[240:243], v6, s[4:7], s3 offen sc1
s_add_u32 s3, s3, 4096
v_mul_f32 v26, v26, v122
v_mul_f32 v27, v27, v123
v_cvt_pk_bf16_f32 v28, v20, v21
v_cvt_pk_bf16_f32 v29, v22, v23
v_cvt_pk_bf16_f32 v30, v24, v25
v_cvt_pk_bf16_f32 v31, v26, v27
s_nop 0
v_permlane16_swap_b32 v28, v30
v_permlane16_swap_b32 v29, v31
buffer_store_dwordx4 v[28:31], v15, s[4:7], 0 offen offset:0 sc1
v_fmac_f32 v36, v76, v140
v_fmac_f32 v37, v77, v140
v_fmac_f32 v38, v78, v140
buffer_load_dwordx4 v[244:247], v6, s[4:7], s3 offen sc1
s_add_u32 s3, s3, 4096
v_fmac_f32 v39, v79, v140
v_fmac_f32 v40, v76, v144
v_fmac_f32 v41, v77, v144
buffer_load_dwordx4 v[248:251], v6, s[4:7], s3 offen sc1
s_add_u32 s3, s3, 4096
v_fmac_f32 v42, v78, v144
v_fmac_f32 v43, v79, v144
v_mul_f32 v116, v36, v141
v_mul_f32 v117, v37, v141
v_mul_f32 v118, v38, v141
s_cmp_ge_u32 s16, 3
s_cselect_b32 s24, 46080, 0
s_add_u32 s3, s3, s24
buffer_load_dwordx4 v[252:255], v6, s[4:7], s3 offen sc1
s_add_u32 s3, s3, 4096
v_mul_f32 v119, v39, v141
v_mul_f32 v120, v40, v145
v_mul_f32 v121, v41, v145
s_cmp_lt_u32 s16, 3
s_cselect_b32 s24, 46080, 0
s_add_u32 s3, s3, s24
buffer_load_dwordx4 v[92:95], v6, s[4:7], s3 offen sc1
s_add_u32 s3, s3, 4096
v_mul_f32 v122, v42, v145
v_mul_f32 v123, v43, v145
v_exp_f32 v116, v116
v_exp_f32 v117, v117
v_exp_f32 v118, v118
buffer_load_dwordx4 v[96:99], v6, s[4:7], s3 offen sc1
s_add_u32 s3, s3, 4096
v_exp_f32 v119, v119
v_exp_f32 v120, v120
v_exp_f32 v121, v121
buffer_load_dwordx4 v[100:103], v6, s[4:7], s3 offen sc1
s_add_u32 s3, s3, 4096
v_exp_f32 v122, v122
v_exp_f32 v123, v123
v_fmac_f32 v44, v80, v140
v_fmac_f32 v45, v81, v140
v_fmac_f32 v46, v82, v140
buffer_load_dwordx4 v[104:107], v6, s[4:7], s3 offen sc1
s_add_u32 s3, s3, 4096
v_fmac_f32 v47, v83, v140
v_fmac_f32 v48, v80, v144
v_fmac_f32 v49, v81, v144
buffer_load_dwordx4 v[108:111], v6, s[4:7], s3 offen sc1
s_add_u32 s3, s3, 4096
v_fmac_f32 v50, v82, v144
v_fmac_f32 v51, v83, v144
v_fma_f32 v116, v116, v142, v142
v_fma_f32 v117, v117, v142, v142
v_fma_f32 v118, v118, v142, v142
v_fma_f32 v119, v119, v142, v142
v_fma_f32 v120, v120, v146, v146
v_fma_f32 v121, v121, v146, v146
v_fma_f32 v122, v122, v146, v146
v_fma_f32 v123, v123, v146, v146
v_rcp_f32 v116, v116
v_rcp_f32 v117, v117
v_rcp_f32 v118, v118
v_rcp_f32 v119, v119
v_rcp_f32 v120, v120
v_rcp_f32 v121, v121
v_rcp_f32 v122, v122
v_rcp_f32 v123, v123
v_mul_f32 v36, v36, v44
v_mul_f32 v37, v37, v45
v_mul_f32 v38, v38, v46
v_mul_f32 v39, v39, v47
v_mul_f32 v40, v40, v48
v_mul_f32 v41, v41, v49
v_mul_f32 v42, v42, v50
v_mul_f32 v43, v43, v51
v_mul_f32 v36, v36, v116
v_mul_f32 v37, v37, v117
v_mul_f32 v38, v38, v118
v_mul_f32 v39, v39, v119
v_mul_f32 v40, v40, v120
v_mul_f32 v41, v41, v121
v_mul_f32 v42, v42, v122
v_mul_f32 v43, v43, v123
v_cvt_pk_bf16_f32 v44, v36, v37
v_cvt_pk_bf16_f32 v45, v38, v39
v_cvt_pk_bf16_f32 v46, v40, v41
v_cvt_pk_bf16_f32 v47, v42, v43
s_nop 0
v_permlane16_swap_b32 v44, v46
v_permlane16_swap_b32 v45, v47
buffer_store_dwordx4 v[44:47], v15, s[4:7], 0 offen offset:512 sc1
v_fmac_f32 v52, v84, v140
v_fmac_f32 v53, v85, v140
v_fmac_f32 v54, v86, v140
v_fmac_f32 v55, v87, v140
v_fmac_f32 v56, v84, v144
v_fmac_f32 v57, v85, v144
v_fmac_f32 v58, v86, v144
v_fmac_f32 v59, v87, v144
v_mul_f32 v116, v52, v141
v_mul_f32 v117, v53, v141
v_mul_f32 v118, v54, v141
v_mul_f32 v119, v55, v141
v_mul_f32 v120, v56, v145
v_mul_f32 v121, v57, v145
v_mul_f32 v122, v58, v145
v_mul_f32 v123, v59, v145
v_exp_f32 v116, v116
v_exp_f32 v117, v117
v_exp_f32 v118, v118
v_exp_f32 v119, v119
v_exp_f32 v120, v120
v_exp_f32 v121, v121
v_exp_f32 v122, v122
v_exp_f32 v123, v123
v_fmac_f32 v60, v88, v140
v_fmac_f32 v61, v89, v140
v_fmac_f32 v62, v90, v140
v_fmac_f32 v63, v91, v140
v_fmac_f32 v64, v88, v144
v_fmac_f32 v65, v89, v144
v_fmac_f32 v66, v90, v144
v_fmac_f32 v67, v91, v144
v_fma_f32 v116, v116, v142, v142
v_fma_f32 v117, v117, v142, v142
v_fma_f32 v118, v118, v142, v142
v_fma_f32 v119, v119, v142, v142
v_fma_f32 v120, v120, v146, v146
v_fma_f32 v121, v121, v146, v146
v_fma_f32 v122, v122, v146, v146
v_fma_f32 v123, v123, v146, v146
v_rcp_f32 v116, v116
v_rcp_f32 v117, v117
v_rcp_f32 v118, v118
v_rcp_f32 v119, v119
v_rcp_f32 v120, v120
v_rcp_f32 v121, v121
v_rcp_f32 v122, v122
v_rcp_f32 v123, v123
v_mul_f32 v52, v52, v60
v_mul_f32 v53, v53, v61
v_mul_f32 v54, v54, v62
v_mul_f32 v55, v55, v63
v_mul_f32 v56, v56, v64
v_mul_f32 v57, v57, v65
v_mul_f32 v58, v58, v66
v_mul_f32 v59, v59, v67
v_mul_f32 v52, v52, v116
v_mul_f32 v53, v53, v117
v_mul_f32 v54, v54, v118
v_mul_f32 v55, v55, v119
v_mul_f32 v56, v56, v120
v_mul_f32 v57, v57, v121
v_mul_f32 v58, v58, v122
v_mul_f32 v59, v59, v123
v_cvt_pk_bf16_f32 v60, v52, v53
v_cvt_pk_bf16_f32 v61, v54, v55
v_cvt_pk_bf16_f32 v62, v56, v57
v_cvt_pk_bf16_f32 v63, v58, v59
s_nop 0
v_permlane16_swap_b32 v60, v62
v_permlane16_swap_b32 v61, v63
buffer_store_dwordx4 v[60:63], v15, s[4:7], 0 offen offset:1024 sc1
s_branch L_p4_done
L_p4_pk:
s_setprio 1
buffer_load_dwordx4 v[116:119], v6, s[4:7], s28 offen offset:0 sc1
buffer_load_dwordx4 v[120:123], v6, s[4:7], s29 offen offset:0 sc1
buffer_load_dwordx4 v[124:127], v6, s[4:7], s28 offen offset:1024 sc1
buffer_load_dwordx4 v[128:131], v6, s[4:7], s29 offen offset:1024 sc1
buffer_load_dwordx4 v[132:135], v6, s[4:7], s28 offen offset:2048 sc1
buffer_load_dwordx4 v[136:139], v6, s[4:7], s29 offen offset:2048 sc1
buffer_load_dwordx4 v[140:143], v6, s[4:7], s28 offen offset:3072 sc1
s_add_u32 s28, s28, 4096
buffer_load_dwordx4 v[144:147], v6, s[4:7], s29 offen offset:3072 sc1
s_add_u32 s29, s29, 4096
ds_read_b128 v[68:71], v12 offset:0
ds_read_b128 v[72:75], v12 offset:1024
ds_read_b128 v[76:79], v12 offset:2048
ds_read_b128 v[80:83], v12 offset:3072
ds_read_b128 v[84:87], v12 offset:4096
ds_read_b128 v[88:91], v12 offset:5120
s_waitcnt vmcnt(6) lgkmcnt(0)
v_mfma_f32_16x16x32_bf16 v[20:23], v[68:71], v[116:119], 0
ds_read_b128 v[92:95], v12 offset:6144
v_mfma_f32_16x16x32_bf16 v[24:27], v[68:71], v[120:123], 0
ds_read_b128 v[96:99], v12 offset:7168
v_mfma_f32_16x16x32_bf16 v[28:31], v[72:75], v[116:119], 0
ds_read_b128 v[100:103], v12 offset:8192
v_mfma_f32_16x16x32_bf16 v[32:35], v[72:75], v[120:123], 0
ds_read_b128 v[104:107], v12 offset:9216
v_mfma_f32_16x16x32_bf16 v[36:39], v[76:79], v[116:119], 0
ds_read_b128 v[108:111], v12 offset:10240
v_mfma_f32_16x16x32_bf16 v[40:43], v[76:79], v[120:123], 0
ds_read_b128 v[112:115], v12 offset:11264
v_mfma_f32_16x16x32_bf16 v[44:47], v[80:83], v[116:119], 0
buffer_load_dwordx4 v[148:151], v6, s[4:7], s28 offen offset:0 sc1
v_mfma_f32_16x16x32_bf16 v[48:51], v[80:83], v[120:123], 0
v_mfma_f32_16x16x32_bf16 v[52:55], v[84:87], v[116:119], 0
buffer_load_dwordx4 v[152:155], v6, s[4:7], s29 offen offset:0 sc1
v_mfma_f32_16x16x32_bf16 v[56:59], v[84:87], v[120:123], 0
v_mfma_f32_16x16x32_bf16 v[60:63], v[88:91], v[116:119], 0
buffer_load_dwordx4 v[156:159], v6, s[4:7], s28 offen offset:1024 sc1
v_mfma_f32_16x16x32_bf16 v[64:67], v[88:91], v[120:123], 0
s_waitcnt vmcnt(7) lgkmcnt(0)
v_mfma_f32_16x16x32_bf16 v[20:23], v[92:95], v[124:127], v[20:23]
ds_read_b128 v[68:71], v12 offset:12288
v_mfma_f32_16x16x32_bf16 v[24:27], v[92:95], v[128:131], v[24:27]
ds_read_b128 v[72:75], v12 offset:13312
v_mfma_f32_16x16x32_bf16 v[28:31], v[96:99], v[124:127], v[28:31]
ds_read_b128 v[76:79], v12 offset:14336
v_mfma_f32_16x16x32_bf16 v[32:35], v[96:99], v[128:131], v[32:35]
ds_read_b128 v[80:83], v12 offset:15360
v_mfma_f32_16x16x32_bf16 v[36:39], v[100:103], v[124:127], v[36:39]
ds_read_b128 v[84:87], v12 offset:16384
v_mfma_f32_16x16x32_bf16 v[40:43], v[100:103], v[128:131], v[40:43]
ds_read_b128 v[88:91], v12 offset:17408
v_mfma_f32_16x16x32_bf16 v[44:47], v[104:107], v[124:127], v[44:47]
buffer_load_dwordx4 v[160:163], v6, s[4:7], s29 offen offset:1024 sc1
v_mfma_f32_16x16x32_bf16 v[48:51], v[104:107], v[128:131], v[48:51]
v_mfma_f32_16x16x32_bf16 v[52:55], v[108:111], v[124:127], v[52:55]
buffer_load_dwordx4 v[116:119], v6, s[4:7], s28 offen offset:2048 sc1
v_mfma_f32_16x16x32_bf16 v[56:59], v[108:111], v[128:131], v[56:59]
v_mfma_f32_16x16x32_bf16 v[60:63], v[112:115], v[124:127], v[60:63]
buffer_load_dwordx4 v[120:123], v6, s[4:7], s29 offen offset:2048 sc1
v_mfma_f32_16x16x32_bf16 v[64:67], v[112:115], v[128:131], v[64:67]
s_waitcnt vmcnt(8) lgkmcnt(0)
v_mfma_f32_16x16x32_bf16 v[20:23], v[68:71], v[132:135], v[20:23]
ds_read_b128 v[92:95], v12 offset:18432
v_mfma_f32_16x16x32_bf16 v[24:27], v[68:71], v[136:139], v[24:27]
ds_read_b128 v[96:99], v12 offset:19456
v_mfma_f32_16x16x32_bf16 v[28:31], v[72:75], v[132:135], v[28:31]
ds_read_b128 v[100:103], v12 offset:20480
v_mfma_f32_16x16x32_bf16 v[32:35], v[72:75], v[136:139], v[32:35]
ds_read_b128 v[104:107], v12 offset:21504
v_mfma_f32_16x16x32_bf16 v[36:39], v[76:79], v[132:135], v[36:39]
ds_read_b128 v[108:111], v12 offset:22528
v_mfma_f32_16x16x32_bf16 v[40:43], v[76:79], v[136:139], v[40:43]
ds_read_b128 v[112:115], v12 offset:23552
v_mfma_f32_16x16x32_bf16 v[44:47], v[80:83], v[132:135], v[44:47]
buffer_load_dwordx4 v[124:127], v6, s[4:7], s28 offen offset:3072 sc1
s_add_u32 s28, s28, 4096
v_mfma_f32_16x16x32_bf16 v[48:51], v[80:83], v[136:139], v[48:51]
v_mfma_f32_16x16x32_bf16 v[52:55], v[84:87], v[132:135], v[52:55]
buffer_load_dwordx4 v[128:131], v6, s[4:7], s29 offen offset:3072 sc1
s_add_u32 s29, s29, 4096
v_mfma_f32_16x16x32_bf16 v[56:59], v[84:87], v[136:139], v[56:59]
v_mfma_f32_16x16x32_bf16 v[60:63], v[88:91], v[132:135], v[60:63]
v_mfma_f32_16x16x32_bf16 v[64:67], v[88:91], v[136:139], v[64:67]
s_waitcnt vmcnt(8) lgkmcnt(0)
v_mfma_f32_16x16x32_bf16 v[20:23], v[92:95], v[140:143], v[20:23]
ds_read_b128 v[68:71], v12 offset:24576
v_mfma_f32_16x16x32_bf16 v[24:27], v[92:95], v[144:147], v[24:27]
ds_read_b128 v[72:75], v12 offset:25600
v_mfma_f32_16x16x32_bf16 v[28:31], v[96:99], v[140:143], v[28:31]
ds_read_b128 v[76:79], v12 offset:26624
v_mfma_f32_16x16x32_bf16 v[32:35], v[96:99], v[144:147], v[32:35]
ds_read_b128 v[80:83], v12 offset:27648
v_mfma_f32_16x16x32_bf16 v[36:39], v[100:103], v[140:143], v[36:39]
ds_read_b128 v[84:87], v12 offset:28672
v_mfma_f32_16x16x32_bf16 v[40:43], v[100:103], v[144:147], v[40:43]
ds_read_b128 v[88:91], v12 offset:29696
v_mfma_f32_16x16x32_bf16 v[44:47], v[104:107], v[140:143], v[44:47]
buffer_load_dwordx4 v[132:135], v6, s[4:7], s28 offen offset:0 sc1
v_mfma_f32_16x16x32_bf16 v[48:51], v[104:107], v[144:147], v[48:51]
v_mfma_f32_16x16x32_bf16 v[52:55], v[108:111], v[140:143], v[52:55]
buffer_load_dwordx4 v[136:139], v6, s[4:7], s29 offen offset:0 sc1
v_mfma_f32_16x16x32_bf16 v[56:59], v[108:111], v[144:147], v[56:59]
v_mfma_f32_16x16x32_bf16 v[60:63], v[112:115], v[140:143], v[60:63]
v_mfma_f32_16x16x32_bf16 v[64:67], v[112:115], v[144:147], v[64:67]
s_waitcnt vmcnt(8) lgkmcnt(0)
v_mfma_f32_16x16x32_bf16 v[20:23], v[68:71], v[148:151], v[20:23]
ds_read_b128 v[92:95], v12 offset:30720
v_mfma_f32_16x16x32_bf16 v[24:27], v[68:71], v[152:155], v[24:27]
ds_read_b128 v[96:99], v12 offset:31744
v_mfma_f32_16x16x32_bf16 v[28:31], v[72:75], v[148:151], v[28:31]
ds_read_b128 v[100:103], v12 offset:32768
v_mfma_f32_16x16x32_bf16 v[32:35], v[72:75], v[152:155], v[32:35]
ds_read_b128 v[104:107], v12 offset:33792
v_mfma_f32_16x16x32_bf16 v[36:39], v[76:79], v[148:151], v[36:39]
ds_read_b128 v[108:111], v12 offset:34816
v_mfma_f32_16x16x32_bf16 v[40:43], v[76:79], v[152:155], v[40:43]
ds_read_b128 v[112:115], v12 offset:35840
v_mfma_f32_16x16x32_bf16 v[44:47], v[80:83], v[148:151], v[44:47]
buffer_load_dwordx4 v[140:143], v6, s[4:7], s28 offen offset:1024 sc1
v_mfma_f32_16x16x32_bf16 v[48:51], v[80:83], v[152:155], v[48:51]
v_mfma_f32_16x16x32_bf16 v[52:55], v[84:87], v[148:151], v[52:55]
buffer_load_dwordx4 v[144:147], v6, s[4:7], s29 offen offset:1024 sc1
v_mfma_f32_16x16x32_bf16 v[56:59], v[84:87], v[152:155], v[56:59]
v_mfma_f32_16x16x32_bf16 v[60:63], v[88:91], v[148:151], v[60:63]
v_mfma_f32_16x16x32_bf16 v[64:67], v[88:91], v[152:155], v[64:67]
s_waitcnt vmcnt(8) lgkmcnt(0)
v_mfma_f32_16x16x32_bf16 v[20:23], v[92:95], v[156:159], v[20:23]
ds_read_b128 v[68:71], v12 offset:36864
v_mfma_f32_16x16x32_bf16 v[24:27], v[92:95], v[160:163], v[24:27]
ds_read_b128 v[72:75], v12 offset:37888
v_mfma_f32_16x16x32_bf16 v[28:31], v[96:99], v[156:159], v[28:31]
ds_read_b128 v[76:79], v12 offset:38912
v_mfma_f32_16x16x32_bf16 v[32:35], v[96:99], v[160:163], v[32:35]
ds_read_b128 v[80:83], v12 offset:39936
v_mfma_f32_16x16x32_bf16 v[36:39], v[100:103], v[156:159], v[36:39]
ds_read_b128 v[84:87], v12 offset:40960
v_mfma_f32_16x16x32_bf16 v[40:43], v[100:103], v[160:163], v[40:43]
ds_read_b128 v[88:91], v12 offset:41984
v_mfma_f32_16x16x32_bf16 v[44:47], v[104:107], v[156:159], v[44:47]
buffer_load_dwordx4 v[148:151], v6, s[4:7], s28 offen offset:2048 sc1
v_mfma_f32_16x16x32_bf16 v[48:51], v[104:107], v[160:163], v[48:51]
v_mfma_f32_16x16x32_bf16 v[52:55], v[108:111], v[156:159], v[52:55]
buffer_load_dwordx4 v[152:155], v6, s[4:7], s29 offen offset:2048 sc1
v_mfma_f32_16x16x32_bf16 v[56:59], v[108:111], v[160:163], v[56:59]
v_mfma_f32_16x16x32_bf16 v[60:63], v[112:115], v[156:159], v[60:63]
v_mfma_f32_16x16x32_bf16 v[64:67], v[112:115], v[160:163], v[64:67]
s_waitcnt vmcnt(8) lgkmcnt(0)
v_mfma_f32_16x16x32_bf16 v[20:23], v[68:71], v[116:119], v[20:23]
ds_read_b128 v[92:95], v12 offset:43008
v_mfma_f32_16x16x32_bf16 v[24:27], v[68:71], v[120:123], v[24:27]
ds_read_b128 v[96:99], v12 offset:44032
v_mfma_f32_16x16x32_bf16 v[28:31], v[72:75], v[116:119], v[28:31]
ds_read_b128 v[100:103], v12 offset:45056
v_mfma_f32_16x16x32_bf16 v[32:35], v[72:75], v[120:123], v[32:35]
ds_read_b128 v[104:107], v12 offset:46080
v_mfma_f32_16x16x32_bf16 v[36:39], v[76:79], v[116:119], v[36:39]
ds_read_b128 v[108:111], v12 offset:47104
v_mfma_f32_16x16x32_bf16 v[40:43], v[76:79], v[120:123], v[40:43]
ds_read_b128 v[112:115], v12 offset:48128
v_mfma_f32_16x16x32_bf16 v[44:47], v[80:83], v[116:119], v[44:47]
buffer_load_dwordx4 v[156:159], v6, s[4:7], s28 offen offset:3072 sc1
s_add_u32 s28, s28, 4096
v_mfma_f32_16x16x32_bf16 v[48:51], v[80:83], v[120:123], v[48:51]
v_mfma_f32_16x16x32_bf16 v[52:55], v[84:87], v[116:119], v[52:55]
buffer_load_dwordx4 v[160:163], v6, s[4:7], s29 offen offset:3072 sc1
s_add_u32 s29, s29, 4096
v_mfma_f32_16x16x32_bf16 v[56:59], v[84:87], v[120:123], v[56:59]
v_mfma_f32_16x16x32_bf16 v[60:63], v[88:91], v[116:119], v[60:63]
v_mfma_f32_16x16x32_bf16 v[64:67], v[88:91], v[120:123], v[64:67]
s_waitcnt vmcnt(8) lgkmcnt(0)
v_mfma_f32_16x16x32_bf16 v[20:23], v[92:95], v[124:127], v[20:23]
ds_read_b128 v[68:71], v12 offset:49152
v_mfma_f32_16x16x32_bf16 v[24:27], v[92:95], v[128:131], v[24:27]
ds_read_b128 v[72:75], v12 offset:50176
v_mfma_f32_16x16x32_bf16 v[28:31], v[96:99], v[124:127], v[28:31]
ds_read_b128 v[76:79], v12 offset:51200
v_mfma_f32_16x16x32_bf16 v[32:35], v[96:99], v[128:131], v[32:35]
ds_read_b128 v[80:83], v12 offset:52224
v_mfma_f32_16x16x32_bf16 v[36:39], v[100:103], v[124:127], v[36:39]
ds_read_b128 v[84:87], v12 offset:53248
v_mfma_f32_16x16x32_bf16 v[40:43], v[100:103], v[128:131], v[40:43]
ds_read_b128 v[88:91], v12 offset:54272
v_mfma_f32_16x16x32_bf16 v[44:47], v[104:107], v[124:127], v[44:47]
buffer_load_dwordx4 v[116:119], v6, s[4:7], s28 offen offset:0 sc1
v_mfma_f32_16x16x32_bf16 v[48:51], v[104:107], v[128:131], v[48:51]
v_mfma_f32_16x16x32_bf16 v[52:55], v[108:111], v[124:127], v[52:55]
buffer_load_dwordx4 v[120:123], v6, s[4:7], s29 offen offset:0 sc1
v_mfma_f32_16x16x32_bf16 v[56:59], v[108:111], v[128:131], v[56:59]
v_mfma_f32_16x16x32_bf16 v[60:63], v[112:115], v[124:127], v[60:63]
v_mfma_f32_16x16x32_bf16 v[64:67], v[112:115], v[128:131], v[64:67]
s_waitcnt vmcnt(8) lgkmcnt(0)
v_mfma_f32_16x16x32_bf16 v[20:23], v[68:71], v[132:135], v[20:23]
ds_read_b128 v[92:95], v12 offset:55296
v_mfma_f32_16x16x32_bf16 v[24:27], v[68:71], v[136:139], v[24:27]
ds_read_b128 v[96:99], v12 offset:56320
v_mfma_f32_16x16x32_bf16 v[28:31], v[72:75], v[132:135], v[28:31]
ds_read_b128 v[100:103], v12 offset:57344
v_mfma_f32_16x16x32_bf16 v[32:35], v[72:75], v[136:139], v[32:35]
ds_read_b128 v[104:107], v12 offset:58368
v_mfma_f32_16x16x32_bf16 v[36:39], v[76:79], v[132:135], v[36:39]
ds_read_b128 v[108:111], v12 offset:59392
v_mfma_f32_16x16x32_bf16 v[40:43], v[76:79], v[136:139], v[40:43]
ds_read_b128 v[112:115], v12 offset:60416
v_mfma_f32_16x16x32_bf16 v[44:47], v[80:83], v[132:135], v[44:47]
buffer_load_dwordx4 v[124:127], v6, s[4:7], s28 offen offset:1024 sc1
v_mfma_f32_16x16x32_bf16 v[48:51], v[80:83], v[136:139], v[48:51]
v_mfma_f32_16x16x32_bf16 v[52:55], v[84:87], v[132:135], v[52:55]
buffer_load_dwordx4 v[128:131], v6, s[4:7], s29 offen offset:1024 sc1
v_mfma_f32_16x16x32_bf16 v[56:59], v[84:87], v[136:139], v[56:59]
v_mfma_f32_16x16x32_bf16 v[60:63], v[88:91], v[132:135], v[60:63]
v_mfma_f32_16x16x32_bf16 v[64:67], v[88:91], v[136:139], v[64:67]
s_waitcnt vmcnt(8) lgkmcnt(0)
v_mfma_f32_16x16x32_bf16 v[20:23], v[92:95], v[140:143], v[20:23]
ds_read_b128 v[68:71], v13 offset:0
v_mfma_f32_16x16x32_bf16 v[24:27], v[92:95], v[144:147], v[24:27]
ds_read_b128 v[72:75], v13 offset:1024
v_mfma_f32_16x16x32_bf16 v[28:31], v[96:99], v[140:143], v[28:31]
ds_read_b128 v[76:79], v13 offset:2048
v_mfma_f32_16x16x32_bf16 v[32:35], v[96:99], v[144:147], v[32:35]
ds_read_b128 v[80:83], v13 offset:3072
v_mfma_f32_16x16x32_bf16 v[36:39], v[100:103], v[140:143], v[36:39]
ds_read_b128 v[84:87], v13 offset:4096
v_mfma_f32_16x16x32_bf16 v[40:43], v[100:103], v[144:147], v[40:43]
ds_read_b128 v[88:91], v13 offset:5120
v_mfma_f32_16x16x32_bf16 v[44:47], v[104:107], v[140:143], v[44:47]
buffer_load_dwordx4 v[132:135], v6, s[4:7], s28 offen offset:2048 sc1
v_mfma_f32_16x16x32_bf16 v[48:51], v[104:107], v[144:147], v[48:51]
v_mfma_f32_16x16x32_bf16 v[52:55], v[108:111], v[140:143], v[52:55]
buffer_load_dwordx4 v[136:139], v6, s[4:7], s29 offen offset:2048 sc1
v_mfma_f32_16x16x32_bf16 v[56:59], v[108:111], v[144:147], v[56:59]
v_mfma_f32_16x16x32_bf16 v[60:63], v[112:115], v[140:143], v[60:63]
v_mfma_f32_16x16x32_bf16 v[64:67], v[112:115], v[144:147], v[64:67]
s_waitcnt vmcnt(8) lgkmcnt(0)
v_mfma_f32_16x16x32_bf16 v[20:23], v[68:71], v[148:151], v[20:23]
ds_read_b128 v[92:95], v13 offset:6144
v_mfma_f32_16x16x32_bf16 v[24:27], v[68:71], v[152:155], v[24:27]
ds_read_b128 v[96:99], v13 offset:7168
v_mfma_f32_16x16x32_bf16 v[28:31], v[72:75], v[148:151], v[28:31]
ds_read_b128 v[100:103], v13 offset:8192
v_mfma_f32_16x16x32_bf16 v[32:35], v[72:75], v[152:155], v[32:35]
ds_read_b128 v[104:107], v13 offset:9216
v_mfma_f32_16x16x32_bf16 v[36:39], v[76:79], v[148:151], v[36:39]
ds_read_b128 v[108:111], v13 offset:10240
v_mfma_f32_16x16x32_bf16 v[40:43], v[76:79], v[152:155], v[40:43]
ds_read_b128 v[112:115], v13 offset:11264
v_mfma_f32_16x16x32_bf16 v[44:47], v[80:83], v[148:151], v[44:47]
buffer_load_dwordx4 v[140:143], v6, s[4:7], s28 offen offset:3072 sc1
s_add_u32 s28, s28, 4096
v_mfma_f32_16x16x32_bf16 v[48:51], v[80:83], v[152:155], v[48:51]
v_mfma_f32_16x16x32_bf16 v[52:55], v[84:87], v[148:151], v[52:55]
buffer_load_dwordx4 v[144:147], v6, s[4:7], s29 offen offset:3072 sc1
s_add_u32 s29, s29, 4096
v_mfma_f32_16x16x32_bf16 v[56:59], v[84:87], v[152:155], v[56:59]
v_mfma_f32_16x16x32_bf16 v[60:63], v[88:91], v[148:151], v[60:63]
v_mfma_f32_16x16x32_bf16 v[64:67], v[88:91], v[152:155], v[64:67]
s_waitcnt vmcnt(8) lgkmcnt(0)
v_mfma_f32_16x16x32_bf16 v[20:23], v[92:95], v[156:159], v[20:23]
ds_read_b128 v[68:71], v13 offset:12288
v_mfma_f32_16x16x32_bf16 v[24:27], v[92:95], v[160:163], v[24:27]
ds_read_b128 v[72:75], v13 offset:13312
v_mfma_f32_16x16x32_bf16 v[28:31], v[96:99], v[156:159], v[28:31]
ds_read_b128 v[76:79], v13 offset:14336
v_mfma_f32_16x16x32_bf16 v[32:35], v[96:99], v[160:163], v[32:35]
ds_read_b128 v[80:83], v13 offset:15360
v_mfma_f32_16x16x32_bf16 v[36:39], v[100:103], v[156:159], v[36:39]
ds_read_b128 v[84:87], v13 offset:16384
v_mfma_f32_16x16x32_bf16 v[40:43], v[100:103], v[160:163], v[40:43]
ds_read_b128 v[88:91], v13 offset:17408
v_mfma_f32_16x16x32_bf16 v[44:47], v[104:107], v[156:159], v[44:47]
buffer_load_dwordx4 v[148:151], v6, s[4:7], s28 offen offset:0 sc1
v_mfma_f32_16x16x32_bf16 v[48:51], v[104:107], v[160:163], v[48:51]
v_mfma_f32_16x16x32_bf16 v[52:55], v[108:111], v[156:159], v[52:55]
buffer_load_dwordx4 v[152:155], v6, s[4:7], s29 offen offset:0 sc1
v_mfma_f32_16x16x32_bf16 v[56:59], v[108:111], v[160:163], v[56:59]
v_mfma_f32_16x16x32_bf16 v[60:63], v[112:115], v[156:159], v[60:63]
v_mfma_f32_16x16x32_bf16 v[64:67], v[112:115], v[160:163], v[64:67]
s_waitcnt vmcnt(8) lgkmcnt(0)
v_mfma_f32_16x16x32_bf16 v[20:23], v[68:71], v[116:119], v[20:23]
ds_read_b128 v[92:95], v13 offset:18432
v_mfma_f32_16x16x32_bf16 v[24:27], v[68:71], v[120:123], v[24:27]
ds_read_b128 v[96:99], v13 offset:19456
v_mfma_f32_16x16x32_bf16 v[28:31], v[72:75], v[116:119], v[28:31]
ds_read_b128 v[100:103], v13 offset:20480
v_mfma_f32_16x16x32_bf16 v[32:35], v[72:75], v[120:123], v[32:35]
ds_read_b128 v[104:107], v13 offset:21504
v_mfma_f32_16x16x32_bf16 v[36:39], v[76:79], v[116:119], v[36:39]
ds_read_b128 v[108:111], v13 offset:22528
v_mfma_f32_16x16x32_bf16 v[40:43], v[76:79], v[120:123], v[40:43]
ds_read_b128 v[112:115], v13 offset:23552
v_mfma_f32_16x16x32_bf16 v[44:47], v[80:83], v[116:119], v[44:47]
buffer_load_dwordx4 v[156:159], v6, s[4:7], s28 offen offset:1024 sc1
v_mfma_f32_16x16x32_bf16 v[48:51], v[80:83], v[120:123], v[48:51]
v_mfma_f32_16x16x32_bf16 v[52:55], v[84:87], v[116:119], v[52:55]
buffer_load_dwordx4 v[160:163], v6, s[4:7], s29 offen offset:1024 sc1
v_mfma_f32_16x16x32_bf16 v[56:59], v[84:87], v[120:123], v[56:59]
v_mfma_f32_16x16x32_bf16 v[60:63], v[88:91], v[116:119], v[60:63]
v_mfma_f32_16x16x32_bf16 v[64:67], v[88:91], v[120:123], v[64:67]
s_waitcnt vmcnt(8) lgkmcnt(0)
v_mfma_f32_16x16x32_bf16 v[20:23], v[92:95], v[124:127], v[20:23]
ds_read_b128 v[68:71], v13 offset:24576
v_mfma_f32_16x16x32_bf16 v[24:27], v[92:95], v[128:131], v[24:27]
ds_read_b128 v[72:75], v13 offset:25600
v_mfma_f32_16x16x32_bf16 v[28:31], v[96:99], v[124:127], v[28:31]
ds_read_b128 v[76:79], v13 offset:26624
v_mfma_f32_16x16x32_bf16 v[32:35], v[96:99], v[128:131], v[32:35]
ds_read_b128 v[80:83], v13 offset:27648
v_mfma_f32_16x16x32_bf16 v[36:39], v[100:103], v[124:127], v[36:39]
ds_read_b128 v[84:87], v13 offset:28672
v_mfma_f32_16x16x32_bf16 v[40:43], v[100:103], v[128:131], v[40:43]
ds_read_b128 v[88:91], v13 offset:29696
v_mfma_f32_16x16x32_bf16 v[44:47], v[104:107], v[124:127], v[44:47]
buffer_load_dwordx4 v[116:119], v6, s[4:7], s28 offen offset:2048 sc1
v_mfma_f32_16x16x32_bf16 v[48:51], v[104:107], v[128:131], v[48:51]
v_mfma_f32_16x16x32_bf16 v[52:55], v[108:111], v[124:127], v[52:55]
buffer_load_dwordx4 v[120:123], v6, s[4:7], s29 offen offset:2048 sc1
v_mfma_f32_16x16x32_bf16 v[56:59], v[108:111], v[128:131], v[56:59]
v_mfma_f32_16x16x32_bf16 v[60:63], v[112:115], v[124:127], v[60:63]
v_mfma_f32_16x16x32_bf16 v[64:67], v[112:115], v[128:131], v[64:67]
s_waitcnt vmcnt(8) lgkmcnt(0)
v_mfma_f32_16x16x32_bf16 v[20:23], v[68:71], v[132:135], v[20:23]
ds_read_b128 v[92:95], v13 offset:30720
v_mfma_f32_16x16x32_bf16 v[24:27], v[68:71], v[136:139], v[24:27]
ds_read_b128 v[96:99], v13 offset:31744
v_mfma_f32_16x16x32_bf16 v[28:31], v[72:75], v[132:135], v[28:31]
ds_read_b128 v[100:103], v13 offset:32768
v_mfma_f32_16x16x32_bf16 v[32:35], v[72:75], v[136:139], v[32:35]
ds_read_b128 v[104:107], v13 offset:33792
v_mfma_f32_16x16x32_bf16 v[36:39], v[76:79], v[132:135], v[36:39]
ds_read_b128 v[108:111], v13 offset:34816
v_mfma_f32_16x16x32_bf16 v[40:43], v[76:79], v[136:139], v[40:43]
ds_read_b128 v[112:115], v13 offset:35840
v_mfma_f32_16x16x32_bf16 v[44:47], v[80:83], v[132:135], v[44:47]
buffer_load_dwordx4 v[124:127], v6, s[4:7], s28 offen offset:3072 sc1
s_add_u32 s28, s28, 4096
v_mfma_f32_16x16x32_bf16 v[48:51], v[80:83], v[136:139], v[48:51]
v_mfma_f32_16x16x32_bf16 v[52:55], v[84:87], v[132:135], v[52:55]
buffer_load_dwordx4 v[128:131], v6, s[4:7], s29 offen offset:3072 sc1
s_add_u32 s29, s29, 4096
v_mfma_f32_16x16x32_bf16 v[56:59], v[84:87], v[136:139], v[56:59]
v_mfma_f32_16x16x32_bf16 v[60:63], v[88:91], v[132:135], v[60:63]
v_mfma_f32_16x16x32_bf16 v[64:67], v[88:91], v[136:139], v[64:67]
s_waitcnt vmcnt(8) lgkmcnt(0)
v_mfma_f32_16x16x32_bf16 v[20:23], v[92:95], v[140:143], v[20:23]
ds_read_b128 v[68:71], v13 offset:36864
v_mfma_f32_16x16x32_bf16 v[24:27], v[92:95], v[144:147], v[24:27]
ds_read_b128 v[72:75], v13 offset:37888
v_mfma_f32_16x16x32_bf16 v[28:31], v[96:99], v[140:143], v[28:31]
ds_read_b128 v[76:79], v13 offset:38912
v_mfma_f32_16x16x32_bf16 v[32:35], v[96:99], v[144:147], v[32:35]
ds_read_b128 v[80:83], v13 offset:39936
v_mfma_f32_16x16x32_bf16 v[36:39], v[100:103], v[140:143], v[36:39]
ds_read_b128 v[84:87], v13 offset:40960
v_mfma_f32_16x16x32_bf16 v[40:43], v[100:103], v[144:147], v[40:43]
ds_read_b128 v[88:91], v13 offset:41984
v_mfma_f32_16x16x32_bf16 v[44:47], v[104:107], v[140:143], v[44:47]
v_mfma_f32_16x16x32_bf16 v[48:51], v[104:107], v[144:147], v[48:51]
v_mfma_f32_16x16x32_bf16 v[52:55], v[108:111], v[140:143], v[52:55]
v_mfma_f32_16x16x32_bf16 v[56:59], v[108:111], v[144:147], v[56:59]
v_mfma_f32_16x16x32_bf16 v[60:63], v[112:115], v[140:143], v[60:63]
v_mfma_f32_16x16x32_bf16 v[64:67], v[112:115], v[144:147], v[64:67]
buffer_load_dwordx2 v[132:133], v16, s[4:7], s30 offen offset:0 sc1
buffer_load_dwordx2 v[134:135], v16, s[4:7], s30 offen offset:128 sc1
buffer_load_dwordx2 v[136:137], v16, s[4:7], s30 offen offset:1024 sc1
buffer_load_dwordx2 v[138:139], v16, s[4:7], s30 offen offset:1152 sc1
s_waitcnt vmcnt(10) lgkmcnt(0)
v_mfma_f32_16x16x32_bf16 v[20:23], v[68:71], v[148:151], v[20:23]
ds_read_b128 v[92:95], v13 offset:43008
v_mfma_f32_16x16x32_bf16 v[24:27], v[68:71], v[152:155], v[24:27]
ds_read_b128 v[96:99], v13 offset:44032
v_mfma_f32_16x16x32_bf16 v[28:31], v[72:75], v[148:151], v[28:31]
ds_read_b128 v[100:103], v13 offset:45056
v_mfma_f32_16x16x32_bf16 v[32:35], v[72:75], v[152:155], v[32:35]
ds_read_b128 v[104:107], v13 offset:46080
v_mfma_f32_16x16x32_bf16 v[36:39], v[76:79], v[148:151], v[36:39]
ds_read_b128 v[108:111], v13 offset:47104
v_mfma_f32_16x16x32_bf16 v[40:43], v[76:79], v[152:155], v[40:43]
ds_read_b128 v[112:115], v13 offset:48128
v_mfma_f32_16x16x32_bf16 v[44:47], v[80:83], v[148:151], v[44:47]
v_mfma_f32_16x16x32_bf16 v[48:51], v[80:83], v[152:155], v[48:51]
v_mfma_f32_16x16x32_bf16 v[52:55], v[84:87], v[148:151], v[52:55]
v_mfma_f32_16x16x32_bf16 v[56:59], v[84:87], v[152:155], v[56:59]
v_mfma_f32_16x16x32_bf16 v[60:63], v[88:91], v[148:151], v[60:63]
v_mfma_f32_16x16x32_bf16 v[64:67], v[88:91], v[152:155], v[64:67]
s_waitcnt vmcnt(8) lgkmcnt(0)
v_mfma_f32_16x16x32_bf16 v[20:23], v[92:95], v[156:159], v[20:23]
ds_read_b128 v[68:71], v13 offset:49152
v_mfma_f32_16x16x32_bf16 v[24:27], v[92:95], v[160:163], v[24:27]
ds_read_b128 v[72:75], v13 offset:50176
v_mfma_f32_16x16x32_bf16 v[28:31], v[96:99], v[156:159], v[28:31]
ds_read_b128 v[76:79], v13 offset:51200
v_mfma_f32_16x16x32_bf16 v[32:35], v[96:99], v[160:163], v[32:35]
ds_read_b128 v[80:83], v13 offset:52224
v_mfma_f32_16x16x32_bf16 v[36:39], v[100:103], v[156:159], v[36:39]
ds_read_b128 v[84:87], v13 offset:53248
v_mfma_f32_16x16x32_bf16 v[40:43], v[100:103], v[160:163], v[40:43]
ds_read_b128 v[88:91], v13 offset:54272
v_mfma_f32_16x16x32_bf16 v[44:47], v[104:107], v[156:159], v[44:47]
v_mfma_f32_16x16x32_bf16 v[48:51], v[104:107], v[160:163], v[48:51]
v_mfma_f32_16x16x32_bf16 v[52:55], v[108:111], v[156:159], v[52:55]
v_mfma_f32_16x16x32_bf16 v[56:59], v[108:111], v[160:163], v[56:59]
v_mfma_f32_16x16x32_bf16 v[60:63], v[112:115], v[156:159], v[60:63]
v_mfma_f32_16x16x32_bf16 v[64:67], v[112:115], v[160:163], v[64:67]
s_waitcnt vmcnt(6) lgkmcnt(0)
v_mfma_f32_16x16x32_bf16 v[20:23], v[68:71], v[116:119], v[20:23]
ds_read_b128 v[92:95], v13 offset:55296
v_mfma_f32_16x16x32_bf16 v[24:27], v[68:71], v[120:123], v[24:27]
ds_read_b128 v[96:99], v13 offset:56320
v_mfma_f32_16x16x32_bf16 v[28:31], v[72:75], v[116:119], v[28:31]
ds_read_b128 v[100:103], v13 offset:57344
v_mfma_f32_16x16x32_bf16 v[32:35], v[72:75], v[120:123], v[32:35]
ds_read_b128 v[104:107], v13 offset:58368
v_mfma_f32_16x16x32_bf16 v[36:39], v[76:79], v[116:119], v[36:39]
ds_read_b128 v[108:111], v13 offset:59392
v_mfma_f32_16x16x32_bf16 v[40:43], v[76:79], v[120:123], v[40:43]
ds_read_b128 v[112:115], v13 offset:60416
v_mfma_f32_16x16x32_bf16 v[44:47], v[80:83], v[116:119], v[44:47]
v_mfma_f32_16x16x32_bf16 v[48:51], v[80:83], v[120:123], v[48:51]
v_mfma_f32_16x16x32_bf16 v[52:55], v[84:87], v[116:119], v[52:55]
v_mfma_f32_16x16x32_bf16 v[56:59], v[84:87], v[120:123], v[56:59]
v_mfma_f32_16x16x32_bf16 v[60:63], v[88:91], v[116:119], v[60:63]
v_mfma_f32_16x16x32_bf16 v[64:67], v[88:91], v[120:123], v[64:67]
s_waitcnt vmcnt(4) lgkmcnt(0)
v_mfma_f32_16x16x32_bf16 v[20:23], v[92:95], v[124:127], v[20:23]
ds_read_b128 v[68:71], v17 offset:0
v_mfma_f32_16x16x32_bf16 v[24:27], v[92:95], v[128:131], v[24:27]
ds_read_b128 v[72:75], v17 offset:64
v_mfma_f32_16x16x32_bf16 v[28:31], v[96:99], v[124:127], v[28:31]
ds_read_b128 v[76:79], v17 offset:128
v_mfma_f32_16x16x32_bf16 v[32:35], v[96:99], v[128:131], v[32:35]
ds_read_b128 v[80:83], v17 offset:192
v_mfma_f32_16x16x32_bf16 v[36:39], v[100:103], v[124:127], v[36:39]
ds_read_b128 v[84:87], v17 offset:256
v_mfma_f32_16x16x32_bf16 v[40:43], v[100:103], v[128:131], v[40:43]
ds_read_b128 v[88:91], v17 offset:320
v_mfma_f32_16x16x32_bf16 v[44:47], v[104:107], v[124:127], v[44:47]
v_mfma_f32_16x16x32_bf16 v[48:51], v[104:107], v[128:131], v[48:51]
v_mfma_f32_16x16x32_bf16 v[52:55], v[108:111], v[124:127], v[52:55]
v_mfma_f32_16x16x32_bf16 v[56:59], v[108:111], v[128:131], v[56:59]
v_mfma_f32_16x16x32_bf16 v[60:63], v[112:115], v[124:127], v[60:63]
v_mfma_f32_16x16x32_bf16 v[64:67], v[112:115], v[128:131], v[64:67]
s_waitcnt vmcnt(0)
v_add_f32 v132, v132, v134
v_add_f32 v133, v133, v135
v_add_f32 v136, v136, v138
v_add_f32 v137, v137, v139
v_mov_b32 v134, v132
v_mov_b32 v135, v133
v_mov_b32 v138, v136
v_mov_b32 v139, v137
v_permlane32_swap_b32 v132, v134
v_permlane32_swap_b32 v133, v135
v_permlane32_swap_b32 v136, v138
v_permlane32_swap_b32 v137, v139
v_add_f32 v132, v132, v134
v_add_f32 v133, v133, v135
v_add_f32 v136, v136, v138
v_add_f32 v137, v137, v139
v_mov_b32 v134, v132
v_mov_b32 v135, v133
v_mov_b32 v138, v136
v_mov_b32 v139, v137
v_permlane16_swap_b32 v132, v134
v_permlane16_swap_b32 v133, v135
v_permlane16_swap_b32 v136, v138
v_permlane16_swap_b32 v137, v139
v_add_f32 v132, v132, v134
v_add_f32 v133, v133, v135
v_add_f32 v136, v136, v138
v_add_f32 v137, v137, v139
v_mul_f32 v132, 0x3acccccd, v132
v_mul_f32 v133, 0x3acccccd, v133
v_mul_f32 v136, 0x3acccccd, v136
v_mul_f32 v137, 0x3acccccd, v137
v_fma_f32 v133, -v132, v132, v133
v_fma_f32 v137, -v136, v136, v137
v_max_f32 v133, 0, v133
v_max_f32 v137, 0, v137
v_add_f32 v142, 0x3727c5ac, v133
v_add_f32 v146, 0x3727c5ac, v137
v_rsq_f32 v141, v142
v_rsq_f32 v145, v146
v_sub_f32 v140, 0, v132
v_sub_f32 v144, 0, v136
v_mul_f32 v141, 0xbfb8aa3b, v141
v_mul_f32 v145, 0xbfb8aa3b, v145
s_waitcnt lgkmcnt(0)
v_pk_fma_f32 v[20:21], v[68:69], v[140:141], v[20:21] op_sel_hi:[1,0,1]
v_pk_fma_f32 v[22:23], v[70:71], v[140:141], v[22:23] op_sel_hi:[1,0,1]
v_pk_fma_f32 v[24:25], v[68:69], v[144:145], v[24:25] op_sel_hi:[1,0,1]
v_pk_fma_f32 v[26:27], v[70:71], v[144:145], v[26:27] op_sel_hi:[1,0,1]
v_pk_fma_f32 v[36:37], v[76:77], v[140:141], v[36:37] op_sel_hi:[1,0,1]
v_pk_fma_f32 v[38:39], v[78:79], v[140:141], v[38:39] op_sel_hi:[1,0,1]
v_pk_fma_f32 v[40:41], v[76:77], v[144:145], v[40:41] op_sel_hi:[1,0,1]
v_pk_fma_f32 v[42:43], v[78:79], v[144:145], v[42:43] op_sel_hi:[1,0,1]
v_pk_fma_f32 v[52:53], v[84:85], v[140:141], v[52:53] op_sel_hi:[1,0,1]
v_pk_fma_f32 v[54:55], v[86:87], v[140:141], v[54:55] op_sel_hi:[1,0,1]
v_pk_fma_f32 v[56:57], v[84:85], v[144:145], v[56:57] op_sel_hi:[1,0,1]
v_pk_fma_f32 v[58:59], v[86:87], v[144:145], v[58:59] op_sel_hi:[1,0,1]
v_pk_mul_f32 v[92:93], v[20:21], v[140:141] op_sel:[0,1] op_sel_hi:[1,1]
v_pk_mul_f32 v[94:95], v[22:23], v[140:141] op_sel:[0,1] op_sel_hi:[1,1]
v_pk_mul_f32 v[96:97], v[24:25], v[144:145] op_sel:[0,1] op_sel_hi:[1,1]
v_pk_mul_f32 v[98:99], v[26:27], v[144:145] op_sel:[0,1] op_sel_hi:[1,1]
v_pk_mul_f32 v[100:101], v[36:37], v[140:141] op_sel:[0,1] op_sel_hi:[1,1]
v_pk_mul_f32 v[102:103], v[38:39], v[140:141] op_sel:[0,1] op_sel_hi:[1,1]
v_pk_mul_f32 v[104:105], v[40:41], v[144:145] op_sel:[0,1] op_sel_hi:[1,1]
v_pk_mul_f32 v[106:107], v[42:43], v[144:145] op_sel:[0,1] op_sel_hi:[1,1]
v_pk_mul_f32 v[108:109], v[52:53], v[140:141] op_sel:[0,1] op_sel_hi:[1,1]
v_pk_mul_f32 v[110:111], v[54:55], v[140:141] op_sel:[0,1] op_sel_hi:[1,1]
v_pk_mul_f32 v[112:113], v[56:57], v[144:145] op_sel:[0,1] op_sel_hi:[1,1]
v_pk_mul_f32 v[114:115], v[58:59], v[144:145] op_sel:[0,1] op_sel_hi:[1,1]
v_exp_f32 v92, v92
v_exp_f32 v93, v93
v_exp_f32 v94, v94
v_exp_f32 v95, v95
v_exp_f32 v96, v96
v_exp_f32 v97, v97
v_exp_f32 v98, v98
v_exp_f32 v99, v99
v_exp_f32 v100, v100
v_exp_f32 v101, v101
v_exp_f32 v102, v102
v_exp_f32 v103, v103
v_exp_f32 v104, v104
v_exp_f32 v105, v105
v_exp_f32 v106, v106
v_exp_f32 v107, v107
v_exp_f32 v108, v108
v_exp_f32 v109, v109
v_exp_f32 v110, v110
v_exp_f32 v111, v111
v_exp_f32 v112, v112
v_exp_f32 v113, v113
v_exp_f32 v114, v114
v_exp_f32 v115, v115
v_pk_fma_f32 v[28:29], v[72:73], v[140:141], v[28:29] op_sel_hi:[1,0,1]
v_pk_fma_f32 v[30:31], v[74:75], v[140:141], v[30:31] op_sel_hi:[1,0,1]
v_pk_fma_f32 v[32:33], v[72:73], v[144:145], v[32:33] op_sel_hi:[1,0,1]
v_pk_fma_f32 v[34:35], v[74:75], v[144:145], v[34:35] op_sel_hi:[1,0,1]
v_pk_fma_f32 v[44:45], v[80:81], v[140:141], v[44:45] op_sel_hi:[1,0,1]
v_pk_fma_f32 v[46:47], v[82:83], v[140:141], v[46:47] op_sel_hi:[1,0,1]
v_pk_fma_f32 v[48:49], v[80:81], v[144:145], v[48:49] op_sel_hi:[1,0,1]
v_pk_fma_f32 v[50:51], v[82:83], v[144:145], v[50:51] op_sel_hi:[1,0,1]
v_pk_fma_f32 v[60:61], v[88:89], v[140:141], v[60:61] op_sel_hi:[1,0,1]
v_pk_fma_f32 v[62:63], v[90:91], v[140:141], v[62:63] op_sel_hi:[1,0,1]
v_pk_fma_f32 v[64:65], v[88:89], v[144:145], v[64:65] op_sel_hi:[1,0,1]
v_pk_fma_f32 v[66:67], v[90:91], v[144:145], v[66:67] op_sel_hi:[1,0,1]
v_pk_fma_f32 v[92:93], v[92:93], v[142:143], v[142:143] op_sel_hi:[1,0,0]
v_pk_fma_f32 v[94:95], v[94:95], v[142:143], v[142:143] op_sel_hi:[1,0,0]
v_pk_fma_f32 v[96:97], v[96:97], v[146:147], v[146:147] op_sel_hi:[1,0,0]
v_pk_fma_f32 v[98:99], v[98:99], v[146:147], v[146:147] op_sel_hi:[1,0,0]
v_pk_fma_f32 v[100:101], v[100:101], v[142:143], v[142:143] op_sel_hi:[1,0,0]
v_pk_fma_f32 v[102:103], v[102:103], v[142:143], v[142:143] op_sel_hi:[1,0,0]
v_pk_fma_f32 v[104:105], v[104:105], v[146:147], v[146:147] op_sel_hi:[1,0,0]
v_pk_fma_f32 v[106:107], v[106:107], v[146:147], v[146:147] op_sel_hi:[1,0,0]
v_pk_fma_f32 v[108:109], v[108:109], v[142:143], v[142:143] op_sel_hi:[1,0,0]
v_pk_fma_f32 v[110:111], v[110:111], v[142:143], v[142:143] op_sel_hi:[1,0,0]
v_pk_fma_f32 v[112:113], v[112:113], v[146:147], v[146:147] op_sel_hi:[1,0,0]
v_pk_fma_f32 v[114:115], v[114:115], v[146:147], v[146:147] op_sel_hi:[1,0,0]
v_pk_mul_f32 v[20:21], v[20:21], v[28:29]
v_pk_mul_f32 v[22:23], v[22:23], v[30:31]
v_pk_mul_f32 v[24:25], v[24:25], v[32:33]
v_pk_mul_f32 v[26:27], v[26:27], v[34:35]
v_pk_mul_f32 v[36:37], v[36:37], v[44:45]
v_pk_mul_f32 v[38:39], v[38:39], v[46:47]
v_pk_mul_f32 v[40:41], v[40:41], v[48:49]
v_pk_mul_f32 v[42:43], v[42:43], v[50:51]
v_pk_mul_f32 v[52:53], v[52:53], v[60:61]
v_pk_mul_f32 v[54:55], v[54:55], v[62:63]
v_pk_mul_f32 v[56:57], v[56:57], v[64:65]
v_pk_mul_f32 v[58:59], v[58:59], v[66:67]
v_rcp_f32 v92, v92
v_rcp_f32 v93, v93
v_rcp_f32 v94, v94
v_rcp_f32 v95, v95
v_rcp_f32 v96, v96
v_rcp_f32 v97, v97
v_rcp_f32 v98, v98
v_rcp_f32 v99, v99
v_pk_mul_f32 v[20:21], v[20:21], v[92:93]
v_pk_mul_f32 v[22:23], v[22:23], v[94:95]
v_pk_mul_f32 v[24:25], v[24:25], v[96:97]
v_pk_mul_f32 v[26:27], v[26:27], v[98:99]
v_cvt_pk_bf16_f32 v28, v20, v21
v_cvt_pk_bf16_f32 v29, v22, v23
v_cvt_pk_bf16_f32 v30, v24, v25
v_cvt_pk_bf16_f32 v31, v26, v27
v_rcp_f32 v100, v100
v_rcp_f32 v101, v101
v_rcp_f32 v102, v102
v_rcp_f32 v103, v103
v_rcp_f32 v104, v104
v_rcp_f32 v105, v105
v_rcp_f32 v106, v106
v_rcp_f32 v107, v107
v_permlane16_swap_b32 v28, v30
v_permlane16_swap_b32 v29, v31
buffer_store_dwordx4 v[28:31], v15, s[4:7], 0 offen offset:0 sc1
v_pk_mul_f32 v[36:37], v[36:37], v[100:101]
v_pk_mul_f32 v[38:39], v[38:39], v[102:103]
v_pk_mul_f32 v[40:41], v[40:41], v[104:105]
v_pk_mul_f32 v[42:43], v[42:43], v[106:107]
v_cvt_pk_bf16_f32 v44, v36, v37
v_cvt_pk_bf16_f32 v45, v38, v39
v_cvt_pk_bf16_f32 v46, v40, v41
v_cvt_pk_bf16_f32 v47, v42, v43
v_rcp_f32 v108, v108
v_rcp_f32 v109, v109
v_rcp_f32 v110, v110
v_rcp_f32 v111, v111
v_rcp_f32 v112, v112
v_rcp_f32 v113, v113
v_rcp_f32 v114, v114
v_rcp_f32 v115, v115
v_permlane16_swap_b32 v44, v46
v_permlane16_swap_b32 v45, v47
buffer_store_dwordx4 v[44:47], v15, s[4:7], 0 offen offset:512 sc1
v_pk_mul_f32 v[52:53], v[52:53], v[108:109]
v_pk_mul_f32 v[54:55], v[54:55], v[110:111]
v_pk_mul_f32 v[56:57], v[56:57], v[112:113]
v_pk_mul_f32 v[58:59], v[58:59], v[114:115]
v_cvt_pk_bf16_f32 v60, v52, v53
v_cvt_pk_bf16_f32 v61, v54, v55
v_cvt_pk_bf16_f32 v62, v56, v57
v_cvt_pk_bf16_f32 v63, v58, v59
s_nop 0
v_permlane16_swap_b32 v60, v62
v_permlane16_swap_b32 v61, v63
buffer_store_dwordx4 v[60:63], v15, s[4:7], 0 offen offset:1024 sc1
s_setprio 0
L_p4_done:
s_and_b32 s32, s19, 3
s_lshr_b32 s33, s19, 2
s_and_b32 s34, s16, 1
s_bfe_u32 s35, s16, 0x10001
s_lshl_b32 s39, s18, 4
s_lshl_b32 s24, s32, 2
s_add_u32 s39, s39, s24
s_lshl_b32 s24, s34, 1
s_add_u32 s39, s39, s24
s_add_u32 s39, s39, s35
s_xor_b32 s24, s39, 1
s_mul_i32 s36, s39, 49152
s_mul_i32 s37, s24, 49152
s_mul_i32 s24, s35, 24576
s_add_u32 s24, s24, 14680064
s_add_u32 s36, s36, s24
s_add_u32 s37, s37, s24
s_mul_i32 s24, s35, 76800
s_add_u32 s24, s24, 0
v_add_u32 v12, s24, v6
v_add_u32 v13, 40960, v12
s_mov_b32 s8, s54
s_mov_b32 s9, s55
s_mov_b32 s10, 0x280000
s_mov_b32 s11, 0x20000
s_mul_i32 s38, s33, 245760
s_add_u32 s38, s38, 25722880
s_lshl_b32 s25, s18, 10
v_lshlrev_b32 v10, 13, v0
s_lshl_b32 s24, s19, 2
s_add_u32 s24, s24, s25
s_add_u32 s47, s24, 27853440
v_mov_b32 v9, s17
s_waitcnt vmcnt(0)
s_barrier
s_cmp_eq_u32 s16, 7
s_cbranch_scc1 L_p5_sync
s_cmp_lt_u32 s16, 4
s_cbranch_scc1 L_p5_wr
s_lshl_b32 s26, s16, 10
s_add_u32 s26, s26, 94208
v_add_u32 v2, s26, v6
v_add_u32 v3, 36864, v2
ds_write_b128 v2, v[168:171] offset:0
ds_write_b128 v2, v[172:175] offset:3072
ds_write_b128 v2, v[176:179] offset:6144
ds_write_b128 v2, v[180:183] offset:9216
ds_write_b128 v2, v[184:187] offset:12288
ds_write_b128 v2, v[188:191] offset:15360
ds_write_b128 v2, v[192:195] offset:18432
ds_write_b128 v2, v[200:203] offset:21504
ds_write_b128 v2, v[204:207] offset:24576
ds_write_b128 v2, v[208:211] offset:27648
ds_write_b128 v2, v[212:215] offset:30720
ds_write_b128 v2, v[216:219] offset:33792
ds_write_b128 v3, v[220:223] offset:0
ds_write_b128 v3, v[224:227] offset:3072
ds_write_b128 v3, v[228:231] offset:6144
ds_write_b128 v3, v[232:235] offset:9216
ds_write_b128 v3, v[236:239] offset:12288
ds_write_b128 v3, v[240:243] offset:15360
s_branch L_p5_go
L_p5_wr:
s_lshl_b32 s26, s16, 10
s_add_u32 s26, s26, 0
v_add_u32 v2, s26, v6
v_add_u32 v3, 49152, v2
ds_write_b128 v2, v[168:171] offset:0
ds_write_b128 v2, v[172:175] offset:4096
ds_write_b128 v2, v[176:179] offset:8192
ds_write_b128 v2, v[180:183] offset:12288
ds_write_b128 v2, v[184:187] offset:16384
ds_write_b128 v2, v[188:191] offset:20480
ds_write_b128 v2, v[192:195] offset:24576
ds_write_b128 v2, v[196:199] offset:28672
ds_write_b128 v2, v[212:215] offset:32768
ds_write_b128 v2, v[216:219] offset:36864
ds_write_b128 v2, v[220:223] offset:40960
ds_write_b128 v2, v[224:227] offset:45056
ds_write_b128 v3, v[228:231] offset:0
ds_write_b128 v3, v[232:235] offset:4096
ds_write_b128 v3, v[236:239] offset:8192
ds_write_b128 v3, v[240:243] offset:12288
ds_write_b128 v3, v[244:247] offset:16384
ds_write_b128 v3, v[248:251] offset:20480
ds_write_b128 v3, v[252:255] offset:24576
ds_write_b128 v3, v[92:95] offset:28672
ds_write_b128 v3, v[96:99] offset:32768
ds_write_b128 v3, v[100:103] offset:36864
ds_write_b128 v3, v[104:107] offset:40960
ds_write_b128 v3, v[108:111] offset:45056
v_lshlrev_b32 v20, 16, v200
v_and_b32 v21, s20, v200
v_lshlrev_b32 v22, 16, v201
v_and_b32 v23, s20, v201
v_lshlrev_b32 v24, 16, v202
v_and_b32 v25, s20, v202
v_lshlrev_b32 v26, 16, v203
v_and_b32 v27, s20, v203
v_lshlrev_b32 v28, 16, v204
v_and_b32 v29, s20, v204
v_lshlrev_b32 v30, 16, v205
v_and_b32 v31, s20, v205
v_lshlrev_b32 v32, 16, v206
v_and_b32 v33, s20, v206
v_lshlrev_b32 v34, 16, v207
v_and_b32 v35, s20, v207
v_lshlrev_b32 v36, 16, v208
v_and_b32 v37, s20, v208
v_lshlrev_b32 v38, 16, v209
v_and_b32 v39, s20, v209
s_branch L_p5_go
L_p5_sync:
s_mov_b32 exec_hi, 0
buffer_atomic_swap v9, v10, s[4:7], s47 offen sc1
s_lshl_b32 s25, s2, 10
s_add_u32 s25, s25, 27853440
v_lshlrev_b32 v10, 2, v0
s_movk_i32 s24, 20000
L_poll_13:
v_mov_b32 v1, 0
buffer_atomic_or v1, v10, s[4:7], s25 offen sc0 sc1
s_sub_u32 s24, s24, 1
s_cbranch_scc1 L_pollok_14
s_waitcnt vmcnt(0)
v_cmp_ne_u32 vcc, s17, v1
s_cbranch_vccnz L_poll_13
L_pollok_14:
s_waitcnt vmcnt(0)
s_mov_b64 exec, -1
L_p5_go:
s_waitcnt lgkmcnt(0)
s_barrier
s_cmp_ge_u32 s16, 4
s_cbranch_scc1 L_p5_help
buffer_load_dwordx4 v[100:103], v6, s[4:7], s36 offen offset:0 sc1
buffer_load_dwordx4 v[104:107], v6, s[4:7], s37 offen offset:0 sc1
buffer_load_dwordx4 v[108:111], v6, s[4:7], s36 offen offset:1024 sc1
buffer_load_dwordx4 v[112:115], v6, s[4:7], s37 offen offset:1024 sc1
buffer_load_dwordx4 v[116:119], v6, s[4:7], s36 offen offset:2048 sc1
buffer_load_dwordx4 v[120:123], v6, s[4:7], s37 offen offset:2048 sc1
buffer_load_dwordx4 v[124:127], v6, s[4:7], s36 offen offset:3072 sc1
buffer_load_dwordx4 v[128:131], v6, s[4:7], s37 offen offset:3072 sc1
s_add_u32 s36, s36, 4096
s_add_u32 s37, s37, 4096
buffer_load_dwordx4 v[132:135], v6, s[4:7], s36 offen offset:0 sc1
buffer_load_dwordx4 v[136:139], v6, s[4:7], s37 offen offset:0 sc1
buffer_load_dwordx4 v[140:143], v6, s[4:7], s36 offen offset:1024 sc1
buffer_load_dwordx4 v[144:147], v6, s[4:7], s37 offen offset:1024 sc1
ds_read_b128 v[60:63], v12 offset:0
ds_read_b128 v[64:67], v12 offset:1024
ds_read_b128 v[68:71], v12 offset:2048
ds_read_b128 v[72:75], v12 offset:3072
ds_read_b128 v[76:79], v12 offset:4096
s_waitcnt vmcnt(10) lgkmcnt(0)
v_mfma_f32_16x16x32_bf16 v[20:23], v[60:63], v[100:103], v[20:23]
ds_read_b128 v[80:83], v12 offset:5120
v_mfma_f32_16x16x32_bf16 v[40:43], v[60:63], v[104:107], 0
ds_read_b128 v[84:87], v12 offset:6144
v_mfma_f32_16x16x32_bf16 v[24:27], v[64:67], v[100:103], v[24:27]
ds_read_b128 v[88:91], v12 offset:7168
v_mfma_f32_16x16x32_bf16 v[44:47], v[64:67], v[104:107], 0
ds_read_b128 v[92:95], v12 offset:8192
v_mfma_f32_16x16x32_bf16 v[28:31], v[68:71], v[100:103], v[28:31]
ds_read_b128 v[96:99], v12 offset:9216
v_mfma_f32_16x16x32_bf16 v[48:51], v[68:71], v[104:107], 0
v_mfma_f32_16x16x32_bf16 v[32:35], v[72:75], v[100:103], v[32:35]
v_mfma_f32_16x16x32_bf16 v[52:55], v[72:75], v[104:107], 0
v_mfma_f32_16x16x32_bf16 v[36:39], v[76:79], v[100:103], v[36:39]
v_mfma_f32_16x16x32_bf16 v[56:59], v[76:79], v[104:107], 0
s_waitcnt vmcnt(8) lgkmcnt(0)
v_mfma_f32_16x16x32_bf16 v[20:23], v[80:83], v[108:111], v[20:23]
ds_read_b128 v[60:63], v12 offset:10240
v_mfma_f32_16x16x32_bf16 v[40:43], v[80:83], v[112:115], v[40:43]
ds_read_b128 v[64:67], v12 offset:11264
v_mfma_f32_16x16x32_bf16 v[24:27], v[84:87], v[108:111], v[24:27]
ds_read_b128 v[68:71], v12 offset:12288
v_mfma_f32_16x16x32_bf16 v[44:47], v[84:87], v[112:115], v[44:47]
ds_read_b128 v[72:75], v12 offset:13312
v_mfma_f32_16x16x32_bf16 v[28:31], v[88:91], v[108:111], v[28:31]
ds_read_b128 v[76:79], v12 offset:14336
v_mfma_f32_16x16x32_bf16 v[48:51], v[88:91], v[112:115], v[48:51]
v_mfma_f32_16x16x32_bf16 v[32:35], v[92:95], v[108:111], v[32:35]
buffer_load_dwordx4 v[100:103], v6, s[4:7], s36 offen offset:2048 sc1
buffer_load_dwordx4 v[104:107], v6, s[4:7], s37 offen offset:2048 sc1
v_mfma_f32_16x16x32_bf16 v[52:55], v[92:95], v[112:115], v[52:55]
v_mfma_f32_16x16x32_bf16 v[36:39], v[96:99], v[108:111], v[36:39]
v_mfma_f32_16x16x32_bf16 v[56:59], v[96:99], v[112:115], v[56:59]
s_waitcnt vmcnt(8) lgkmcnt(0)
v_mfma_f32_16x16x32_bf16 v[20:23], v[60:63], v[116:119], v[20:23]
ds_read_b128 v[80:83], v12 offset:15360
v_mfma_f32_16x16x32_bf16 v[40:43], v[60:63], v[120:123], v[40:43]
ds_read_b128 v[84:87], v12 offset:16384
v_mfma_f32_16x16x32_bf16 v[24:27], v[64:67], v[116:119], v[24:27]
ds_read_b128 v[88:91], v12 offset:17408
v_mfma_f32_16x16x32_bf16 v[44:47], v[64:67], v[120:123], v[44:47]
ds_read_b128 v[92:95], v12 offset:18432
v_mfma_f32_16x16x32_bf16 v[28:31], v[68:71], v[116:119], v[28:31]
ds_read_b128 v[96:99], v12 offset:19456
v_mfma_f32_16x16x32_bf16 v[48:51], v[68:71], v[120:123], v[48:51]
v_mfma_f32_16x16x32_bf16 v[32:35], v[72:75], v[116:119], v[32:35]
buffer_load_dwordx4 v[108:111], v6, s[4:7], s36 offen offset:3072 sc1
buffer_load_dwordx4 v[112:115], v6, s[4:7], s37 offen offset:3072 sc1
s_add_u32 s36, s36, 4096
s_add_u32 s37, s37, 4096
v_mfma_f32_16x16x32_bf16 v[52:55], v[72:75], v[120:123], v[52:55]
v_mfma_f32_16x16x32_bf16 v[36:39], v[76:79], v[116:119], v[36:39]
v_mfma_f32_16x16x32_bf16 v[56:59], v[76:79], v[120:123], v[56:59]
s_waitcnt vmcnt(8) lgkmcnt(0)
s_barrier
v_mfma_f32_16x16x32_bf16 v[20:23], v[80:83], v[124:127], v[20:23]
ds_read_b128 v[60:63], v12 offset:20480
v_mfma_f32_16x16x32_bf16 v[40:43], v[80:83], v[128:131], v[40:43]
ds_read_b128 v[64:67], v12 offset:21504
v_mfma_f32_16x16x32_bf16 v[24:27], v[84:87], v[124:127], v[24:27]
ds_read_b128 v[68:71], v12 offset:22528
v_mfma_f32_16x16x32_bf16 v[44:47], v[84:87], v[128:131], v[44:47]
ds_read_b128 v[72:75], v12 offset:23552
v_mfma_f32_16x16x32_bf16 v[28:31], v[88:91], v[124:127], v[28:31]
ds_read_b128 v[76:79], v12 offset:24576
v_mfma_f32_16x16x32_bf16 v[48:51], v[88:91], v[128:131], v[48:51]
v_mfma_f32_16x16x32_bf16 v[32:35], v[92:95], v[124:127], v[32:35]
buffer_load_dwordx4 v[116:119], v6, s[4:7], s36 offen offset:0 sc1
buffer_load_dwordx4 v[120:123], v6, s[4:7], s37 offen offset:0 sc1
v_mfma_f32_16x16x32_bf16 v[52:55], v[92:95], v[128:131], v[52:55]
v_mfma_f32_16x16x32_bf16 v[36:39], v[96:99], v[124:127], v[36:39]
v_mfma_f32_16x16x32_bf16 v[56:59], v[96:99], v[128:131], v[56:59]
s_waitcnt vmcnt(8) lgkmcnt(0)
v_mfma_f32_16x16x32_bf16 v[20:23], v[60:63], v[132:135], v[20:23]
ds_read_b128 v[80:83], v12 offset:25600
v_mfma_f32_16x16x32_bf16 v[40:43], v[60:63], v[136:139], v[40:43]
ds_read_b128 v[84:87], v12 offset:26624
v_mfma_f32_16x16x32_bf16 v[24:27], v[64:67], v[132:135], v[24:27]
ds_read_b128 v[88:91], v12 offset:27648
v_mfma_f32_16x16x32_bf16 v[44:47], v[64:67], v[136:139], v[44:47]
ds_read_b128 v[92:95], v12 offset:28672
v_mfma_f32_16x16x32_bf16 v[28:31], v[68:71], v[132:135], v[28:31]
ds_read_b128 v[96:99], v12 offset:29696
v_mfma_f32_16x16x32_bf16 v[48:51], v[68:71], v[136:139], v[48:51]
v_mfma_f32_16x16x32_bf16 v[32:35], v[72:75], v[132:135], v[32:35]
buffer_load_dwordx4 v[124:127], v6, s[4:7], s36 offen offset:1024 sc1
buffer_load_dwordx4 v[128:131], v6, s[4:7], s37 offen offset:1024 sc1
v_mfma_f32_16x16x32_bf16 v[52:55], v[72:75], v[136:139], v[52:55]
v_mfma_f32_16x16x32_bf16 v[36:39], v[76:79], v[132:135], v[36:39]
v_mfma_f32_16x16x32_bf16 v[56:59], v[76:79], v[136:139], v[56:59]
s_waitcnt vmcnt(8) lgkmcnt(0)
v_mfma_f32_16x16x32_bf16 v[20:23], v[80:83], v[140:143], v[20:23]
ds_read_b128 v[60:63], v12 offset:30720
v_mfma_f32_16x16x32_bf16 v[40:43], v[80:83], v[144:147], v[40:43]
ds_read_b128 v[64:67], v12 offset:31744
v_mfma_f32_16x16x32_bf16 v[24:27], v[84:87], v[140:143], v[24:27]
ds_read_b128 v[68:71], v12 offset:32768
v_mfma_f32_16x16x32_bf16 v[44:47], v[84:87], v[144:147], v[44:47]
ds_read_b128 v[72:75], v12 offset:33792
v_mfma_f32_16x16x32_bf16 v[28:31], v[88:91], v[140:143], v[28:31]
ds_read_b128 v[76:79], v12 offset:34816
v_mfma_f32_16x16x32_bf16 v[48:51], v[88:91], v[144:147], v[48:51]
v_mfma_f32_16x16x32_bf16 v[32:35], v[92:95], v[140:143], v[32:35]
buffer_load_dwordx4 v[132:135], v6, s[4:7], s36 offen offset:2048 sc1
buffer_load_dwordx4 v[136:139], v6, s[4:7], s37 offen offset:2048 sc1
v_mfma_f32_16x16x32_bf16 v[52:55], v[92:95], v[144:147], v[52:55]
v_mfma_f32_16x16x32_bf16 v[36:39], v[96:99], v[140:143], v[36:39]
v_mfma_f32_16x16x32_bf16 v[56:59], v[96:99], v[144:147], v[56:59]
s_waitcnt vmcnt(8) lgkmcnt(0)
s_barrier
v_mfma_f32_16x16x32_bf16 v[20:23], v[60:63], v[100:103], v[20:23]
ds_read_b128 v[80:83], v12 offset:35840
v_mfma_f32_16x16x32_bf16 v[40:43], v[60:63], v[104:107], v[40:43]
ds_read_b128 v[84:87], v12 offset:36864
v_mfma_f32_16x16x32_bf16 v[24:27], v[64:67], v[100:103], v[24:27]
ds_read_b128 v[88:91], v12 offset:37888
v_mfma_f32_16x16x32_bf16 v[44:47], v[64:67], v[104:107], v[44:47]
ds_read_b128 v[92:95], v12 offset:38912
v_mfma_f32_16x16x32_bf16 v[28:31], v[68:71], v[100:103], v[28:31]
ds_read_b128 v[96:99], v12 offset:39936
v_mfma_f32_16x16x32_bf16 v[48:51], v[68:71], v[104:107], v[48:51]
v_mfma_f32_16x16x32_bf16 v[32:35], v[72:75], v[100:103], v[32:35]
buffer_load_dwordx4 v[140:143], v6, s[4:7], s36 offen offset:3072 sc1
buffer_load_dwordx4 v[144:147], v6, s[4:7], s37 offen offset:3072 sc1
s_add_u32 s36, s36, 4096
s_add_u32 s37, s37, 4096
v_mfma_f32_16x16x32_bf16 v[52:55], v[72:75], v[104:107], v[52:55]
v_mfma_f32_16x16x32_bf16 v[36:39], v[76:79], v[100:103], v[36:39]
v_mfma_f32_16x16x32_bf16 v[56:59], v[76:79], v[104:107], v[56:59]
s_waitcnt vmcnt(8) lgkmcnt(0)
v_mfma_f32_16x16x32_bf16 v[20:23], v[80:83], v[108:111], v[20:23]
ds_read_b128 v[60:63], v13 offset:0
v_mfma_f32_16x16x32_bf16 v[40:43], v[80:83], v[112:115], v[40:43]
ds_read_b128 v[64:67], v13 offset:1024
v_mfma_f32_16x16x32_bf16 v[24:27], v[84:87], v[108:111], v[24:27]
ds_read_b128 v[68:71], v13 offset:2048
v_mfma_f32_16x16x32_bf16 v[44:47], v[84:87], v[112:115], v[44:47]
ds_read_b128 v[72:75], v13 offset:3072
v_mfma_f32_16x16x32_bf16 v[28:31], v[88:91], v[108:111], v[28:31]
ds_read_b128 v[76:79], v13 offset:4096
v_mfma_f32_16x16x32_bf16 v[48:51], v[88:91], v[112:115], v[48:51]
v_mfma_f32_16x16x32_bf16 v[32:35], v[92:95], v[108:111], v[32:35]
buffer_load_dwordx4 v[100:103], v6, s[4:7], s36 offen offset:0 sc1
buffer_load_dwordx4 v[104:107], v6, s[4:7], s37 offen offset:0 sc1
v_mfma_f32_16x16x32_bf16 v[52:55], v[92:95], v[112:115], v[52:55]
v_mfma_f32_16x16x32_bf16 v[36:39], v[96:99], v[108:111], v[36:39]
v_mfma_f32_16x16x32_bf16 v[56:59], v[96:99], v[112:115], v[56:59]
s_waitcnt vmcnt(8) lgkmcnt(0)
v_mfma_f32_16x16x32_bf16 v[20:23], v[60:63], v[116:119], v[20:23]
ds_read_b128 v[80:83], v13 offset:5120
v_mfma_f32_16x16x32_bf16 v[40:43], v[60:63], v[120:123], v[40:43]
ds_read_b128 v[84:87], v13 offset:6144
v_mfma_f32_16x16x32_bf16 v[24:27], v[64:67], v[116:119], v[24:27]
ds_read_b128 v[88:91], v13 offset:7168
v_mfma_f32_16x16x32_bf16 v[44:47], v[64:67], v[120:123], v[44:47]
ds_read_b128 v[92:95], v13 offset:8192
v_mfma_f32_16x16x32_bf16 v[28:31], v[68:71], v[116:119], v[28:31]
ds_read_b128 v[96:99], v13 offset:9216
v_mfma_f32_16x16x32_bf16 v[48:51], v[68:71], v[120:123], v[48:51]
v_mfma_f32_16x16x32_bf16 v[32:35], v[72:75], v[116:119], v[32:35]
buffer_load_dwordx4 v[108:111], v6, s[4:7], s36 offen offset:1024 sc1
buffer_load_dwordx4 v[112:115], v6, s[4:7], s37 offen offset:1024 sc1
v_mfma_f32_16x16x32_bf16 v[52:55], v[72:75], v[120:123], v[52:55]
v_mfma_f32_16x16x32_bf16 v[36:39], v[76:79], v[116:119], v[36:39]
v_mfma_f32_16x16x32_bf16 v[56:59], v[76:79], v[120:123], v[56:59]
s_waitcnt vmcnt(8) lgkmcnt(0)
s_barrier
v_mfma_f32_16x16x32_bf16 v[20:23], v[80:83], v[124:127], v[20:23]
ds_read_b128 v[60:63], v13 offset:10240
v_mfma_f32_16x16x32_bf16 v[40:43], v[80:83], v[128:131], v[40:43]
ds_read_b128 v[64:67], v13 offset:11264
v_mfma_f32_16x16x32_bf16 v[24:27], v[84:87], v[124:127], v[24:27]
ds_read_b128 v[68:71], v13 offset:12288
v_mfma_f32_16x16x32_bf16 v[44:47], v[84:87], v[128:131], v[44:47]
ds_read_b128 v[72:75], v13 offset:13312
v_mfma_f32_16x16x32_bf16 v[28:31], v[88:91], v[124:127], v[28:31]
ds_read_b128 v[76:79], v13 offset:14336
v_mfma_f32_16x16x32_bf16 v[48:51], v[88:91], v[128:131], v[48:51]
v_mfma_f32_16x16x32_bf16 v[32:35], v[92:95], v[124:127], v[32:35]
buffer_load_dwordx4 v[116:119], v6, s[4:7], s36 offen offset:2048 sc1
buffer_load_dwordx4 v[120:123], v6, s[4:7], s37 offen offset:2048 sc1
v_mfma_f32_16x16x32_bf16 v[52:55], v[92:95], v[128:131], v[52:55]
v_mfma_f32_16x16x32_bf16 v[36:39], v[96:99], v[124:127], v[36:39]
v_mfma_f32_16x16x32_bf16 v[56:59], v[96:99], v[128:131], v[56:59]
s_waitcnt vmcnt(8) lgkmcnt(0)
v_mfma_f32_16x16x32_bf16 v[20:23], v[60:63], v[132:135], v[20:23]
ds_read_b128 v[80:83], v13 offset:15360
v_mfma_f32_16x16x32_bf16 v[40:43], v[60:63], v[136:139], v[40:43]
ds_read_b128 v[84:87], v13 offset:16384
v_mfma_f32_16x16x32_bf16 v[24:27], v[64:67], v[132:135], v[24:27]
ds_read_b128 v[88:91], v13 offset:17408
v_mfma_f32_16x16x32_bf16 v[44:47], v[64:67], v[136:139], v[44:47]
ds_read_b128 v[92:95], v13 offset:18432
v_mfma_f32_16x16x32_bf16 v[28:31], v[68:71], v[132:135], v[28:31]
ds_read_b128 v[96:99], v13 offset:19456
v_mfma_f32_16x16x32_bf16 v[48:51], v[68:71], v[136:139], v[48:51]
v_mfma_f32_16x16x32_bf16 v[32:35], v[72:75], v[132:135], v[32:35]
buffer_load_dwordx4 v[124:127], v6, s[4:7], s36 offen offset:3072 sc1
buffer_load_dwordx4 v[128:131], v6, s[4:7], s37 offen offset:3072 sc1
s_add_u32 s36, s36, 4096
s_add_u32 s37, s37, 4096
v_mfma_f32_16x16x32_bf16 v[52:55], v[72:75], v[136:139], v[52:55]
v_mfma_f32_16x16x32_bf16 v[36:39], v[76:79], v[132:135], v[36:39]
v_mfma_f32_16x16x32_bf16 v[56:59], v[76:79], v[136:139], v[56:59]
s_waitcnt vmcnt(8) lgkmcnt(0)
v_mfma_f32_16x16x32_bf16 v[20:23], v[80:83], v[140:143], v[20:23]
ds_read_b128 v[60:63], v13 offset:20480
v_mfma_f32_16x16x32_bf16 v[40:43], v[80:83], v[144:147], v[40:43]
ds_read_b128 v[64:67], v13 offset:21504
v_mfma_f32_16x16x32_bf16 v[24:27], v[84:87], v[140:143], v[24:27]
ds_read_b128 v[68:71], v13 offset:22528
v_mfma_f32_16x16x32_bf16 v[44:47], v[84:87], v[144:147], v[44:47]
ds_read_b128 v[72:75], v13 offset:23552
v_mfma_f32_16x16x32_bf16 v[28:31], v[88:91], v[140:143], v[28:31]
ds_read_b128 v[76:79], v13 offset:24576
v_mfma_f32_16x16x32_bf16 v[48:51], v[88:91], v[144:147], v[48:51]
v_mfma_f32_16x16x32_bf16 v[32:35], v[92:95], v[140:143], v[32:35]
buffer_load_dwordx4 v[132:135], v6, s[4:7], s36 offen offset:0 sc1
buffer_load_dwordx4 v[136:139], v6, s[4:7], s37 offen offset:0 sc1
v_mfma_f32_16x16x32_bf16 v[52:55], v[92:95], v[144:147], v[52:55]
v_mfma_f32_16x16x32_bf16 v[36:39], v[96:99], v[140:143], v[36:39]
v_mfma_f32_16x16x32_bf16 v[56:59], v[96:99], v[144:147], v[56:59]
s_waitcnt vmcnt(8) lgkmcnt(0)
v_mfma_f32_16x16x32_bf16 v[20:23], v[60:63], v[100:103], v[20:23]
ds_read_b128 v[80:83], v13 offset:25600
v_mfma_f32_16x16x32_bf16 v[40:43], v[60:63], v[104:107], v[40:43]
ds_read_b128 v[84:87], v13 offset:26624
v_mfma_f32_16x16x32_bf16 v[24:27], v[64:67], v[100:103], v[24:27]
ds_read_b128 v[88:91], v13 offset:27648
v_mfma_f32_16x16x32_bf16 v[44:47], v[64:67], v[104:107], v[44:47]
ds_read_b128 v[92:95], v13 offset:28672
v_mfma_f32_16x16x32_bf16 v[28:31], v[68:71], v[100:103], v[28:31]
ds_read_b128 v[96:99], v13 offset:29696
v_mfma_f32_16x16x32_bf16 v[48:51], v[68:71], v[104:107], v[48:51]
v_mfma_f32_16x16x32_bf16 v[32:35], v[72:75], v[100:103], v[32:35]
buffer_load_dwordx4 v[140:143], v6, s[4:7], s36 offen offset:1024 sc1
buffer_load_dwordx4 v[144:147], v6, s[4:7], s37 offen offset:1024 sc1
v_mfma_f32_16x16x32_bf16 v[52:55], v[72:75], v[104:107], v[52:55]
v_mfma_f32_16x16x32_bf16 v[36:39], v[76:79], v[100:103], v[36:39]
v_mfma_f32_16x16x32_bf16 v[56:59], v[76:79], v[104:107], v[56:59]
s_waitcnt vmcnt(8) lgkmcnt(0)
v_mfma_f32_16x16x32_bf16 v[20:23], v[80:83], v[108:111], v[20:23]
ds_read_b128 v[60:63], v13 offset:30720
v_mfma_f32_16x16x32_bf16 v[40:43], v[80:83], v[112:115], v[40:43]
ds_read_b128 v[64:67], v13 offset:31744
v_mfma_f32_16x16x32_bf16 v[24:27], v[84:87], v[108:111], v[24:27]
ds_read_b128 v[68:71], v13 offset:32768
v_mfma_f32_16x16x32_bf16 v[44:47], v[84:87], v[112:115], v[44:47]
ds_read_b128 v[72:75], v13 offset:33792
v_mfma_f32_16x16x32_bf16 v[28:31], v[88:91], v[108:111], v[28:31]
ds_read_b128 v[76:79], v13 offset:34816
v_mfma_f32_16x16x32_bf16 v[48:51], v[88:91], v[112:115], v[48:51]
v_mfma_f32_16x16x32_bf16 v[32:35], v[92:95], v[108:111], v[32:35]
buffer_load_dwordx4 v[100:103], v6, s[4:7], s36 offen offset:2048 sc1
buffer_load_dwordx4 v[104:107], v6, s[4:7], s37 offen offset:2048 sc1
v_mfma_f32_16x16x32_bf16 v[52:55], v[92:95], v[112:115], v[52:55]
v_mfma_f32_16x16x32_bf16 v[36:39], v[96:99], v[108:111], v[36:39]
v_mfma_f32_16x16x32_bf16 v[56:59], v[96:99], v[112:115], v[56:59]
s_waitcnt vmcnt(8) lgkmcnt(0)
s_barrier
v_mfma_f32_16x16x32_bf16 v[20:23], v[60:63], v[116:119], v[20:23]
ds_read_b128 v[80:83], v12 offset:0
v_mfma_f32_16x16x32_bf16 v[40:43], v[60:63], v[120:123], v[40:43]
ds_read_b128 v[84:87], v12 offset:1024
v_mfma_f32_16x16x32_bf16 v[24:27], v[64:67], v[116:119], v[24:27]
ds_read_b128 v[88:91], v12 offset:2048
v_mfma_f32_16x16x32_bf16 v[44:47], v[64:67], v[120:123], v[44:47]
ds_read_b128 v[92:95], v12 offset:3072
v_mfma_f32_16x16x32_bf16 v[28:31], v[68:71], v[116:119], v[28:31]
ds_read_b128 v[96:99], v12 offset:4096
v_mfma_f32_16x16x32_bf16 v[48:51], v[68:71], v[120:123], v[48:51]
v_mfma_f32_16x16x32_bf16 v[32:35], v[72:75], v[116:119], v[32:35]
buffer_load_dwordx4 v[108:111], v6, s[4:7], s36 offen offset:3072 sc1
buffer_load_dwordx4 v[112:115], v6, s[4:7], s37 offen offset:3072 sc1
s_add_u32 s36, s36, 4096
s_add_u32 s37, s37, 4096
v_mfma_f32_16x16x32_bf16 v[52:55], v[72:75], v[120:123], v[52:55]
v_mfma_f32_16x16x32_bf16 v[36:39], v[76:79], v[116:119], v[36:39]
v_mfma_f32_16x16x32_bf16 v[56:59], v[76:79], v[120:123], v[56:59]
s_waitcnt vmcnt(8) lgkmcnt(0)
v_mfma_f32_16x16x32_bf16 v[20:23], v[80:83], v[124:127], v[20:23]
ds_read_b128 v[60:63], v12 offset:5120
v_mfma_f32_16x16x32_bf16 v[40:43], v[80:83], v[128:131], v[40:43]
ds_read_b128 v[64:67], v12 offset:6144
v_mfma_f32_16x16x32_bf16 v[24:27], v[84:87], v[124:127], v[24:27]
ds_read_b128 v[68:71], v12 offset:7168
v_mfma_f32_16x16x32_bf16 v[44:47], v[84:87], v[128:131], v[44:47]
ds_read_b128 v[72:75], v12 offset:8192
v_mfma_f32_16x16x32_bf16 v[28:31], v[88:91], v[124:127], v[28:31]
ds_read_b128 v[76:79], v12 offset:9216
v_mfma_f32_16x16x32_bf16 v[48:51], v[88:91], v[128:131], v[48:51]
v_mfma_f32_16x16x32_bf16 v[32:35], v[92:95], v[124:127], v[32:35]
buffer_load_dwordx4 v[116:119], v6, s[4:7], s36 offen offset:0 sc1
buffer_load_dwordx4 v[120:123], v6, s[4:7], s37 offen offset:0 sc1
v_mfma_f32_16x16x32_bf16 v[52:55], v[92:95], v[128:131], v[52:55]
v_mfma_f32_16x16x32_bf16 v[36:39], v[96:99], v[124:127], v[36:39]
v_mfma_f32_16x16x32_bf16 v[56:59], v[96:99], v[128:131], v[56:59]
s_waitcnt vmcnt(8) lgkmcnt(0)
v_mfma_f32_16x16x32_bf16 v[20:23], v[60:63], v[132:135], v[20:23]
ds_read_b128 v[80:83], v12 offset:10240
v_mfma_f32_16x16x32_bf16 v[40:43], v[60:63], v[136:139], v[40:43]
ds_read_b128 v[84:87], v12 offset:11264
v_mfma_f32_16x16x32_bf16 v[24:27], v[64:67], v[132:135], v[24:27]
ds_read_b128 v[88:91], v12 offset:12288
v_mfma_f32_16x16x32_bf16 v[44:47], v[64:67], v[136:139], v[44:47]
ds_read_b128 v[92:95], v12 offset:13312
v_mfma_f32_16x16x32_bf16 v[28:31], v[68:71], v[132:135], v[28:31]
ds_read_b128 v[96:99], v12 offset:14336
v_mfma_f32_16x16x32_bf16 v[48:51], v[68:71], v[136:139], v[48:51]
v_mfma_f32_16x16x32_bf16 v[32:35], v[72:75], v[132:135], v[32:35]
buffer_load_dwordx4 v[124:127], v6, s[4:7], s36 offen offset:1024 sc1
buffer_load_dwordx4 v[128:131], v6, s[4:7], s37 offen offset:1024 sc1
v_mfma_f32_16x16x32_bf16 v[52:55], v[72:75], v[136:139], v[52:55]
v_mfma_f32_16x16x32_bf16 v[36:39], v[76:79], v[132:135], v[36:39]
v_mfma_f32_16x16x32_bf16 v[56:59], v[76:79], v[136:139], v[56:59]
s_waitcnt vmcnt(8) lgkmcnt(0)
s_barrier
v_mfma_f32_16x16x32_bf16 v[20:23], v[80:83], v[140:143], v[20:23]
ds_read_b128 v[60:63], v12 offset:15360
v_mfma_f32_16x16x32_bf16 v[40:43], v[80:83], v[144:147], v[40:43]
ds_read_b128 v[64:67], v12 offset:16384
v_mfma_f32_16x16x32_bf16 v[24:27], v[84:87], v[140:143], v[24:27]
ds_read_b128 v[68:71], v12 offset:17408
v_mfma_f32_16x16x32_bf16 v[44:47], v[84:87], v[144:147], v[44:47]
ds_read_b128 v[72:75], v12 offset:18432
v_mfma_f32_16x16x32_bf16 v[28:31], v[88:91], v[140:143], v[28:31]
ds_read_b128 v[76:79], v12 offset:19456
v_mfma_f32_16x16x32_bf16 v[48:51], v[88:91], v[144:147], v[48:51]
v_mfma_f32_16x16x32_bf16 v[32:35], v[92:95], v[140:143], v[32:35]
buffer_load_dwordx4 v[132:135], v6, s[4:7], s36 offen offset:2048 sc1
buffer_load_dwordx4 v[136:139], v6, s[4:7], s37 offen offset:2048 sc1
v_mfma_f32_16x16x32_bf16 v[52:55], v[92:95], v[144:147], v[52:55]
v_mfma_f32_16x16x32_bf16 v[36:39], v[96:99], v[140:143], v[36:39]
v_mfma_f32_16x16x32_bf16 v[56:59], v[96:99], v[144:147], v[56:59]
s_waitcnt vmcnt(8) lgkmcnt(0)
v_mfma_f32_16x16x32_bf16 v[20:23], v[60:63], v[100:103], v[20:23]
ds_read_b128 v[80:83], v12 offset:20480
v_mfma_f32_16x16x32_bf16 v[40:43], v[60:63], v[104:107], v[40:43]
ds_read_b128 v[84:87], v12 offset:21504
v_mfma_f32_16x16x32_bf16 v[24:27], v[64:67], v[100:103], v[24:27]
ds_read_b128 v[88:91], v12 offset:22528
v_mfma_f32_16x16x32_bf16 v[44:47], v[64:67], v[104:107], v[44:47]
ds_read_b128 v[92:95], v12 offset:23552
v_mfma_f32_16x16x32_bf16 v[28:31], v[68:71], v[100:103], v[28:31]
ds_read_b128 v[96:99], v12 offset:24576
v_mfma_f32_16x16x32_bf16 v[48:51], v[68:71], v[104:107], v[48:51]
v_mfma_f32_16x16x32_bf16 v[32:35], v[72:75], v[100:103], v[32:35]
buffer_load_dwordx4 v[140:143], v6, s[4:7], s36 offen offset:3072 sc1
buffer_load_dwordx4 v[144:147], v6, s[4:7], s37 offen offset:3072 sc1
s_add_u32 s36, s36, 4096
s_add_u32 s37, s37, 4096
v_mfma_f32_16x16x32_bf16 v[52:55], v[72:75], v[104:107], v[52:55]
v_mfma_f32_16x16x32_bf16 v[36:39], v[76:79], v[100:103], v[36:39]
v_mfma_f32_16x16x32_bf16 v[56:59], v[76:79], v[104:107], v[56:59]
s_waitcnt vmcnt(8) lgkmcnt(0)
v_mfma_f32_16x16x32_bf16 v[20:23], v[80:83], v[108:111], v[20:23]
ds_read_b128 v[60:63], v12 offset:25600
v_mfma_f32_16x16x32_bf16 v[40:43], v[80:83], v[112:115], v[40:43]
ds_read_b128 v[64:67], v12 offset:26624
v_mfma_f32_16x16x32_bf16 v[24:27], v[84:87], v[108:111], v[24:27]
ds_read_b128 v[68:71], v12 offset:27648
v_mfma_f32_16x16x32_bf16 v[44:47], v[84:87], v[112:115], v[44:47]
ds_read_b128 v[72:75], v12 offset:28672
v_mfma_f32_16x16x32_bf16 v[28:31], v[88:91], v[108:111], v[28:31]
ds_read_b128 v[76:79], v12 offset:29696
v_mfma_f32_16x16x32_bf16 v[48:51], v[88:91], v[112:115], v[48:51]
v_mfma_f32_16x16x32_bf16 v[32:35], v[92:95], v[108:111], v[32:35]
v_mfma_f32_16x16x32_bf16 v[52:55], v[92:95], v[112:115], v[52:55]
v_mfma_f32_16x16x32_bf16 v[36:39], v[96:99], v[108:111], v[36:39]
v_mfma_f32_16x16x32_bf16 v[56:59], v[96:99], v[112:115], v[56:59]
s_waitcnt vmcnt(6) lgkmcnt(0)
s_barrier
v_mfma_f32_16x16x32_bf16 v[20:23], v[60:63], v[116:119], v[20:23]
ds_read_b128 v[80:83], v12 offset:30720
v_mfma_f32_16x16x32_bf16 v[40:43], v[60:63], v[120:123], v[40:43]
ds_read_b128 v[84:87], v12 offset:31744
v_mfma_f32_16x16x32_bf16 v[24:27], v[64:67], v[116:119], v[24:27]
ds_read_b128 v[88:91], v12 offset:32768
v_mfma_f32_16x16x32_bf16 v[44:47], v[64:67], v[120:123], v[44:47]
ds_read_b128 v[92:95], v12 offset:33792
v_mfma_f32_16x16x32_bf16 v[28:31], v[68:71], v[116:119], v[28:31]
ds_read_b128 v[96:99], v12 offset:34816
v_mfma_f32_16x16x32_bf16 v[48:51], v[68:71], v[120:123], v[48:51]
v_mfma_f32_16x16x32_bf16 v[32:35], v[72:75], v[116:119], v[32:35]
v_mfma_f32_16x16x32_bf16 v[52:55], v[72:75], v[120:123], v[52:55]
v_mfma_f32_16x16x32_bf16 v[36:39], v[76:79], v[116:119], v[36:39]
v_mfma_f32_16x16x32_bf16 v[56:59], v[76:79], v[120:123], v[56:59]
s_waitcnt vmcnt(4) lgkmcnt(0)
v_mfma_f32_16x16x32_bf16 v[20:23], v[80:83], v[124:127], v[20:23]
ds_read_b128 v[60:63], v12 offset:35840
v_mfma_f32_16x16x32_bf16 v[40:43], v[80:83], v[128:131], v[40:43]
ds_read_b128 v[64:67], v12 offset:36864
v_mfma_f32_16x16x32_bf16 v[24:27], v[84:87], v[124:127], v[24:27]
ds_read_b128 v[68:71], v12 offset:37888
v_mfma_f32_16x16x32_bf16 v[44:47], v[84:87], v[128:131], v[44:47]
ds_read_b128 v[72:75], v12 offset:38912
v_mfma_f32_16x16x32_bf16 v[28:31], v[88:91], v[124:127], v[28:31]
ds_read_b128 v[76:79], v12 offset:39936
v_mfma_f32_16x16x32_bf16 v[48:51], v[88:91], v[128:131], v[48:51]
v_mfma_f32_16x16x32_bf16 v[32:35], v[92:95], v[124:127], v[32:35]
v_mfma_f32_16x16x32_bf16 v[52:55], v[92:95], v[128:131], v[52:55]
v_mfma_f32_16x16x32_bf16 v[36:39], v[96:99], v[124:127], v[36:39]
v_mfma_f32_16x16x32_bf16 v[56:59], v[96:99], v[128:131], v[56:59]
s_waitcnt vmcnt(2) lgkmcnt(0)
v_mfma_f32_16x16x32_bf16 v[20:23], v[60:63], v[132:135], v[20:23]
ds_read_b128 v[80:83], v13 offset:0
v_mfma_f32_16x16x32_bf16 v[40:43], v[60:63], v[136:139], v[40:43]
ds_read_b128 v[84:87], v13 offset:1024
v_mfma_f32_16x16x32_bf16 v[24:27], v[64:67], v[132:135], v[24:27]
ds_read_b128 v[88:91], v13 offset:2048
v_mfma_f32_16x16x32_bf16 v[44:47], v[64:67], v[136:139], v[44:47]
ds_read_b128 v[92:95], v13 offset:3072
v_mfma_f32_16x16x32_bf16 v[28:31], v[68:71], v[132:135], v[28:31]
ds_read_b128 v[96:99], v13 offset:4096
v_mfma_f32_16x16x32_bf16 v[48:51], v[68:71], v[136:139], v[48:51]
v_mfma_f32_16x16x32_bf16 v[32:35], v[72:75], v[132:135], v[32:35]
v_mfma_f32_16x16x32_bf16 v[52:55], v[72:75], v[136:139], v[52:55]
v_mfma_f32_16x16x32_bf16 v[36:39], v[76:79], v[132:135], v[36:39]
v_mfma_f32_16x16x32_bf16 v[56:59], v[76:79], v[136:139], v[56:59]
s_waitcnt vmcnt(0) lgkmcnt(0)
v_mfma_f32_16x16x32_bf16 v[20:23], v[80:83], v[140:143], v[20:23]
v_mfma_f32_16x16x32_bf16 v[40:43], v[80:83], v[144:147], v[40:43]
v_mfma_f32_16x16x32_bf16 v[24:27], v[84:87], v[140:143], v[24:27]
v_mfma_f32_16x16x32_bf16 v[44:47], v[84:87], v[144:147], v[44:47]
v_mfma_f32_16x16x32_bf16 v[28:31], v[88:91], v[140:143], v[28:31]
v_mfma_f32_16x16x32_bf16 v[48:51], v[88:91], v[144:147], v[48:51]
v_mfma_f32_16x16x32_bf16 v[32:35], v[92:95], v[140:143], v[32:35]
v_mfma_f32_16x16x32_bf16 v[52:55], v[92:95], v[144:147], v[52:55]
v_mfma_f32_16x16x32_bf16 v[36:39], v[96:99], v[140:143], v[36:39]
v_mfma_f32_16x16x32_bf16 v[56:59], v[96:99], v[144:147], v[56:59]
s_mul_i32 s24, s16, 5120
s_add_u32 s24, s24, 46080
v_add_u32 v1, s24, v6
s_xor_b32 s25, s16, 2
s_mul_i32 s25, s25, 5120
s_add_u32 s25, s25, 46080
v_add_u32 v2, s25, v6
ds_write_b128 v1, v[40:43] offset:0
ds_write_b128 v1, v[44:47] offset:1024
ds_write_b128 v1, v[48:51] offset:2048
ds_write_b128 v1, v[52:55] offset:3072
ds_write_b128 v1, v[56:59] offset:4096
s_waitcnt lgkmcnt(0)
s_barrier
ds_read_b128 v[40:43], v2 offset:0
ds_read_b128 v[44:47], v2 offset:1024
ds_read_b128 v[48:51], v2 offset:2048
ds_read_b128 v[52:55], v2 offset:3072
ds_read_b128 v[56:59], v2 offset:4096
s_waitcnt lgkmcnt(4)
v_pk_add_f32 v[20:21], v[20:21], v[40:41]
v_pk_add_f32 v[22:23], v[22:23], v[42:43]
v_cvt_pk_bf16_f32 v200, v20, v21
v_cvt_pk_bf16_f32 v201, v22, v23
s_waitcnt lgkmcnt(3)
v_pk_add_f32 v[24:25], v[24:25], v[44:45]
v_pk_add_f32 v[26:27], v[26:27], v[46:47]
v_cvt_pk_bf16_f32 v202, v24, v25
v_cvt_pk_bf16_f32 v203, v26, v27
s_waitcnt lgkmcnt(2)
v_pk_add_f32 v[28:29], v[28:29], v[48:49]
v_pk_add_f32 v[30:31], v[30:31], v[50:51]
v_cvt_pk_bf16_f32 v204, v28, v29
v_cvt_pk_bf16_f32 v205, v30, v31
s_waitcnt lgkmcnt(1)
v_pk_add_f32 v[32:33], v[32:33], v[52:53]
v_pk_add_f32 v[34:35], v[34:35], v[54:55]
v_cvt_pk_bf16_f32 v206, v32, v33
v_cvt_pk_bf16_f32 v207, v34, v35
s_waitcnt lgkmcnt(0)
v_pk_add_f32 v[36:37], v[36:37], v[56:57]
v_pk_add_f32 v[38:39], v[38:39], v[58:59]
v_cvt_pk_bf16_f32 v208, v36, v37
v_cvt_pk_bf16_f32 v209, v38, v39
buffer_store_dwordx4 v[200:203], v210, s[8:11], 0 offen
buffer_store_dwordx4 v[204:207], v210, s[8:11], 0 offen offset:64
buffer_store_dwordx2 v[208:209], v211, s[8:11], 0 offen offset:128
s_endpgm
L_p5_help:
s_cmp_eq_u32 s16, 7
s_cbranch_scc1 L_p5_idle
s_sub_u32 s26, s16, 4
s_mul_i32 s26, s26, 5120
v_add_u32 v2, s26, v6
v_add_u32 v3, 76800, v2
s_add_u32 s26, s26, s38
s_sub_u32 s27, s26, s38
s_barrier
s_add_u32 m0, s27, 0
s_add_u32 s25, s26, 76800
buffer_load_dwordx4 v6, s[4:7], s25 offen offset:0 sc1 lds
buffer_load_dwordx4 v6, s[4:7], s25 offen offset:1024 sc1 lds
buffer_load_dwordx4 v6, s[4:7], s25 offen offset:2048 sc1 lds
buffer_load_dwordx4 v6, s[4:7], s25 offen offset:3072 sc1 lds
s_add_u32 m0, m0, 4096
s_add_u32 s25, s25, 4096
buffer_load_dwordx4 v6, s[4:7], s25 offen sc1 lds
s_add_u32 m0, s27, 76800
s_add_u32 s25, s26, 199680
buffer_load_dwordx4 v6, s[4:7], s25 offen offset:0 sc1 lds
buffer_load_dwordx4 v6, s[4:7], s25 offen offset:1024 sc1 lds
buffer_load_dwordx4 v6, s[4:7], s25 offen offset:2048 sc1 lds
buffer_load_dwordx4 v6, s[4:7], s25 offen offset:3072 sc1 lds
s_add_u32 m0, m0, 4096
s_add_u32 s25, s25, 4096
buffer_load_dwordx4 v6, s[4:7], s25 offen sc1 lds
s_barrier
s_add_u32 m0, s27, 15360
s_add_u32 s25, s26, 92160
buffer_load_dwordx4 v6, s[4:7], s25 offen offset:0 sc1 lds
buffer_load_dwordx4 v6, s[4:7], s25 offen offset:1024 sc1 lds
buffer_load_dwordx4 v6, s[4:7], s25 offen offset:2048 sc1 lds
buffer_load_dwordx4 v6, s[4:7], s25 offen offset:3072 sc1 lds
s_add_u32 m0, m0, 4096
s_add_u32 s25, s25, 4096
buffer_load_dwordx4 v6, s[4:7], s25 offen sc1 lds
s_add_u32 m0, s27, 92160
s_add_u32 s25, s26, 215040
buffer_load_dwordx4 v6, s[4:7], s25 offen offset:0 sc1 lds
buffer_load_dwordx4 v6, s[4:7], s25 offen offset:1024 sc1 lds
buffer_load_dwordx4 v6, s[4:7], s25 offen offset:2048 sc1 lds
buffer_load_dwordx4 v6, s[4:7], s25 offen offset:3072 sc1 lds
s_add_u32 m0, m0, 4096
s_add_u32 s25, s25, 4096
buffer_load_dwordx4 v6, s[4:7], s25 offen sc1 lds
s_barrier
s_add_u32 m0, s27, 30720
s_add_u32 s25, s26, 107520
buffer_load_dwordx4 v6, s[4:7], s25 offen offset:0 sc1 lds
buffer_load_dwordx4 v6, s[4:7], s25 offen offset:1024 sc1 lds
buffer_load_dwordx4 v6, s[4:7], s25 offen offset:2048 sc1 lds
buffer_load_dwordx4 v6, s[4:7], s25 offen offset:3072 sc1 lds
s_add_u32 m0, m0, 4096
s_add_u32 s25, s25, 4096
buffer_load_dwordx4 v6, s[4:7], s25 offen sc1 lds
s_add_u32 m0, s27, 107520
s_add_u32 s25, s26, 230400
buffer_load_dwordx4 v6, s[4:7], s25 offen offset:0 sc1 lds
buffer_load_dwordx4 v6, s[4:7], s25 offen offset:1024 sc1 lds
buffer_load_dwordx4 v6, s[4:7], s25 offen offset:2048 sc1 lds
buffer_load_dwordx4 v6, s[4:7], s25 offen offset:3072 sc1 lds
s_add_u32 m0, m0, 4096
s_add_u32 s25, s25, 4096
buffer_load_dwordx4 v6, s[4:7], s25 offen sc1 lds
s_waitcnt vmcnt(20)
s_barrier
s_waitcnt vmcnt(10)
s_barrier
s_waitcnt vmcnt(0)
s_barrier
s_branch L_p5_last
L_p5_idle:
s_barrier
s_barrier
s_barrier
s_barrier
s_barrier
s_barrier
L_p5_last:
s_barrier
s_endpgm
L_at_slow:
s_waitcnt vmcnt(0) lgkmcnt(0)
s_mov_b32 s34, 2
s_mov_b32 s35, 0
v_mov_b32 v48, 0xff800000
v_mov_b32 v49, 0xff800000
v_mov_b32 v50, 0xff800000
v_mov_b32 v51, 0xff800000
v_mov_b32 v52, 0xff800000
v_mov_b32 v53, 0xff800000
v_mov_b32 v54, 0xff800000
v_mov_b32 v55, 0xff800000
v_mov_b32 v56, 0xff800000
v_mov_b32 v57, 0xff800000
v_mov_b32 v58, 0xff800000
v_mov_b32 v59, 0xff800000
v_mov_b32 v60, 0xff800000
v_mov_b32 v61, 0xff800000
v_mov_b32 v62, 0xff800000
v_mov_b32 v63, 0xff800000
v_mov_b32 v64, 0xff800000
v_mov_b32 v65, 0xff800000
v_mov_b32 v66, 0xff800000
v_mov_b32 v67, 0xff800000
v_mov_b32 v68, 0xff800000
v_mov_b32 v69, 0xff800000
v_mov_b32 v70, 0xff800000
v_mov_b32 v71, 0xff800000
v_mov_b32 v72, 0xff800000
v_mov_b32 v73, 0xff800000
v_mov_b32 v74, 0xff800000
v_mov_b32 v75, 0xff800000
v_mov_b32 v76, 0xff800000
v_mov_b32 v77, 0xff800000
v_mov_b32 v78, 0xff800000
v_mov_b32 v79, 0xff800000
v_subrev_u32 v4, s38, v17
L_at_slowloop:
s_lshl_b32 s24, s29, 5
s_add_u32 s24, s24, s35
s_add_u32 s24, s24, 63
s_and_b32 s24, s24, 63
s_lshl_b32 s25, s30, 6
s_add_u32 s24, s24, s25
s_mul_i32 s24, s24, 3072
v_add_u32 v3, s24, v4
buffer_load_dwordx4 v[36:39], v6, s[4:7], s24 offen sc1
buffer_load_dwordx2 v[34:35], v3, s[4:7], 0 offen offset:2560 sc1
s_waitcnt vmcnt(0)
v_mfma_f32_32x32x4_2b_bf16 v[80:111], v[34:35], v[32:33], 0
s_nop 15
s_nop 1
v_mfma_f32_32x32x16_bf16 v[80:95], v[36:39], v[24:27], v[80:95]
v_mfma_f32_32x32x16_bf16 v[96:111], v[36:39], v[28:31], v[96:111]
s_nop 10
v_max_f32 v48, v48, v80
v_max_f32 v49, v49, v81
v_max_f32 v50, v50, v82
v_max_f32 v51, v51, v83
v_max_f32 v52, v52, v84
v_max_f32 v53, v53, v85
v_max_f32 v54, v54, v86
v_max_f32 v55, v55, v87
v_max_f32 v56, v56, v88
v_max_f32 v57, v57, v89
v_max_f32 v58, v58, v90
v_max_f32 v59, v59, v91
v_max_f32 v60, v60, v92
v_max_f32 v61, v61, v93
v_max_f32 v62, v62, v94
v_max_f32 v63, v63, v95
v_max_f32 v64, v64, v96
v_max_f32 v65, v65, v97
v_max_f32 v66, v66, v98
v_max_f32 v67, v67, v99
v_max_f32 v68, v68, v100
v_max_f32 v69, v69, v101
v_max_f32 v70, v70, v102
v_max_f32 v71, v71, v103
v_max_f32 v72, v72, v104
v_max_f32 v73, v73, v105
v_max_f32 v74, v74, v106
v_max_f32 v75, v75, v107
v_max_f32 v76, v76, v108
v_max_f32 v77, v77, v109
v_max_f32 v78, v78, v110
v_max_f32 v79, v79, v111
s_add_u32 s35, s35, 1
s_cmp_lt_u32 s35, 32
s_cbranch_scc1 L_at_slowloop
v_max3_f32 v20, v48, v49, v50
v_max3_f32 v20, v51, v52, v20
v_max3_f32 v20, v53, v54, v20
v_max3_f32 v20, v55, v56, v20
v_max3_f32 v20, v57, v58, v20
v_max3_f32 v20, v59, v60, v20
v_max3_f32 v20, v61, v62, v20
v_max_f32 v20, v63, v20
v_max3_f32 v21, v64, v65, v66
v_max3_f32 v21, v67, v68, v21
v_max3_f32 v21, v69, v70, v21
v_max3_f32 v21, v71, v72, v21
v_max3_f32 v21, v73, v74, v21
v_max3_f32 v21, v75, v76, v21
v_max3_f32 v21, v77, v78, v21
v_max_f32 v21, v79, v21
s_nop 1
v_permlane32_swap_b32 v20, v21
v_max_f32 v20, v20, v21
v_mov_b32 v144, 0
v_mov_b32 v145, 0
v_mov_b32 v146, 0
v_mov_b32 v147, 0
v_mov_b32 v148, 0
v_mov_b32 v149, 0
v_mov_b32 v150, 0
v_mov_b32 v151, 0
v_mov_b32 v152, 0
v_mov_b32 v153, 0
v_mov_b32 v154, 0
v_mov_b32 v155, 0
v_mov_b32 v156, 0
v_mov_b32 v157, 0
v_mov_b32 v158, 0
v_mov_b32 v159, 0
v_mov_b32 v160, 0
v_mov_b32 v161, 0
v_mov_b32 v162, 0
v_mov_b32 v163, 0
v_mov_b32 v164, 0
v_mov_b32 v165, 0
v_mov_b32 v166, 0
v_mov_b32 v167, 0
v_mov_b32 v168, 0
v_mov_b32 v169, 0
v_mov_b32 v170, 0
v_mov_b32 v171, 0
v_mov_b32 v172, 0
v_mov_b32 v173, 0
v_mov_b32 v174, 0
v_mov_b32 v175, 0
v_mov_b32 v136, 0
v_mov_b32 v44, 0
v_mov_b32 v137, 0
v_mov_b32 v45, 0
v_mov_b32 v138, 0
v_mov_b32 v46, 0
v_mov_b32 v139, 0
v_mov_b32 v47, 0
s_barrier
buffer_load_dwordx4 v[36:39], v6, s[4:7], s38 offen sc1
buffer_load_dwordx2 v[34:35], v17, s[4:7], 0 offen offset:2560 sc1
s_mov_b32 s32, s37
s_add_u32 m0, s33, 0
s_sub_u32 s24, s32, s0
buffer_load_dwordx4 v6, s[4:7], s32 offen sc1 lds
buffer_load_dwordx4 v6, s[4:7], s32 offen offset:1024 sc1 lds
buffer_load_dwordx4 v15, s[4:7], s24 offen offset:2048 sc1 lds
s_add_u32 s32, s32, 12288
s_add_u32 m0, s33, 12288
s_sub_u32 s24, s32, s0
buffer_load_dwordx4 v6, s[4:7], s32 offen sc1 lds
buffer_load_dwordx4 v6, s[4:7], s32 offen offset:1024 sc1 lds
buffer_load_dwordx4 v15, s[4:7], s24 offen offset:2048 sc1 lds
s_add_u32 s32, s32, 12288
s_waitcnt vmcnt(6)
v_mfma_f32_32x32x4_2b_bf16 v[80:111], v[34:35], v[32:33], 0
s_nop 15
s_nop 1
v_mfma_f32_32x32x16_bf16 v[80:95], v[36:39], v[24:27], v[80:95]
v_mfma_f32_32x32x16_bf16 v[96:111], v[36:39], v[28:31], v[96:111]
s_lshl_b32 s24, s16, 8
s_add_u32 s24, s24, 49152
v_lshl_add_u32 v1, v0, 2, s24
ds_write_b32 v1, v20
v_xor_b32 v1, 1152, v1
s_waitcnt vmcnt(3) lgkmcnt(0)
s_barrier
ds_read_b32 v2, v1
ds_read_b128 v[40:43], v14
s_waitcnt lgkmcnt(1)
v_max_f32 v2, v2, v20
v_sub_f32 v2, 0, v2
v_mov_b32 v3, v2
ds_read_b128 v[36:39], v12
ds_read_b64 v[34:35], v13
v_permlane32_swap_b32 v2, v3
v_add_f32 v80, v80, v2
v_add_f32 v96, v96, v3
v_add_f32 v81, v81, v2
v_add_f32 v97, v97, v3
v_add_f32 v82, v82, v2
v_add_f32 v98, v98, v3
v_add_f32 v83, v83, v2
v_add_f32 v99, v99, v3
v_add_f32 v84, v84, v2
v_add_f32 v100, v100, v3
v_add_f32 v85, v85, v2
v_add_f32 v101, v101, v3
v_add_f32 v86, v86, v2
v_add_f32 v102, v102, v3
v_add_f32 v87, v87, v2
v_add_f32 v103, v103, v3
v_add_f32 v88, v88, v2
v_add_f32 v104, v104, v3
v_add_f32 v89, v89, v2
v_add_f32 v105, v105, v3
v_add_f32 v90, v90, v2
v_add_f32 v106, v106, v3
v_add_f32 v91, v91, v2
v_add_f32 v107, v107, v3
v_add_f32 v92, v92, v2
v_add_f32 v108, v108, v3
v_add_f32 v93, v93, v2
v_add_f32 v109, v109, v3
v_add_f32 v94, v94, v2
v_add_f32 v110, v110, v3
v_add_f32 v95, v95, v2
v_add_f32 v111, v111, v3
v_mov_b32 v48, v2
v_mov_b32 v64, v3
v_mov_b32 v49, v2
v_mov_b32 v65, v3
v_mov_b32 v50, v2
v_mov_b32 v66, v3
v_mov_b32 v51, v2
v_mov_b32 v67, v3
v_mov_b32 v52, v2
v_mov_b32 v68, v3
v_mov_b32 v53, v2
v_mov_b32 v69, v3
v_mov_b32 v54, v2
v_mov_b32 v70, v3
v_mov_b32 v55, v2
v_mov_b32 v71, v3
v_mov_b32 v56, v2
v_mov_b32 v72, v3
v_mov_b32 v57, v2
v_mov_b32 v73, v3
v_mov_b32 v58, v2
v_mov_b32 v74, v3
v_mov_b32 v59, v2
v_mov_b32 v75, v3
v_mov_b32 v60, v2
v_mov_b32 v76, v3
v_mov_b32 v61, v2
v_mov_b32 v77, v3
v_mov_b32 v62, v2
v_mov_b32 v78, v3
v_mov_b32 v63, v2
v_mov_b32 v79, v3
s_mov_b32 s35, 0
L_at_loop2:
v_exp_f32 v80, v80
v_exp_f32 v81, v81
v_exp_f32 v82, v82
v_mfma_f32_32x32x16_bf16 v[160:175], v[44:47], v[136:139], v[160:175]
ds_read_b128 v[44:47], v14 offset:768
v_exp_f32 v83, v83
v_cvt_pk_bf16_f32 v80, v80, v81
v_exp_f32 v84, v84
v_exp_f32 v85, v85
v_cvt_pk_bf16_f32 v81, v82, v83
v_exp_f32 v86, v86
v_exp_f32 v87, v87
v_cvt_pk_bf16_f32 v82, v84, v85
s_waitcnt lgkmcnt(0)
v_mfma_f32_32x32x4_2b_bf16 v[112:143], v[34:35], v[32:33], v[48:79]
ds_read_b64 v[34:35], v13 offset:3072
v_cvt_pk_bf16_f32 v83, v86, v87
v_exp_f32 v88, v88
v_exp_f32 v89, v89
v_exp_f32 v90, v90
v_exp_f32 v91, v91
v_cvt_pk_bf16_f32 v88, v88, v89
v_exp_f32 v92, v92
v_exp_f32 v93, v93
v_mfma_f32_32x32x16_bf16 v[144:159], v[40:43], v[80:83], v[144:159]
v_cvt_pk_bf16_f32 v89, v90, v91
v_exp_f32 v94, v94
v_exp_f32 v95, v95
v_cvt_pk_bf16_f32 v90, v92, v93
v_cvt_pk_bf16_f32 v91, v94, v95
v_exp_f32 v96, v96
v_exp_f32 v97, v97
v_exp_f32 v98, v98
v_mfma_f32_32x32x16_bf16 v[144:159], v[44:47], v[88:91], v[144:159]
v_exp_f32 v99, v99
v_cvt_pk_bf16_f32 v96, v96, v97
v_exp_f32 v100, v100
v_exp_f32 v101, v101
v_cvt_pk_bf16_f32 v97, v98, v99
v_mfma_f32_32x32x16_bf16 v[112:127], v[36:39], v[24:27], v[112:127]
v_exp_f32 v102, v102
v_exp_f32 v103, v103
v_cvt_pk_bf16_f32 v98, v100, v101
v_cvt_pk_bf16_f32 v99, v102, v103
v_exp_f32 v104, v104
v_exp_f32 v105, v105
v_exp_f32 v106, v106
v_mfma_f32_32x32x16_bf16 v[160:175], v[40:43], v[96:99], v[160:175]
ds_read_b128 v[40:43], v14 offset:3072
v_exp_f32 v107, v107
v_cvt_pk_bf16_f32 v104, v104, v105
v_exp_f32 v108, v108
v_exp_f32 v109, v109
v_cvt_pk_bf16_f32 v105, v106, v107
v_mfma_f32_32x32x16_bf16 v[128:143], v[36:39], v[28:31], v[128:143]
ds_read_b128 v[36:39], v12 offset:3072
v_exp_f32 v110, v110
v_exp_f32 v111, v111
v_cvt_pk_bf16_f32 v106, v108, v109
v_cvt_pk_bf16_f32 v107, v110, v111
v_exp_f32 v112, v112
v_exp_f32 v113, v113
v_exp_f32 v114, v114
v_mfma_f32_32x32x16_bf16 v[160:175], v[44:47], v[104:107], v[160:175]
ds_read_b128 v[44:47], v14 offset:3840
v_exp_f32 v115, v115
v_cvt_pk_bf16_f32 v112, v112, v113
v_exp_f32 v116, v116
v_exp_f32 v117, v117
v_cvt_pk_bf16_f32 v113, v114, v115
v_exp_f32 v118, v118
v_exp_f32 v119, v119
v_cvt_pk_bf16_f32 v114, v116, v117
s_waitcnt lgkmcnt(0)
v_mfma_f32_32x32x4_2b_bf16 v[80:111], v[34:35], v[32:33], v[48:79]
ds_read_b64 v[34:35], v13 offset:6144
v_cvt_pk_bf16_f32 v115, v118, v119
v_exp_f32 v120, v120
v_exp_f32 v121, v121
v_exp_f32 v122, v122
v_exp_f32 v123, v123
v_cvt_pk_bf16_f32 v120, v120, v121
v_exp_f32 v124, v124
v_exp_f32 v125, v125
v_mfma_f32_32x32x16_bf16 v[144:159], v[40:43], v[112:115], v[144:159]
v_cvt_pk_bf16_f32 v121, v122, v123
v_exp_f32 v126, v126
v_exp_f32 v127, v127
v_cvt_pk_bf16_f32 v122, v124, v125
v_cvt_pk_bf16_f32 v123, v126, v127
v_exp_f32 v128, v128
v_exp_f32 v129, v129
v_exp_f32 v130, v130
v_mfma_f32_32x32x16_bf16 v[144:159], v[44:47], v[120:123], v[144:159]
v_exp_f32 v131, v131
v_cvt_pk_bf16_f32 v128, v128, v129
v_exp_f32 v132, v132
v_exp_f32 v133, v133
v_cvt_pk_bf16_f32 v129, v130, v131
v_mfma_f32_32x32x16_bf16 v[80:95], v[36:39], v[24:27], v[80:95]
v_exp_f32 v134, v134
v_exp_f32 v135, v135
v_cvt_pk_bf16_f32 v130, v132, v133
v_cvt_pk_bf16_f32 v131, v134, v135
v_exp_f32 v136, v136
v_exp_f32 v137, v137
v_exp_f32 v138, v138
v_mfma_f32_32x32x16_bf16 v[160:175], v[40:43], v[128:131], v[160:175]
ds_read_b128 v[40:43], v14 offset:6144
v_exp_f32 v139, v139
v_cvt_pk_bf16_f32 v136, v136, v137
v_exp_f32 v140, v140
v_exp_f32 v141, v141
v_cvt_pk_bf16_f32 v137, v138, v139
v_mfma_f32_32x32x16_bf16 v[96:111], v[36:39], v[28:31], v[96:111]
ds_read_b128 v[36:39], v12 offset:6144
v_exp_f32 v142, v142
v_exp_f32 v143, v143
v_cvt_pk_bf16_f32 v138, v140, v141
v_cvt_pk_bf16_f32 v139, v142, v143
v_exp_f32 v80, v80
v_exp_f32 v81, v81
v_exp_f32 v82, v82
v_mfma_f32_32x32x16_bf16 v[160:175], v[44:47], v[136:139], v[160:175]
ds_read_b128 v[44:47], v14 offset:6912
v_exp_f32 v83, v83
v_cvt_pk_bf16_f32 v80, v80, v81
v_exp_f32 v84, v84
v_exp_f32 v85, v85
v_cvt_pk_bf16_f32 v81, v82, v83
v_exp_f32 v86, v86
v_exp_f32 v87, v87
v_cvt_pk_bf16_f32 v82, v84, v85
s_waitcnt lgkmcnt(0)
v_mfma_f32_32x32x4_2b_bf16 v[112:143], v[34:35], v[32:33], v[48:79]
ds_read_b64 v[34:35], v13 offset:9216
v_cvt_pk_bf16_f32 v83, v86, v87
v_exp_f32 v88, v88
v_exp_f32 v89, v89
v_exp_f32 v90, v90
v_exp_f32 v91, v91
v_cvt_pk_bf16_f32 v88, v88, v89
v_exp_f32 v92, v92
v_exp_f32 v93, v93
v_mfma_f32_32x32x16_bf16 v[144:159], v[40:43], v[80:83], v[144:159]
v_cvt_pk_bf16_f32 v89, v90, v91
v_exp_f32 v94, v94
v_exp_f32 v95, v95
v_cvt_pk_bf16_f32 v90, v92, v93
v_cvt_pk_bf16_f32 v91, v94, v95
v_exp_f32 v96, v96
v_exp_f32 v97, v97
v_exp_f32 v98, v98
v_mfma_f32_32x32x16_bf16 v[144:159], v[44:47], v[88:91], v[144:159]
v_exp_f32 v99, v99
v_cvt_pk_bf16_f32 v96, v96, v97
v_exp_f32 v100, v100
v_exp_f32 v101, v101
v_cvt_pk_bf16_f32 v97, v98, v99
v_mfma_f32_32x32x16_bf16 v[112:127], v[36:39], v[24:27], v[112:127]
v_exp_f32 v102, v102
v_exp_f32 v103, v103
v_cvt_pk_bf16_f32 v98, v100, v101
v_cvt_pk_bf16_f32 v99, v102, v103
v_exp_f32 v104, v104
v_exp_f32 v105, v105
v_exp_f32 v106, v106
v_mfma_f32_32x32x16_bf16 v[160:175], v[40:43], v[96:99], v[160:175]
ds_read_b128 v[40:43], v14 offset:9216
v_exp_f32 v107, v107
v_cvt_pk_bf16_f32 v104, v104, v105
v_exp_f32 v108, v108
v_exp_f32 v109, v109
v_cvt_pk_bf16_f32 v105, v106, v107
v_mfma_f32_32x32x16_bf16 v[128:143], v[36:39], v[28:31], v[128:143]
ds_read_b128 v[36:39], v12 offset:9216
v_exp_f32 v110, v110
v_exp_f32 v111, v111
v_cvt_pk_bf16_f32 v106, v108, v109
v_cvt_pk_bf16_f32 v107, v110, v111
v_exp_f32 v112, v112
v_exp_f32 v113, v113
v_exp_f32 v114, v114
v_mfma_f32_32x32x16_bf16 v[160:175], v[44:47], v[104:107], v[160:175]
ds_read_b128 v[44:47], v14 offset:9984
v_exp_f32 v115, v115
v_cvt_pk_bf16_f32 v112, v112, v113
v_exp_f32 v116, v116
v_exp_f32 v117, v117
v_cvt_pk_bf16_f32 v113, v114, v115
v_exp_f32 v118, v118
v_exp_f32 v119, v119
v_cvt_pk_bf16_f32 v114, v116, v117
s_waitcnt vmcnt(0) lgkmcnt(0)
s_barrier
v_mfma_f32_32x32x4_2b_bf16 v[80:111], v[34:35], v[32:33], v[48:79]
s_cmp_eq_u32 s35, 3
s_cbranch_scc1 L_ats_15
s_add_u32 m0, s33, 0
s_sub_u32 s24, s32, s0
buffer_load_dwordx4 v6, s[4:7], s32 offen sc1 lds
buffer_load_dwordx4 v6, s[4:7], s32 offen offset:1024 sc1 lds
buffer_load_dwordx4 v15, s[4:7], s24 offen offset:2048 sc1 lds
s_add_u32 s32, s32, 12288
L_ats_15:
ds_read_b64 v[34:35], v13 offset:12288
v_cvt_pk_bf16_f32 v115, v118, v119
v_exp_f32 v120, v120
v_exp_f32 v121, v121
v_exp_f32 v122, v122
v_exp_f32 v123, v123
v_cvt_pk_bf16_f32 v120, v120, v121
v_exp_f32 v124, v124
v_exp_f32 v125, v125
v_mfma_f32_32x32x16_bf16 v[144:159], v[40:43], v[112:115], v[144:159]
v_cvt_pk_bf16_f32 v121, v122, v123
v_exp_f32 v126, v126
v_exp_f32 v127, v127
v_cvt_pk_bf16_f32 v122, v124, v125
v_cvt_pk_bf16_f32 v123, v126, v127
v_exp_f32 v128, v128
v_exp_f32 v129, v129
v_exp_f32 v130, v130
v_mfma_f32_32x32x16_bf16 v[144:159], v[44:47], v[120:123], v[144:159]
v_exp_f32 v131, v131
v_cvt_pk_bf16_f32 v128, v128, v129
v_exp_f32 v132, v132
v_exp_f32 v133, v133
v_cvt_pk_bf16_f32 v129, v130, v131
v_mfma_f32_32x32x16_bf16 v[80:95], v[36:39], v[24:27], v[80:95]
v_exp_f32 v134, v134
v_exp_f32 v135, v135
v_cvt_pk_bf16_f32 v130, v132, v133
v_cvt_pk_bf16_f32 v131, v134, v135
v_exp_f32 v136, v136
v_exp_f32 v137, v137
v_exp_f32 v138, v138
v_mfma_f32_32x32x16_bf16 v[160:175], v[40:43], v[128:131], v[160:175]
ds_read_b128 v[40:43], v14 offset:12288
v_exp_f32 v139, v139
v_cvt_pk_bf16_f32 v136, v136, v137
v_exp_f32 v140, v140
v_exp_f32 v141, v141
v_cvt_pk_bf16_f32 v137, v138, v139
v_mfma_f32_32x32x16_bf16 v[96:111], v[36:39], v[28:31], v[96:111]
ds_read_b128 v[36:39], v12 offset:12288
v_exp_f32 v142, v142
v_exp_f32 v143, v143
v_cvt_pk_bf16_f32 v138, v140, v141
v_cvt_pk_bf16_f32 v139, v142, v143
v_exp_f32 v80, v80
v_exp_f32 v81, v81
v_exp_f32 v82, v82
v_mfma_f32_32x32x16_bf16 v[160:175], v[44:47], v[136:139], v[160:175]
ds_read_b128 v[44:47], v14 offset:13056
v_exp_f32 v83, v83
v_cvt_pk_bf16_f32 v80, v80, v81
v_exp_f32 v84, v84
v_exp_f32 v85, v85
v_cvt_pk_bf16_f32 v81, v82, v83
v_exp_f32 v86, v86
v_exp_f32 v87, v87
v_cvt_pk_bf16_f32 v82, v84, v85
s_waitcnt lgkmcnt(0)
v_mfma_f32_32x32x4_2b_bf16 v[112:143], v[34:35], v[32:33], v[48:79]
ds_read_b64 v[34:35], v13 offset:15360
v_cvt_pk_bf16_f32 v83, v86, v87
v_exp_f32 v88, v88
v_exp_f32 v89, v89
v_exp_f32 v90, v90
v_exp_f32 v91, v91
v_cvt_pk_bf16_f32 v88, v88, v89
v_exp_f32 v92, v92
v_exp_f32 v93, v93
v_mfma_f32_32x32x16_bf16 v[144:159], v[40:43], v[80:83], v[144:159]
v_cvt_pk_bf16_f32 v89, v90, v91
v_exp_f32 v94, v94
v_exp_f32 v95, v95
v_cvt_pk_bf16_f32 v90, v92, v93
v_cvt_pk_bf16_f32 v91, v94, v95
v_exp_f32 v96, v96
v_exp_f32 v97, v97
v_exp_f32 v98, v98
v_mfma_f32_32x32x16_bf16 v[144:159], v[44:47], v[88:91], v[144:159]
v_exp_f32 v99, v99
v_cvt_pk_bf16_f32 v96, v96, v97
v_exp_f32 v100, v100
v_exp_f32 v101, v101
v_cvt_pk_bf16_f32 v97, v98, v99
v_mfma_f32_32x32x16_bf16 v[112:127], v[36:39], v[24:27], v[112:127]
v_exp_f32 v102, v102
v_exp_f32 v103, v103
v_cvt_pk_bf16_f32 v98, v100, v101
v_cvt_pk_bf16_f32 v99, v102, v103
v_exp_f32 v104, v104
v_exp_f32 v105, v105
v_exp_f32 v106, v106
v_mfma_f32_32x32x16_bf16 v[160:175], v[40:43], v[96:99], v[160:175]
ds_read_b128 v[40:43], v14 offset:15360
v_exp_f32 v107, v107
v_cvt_pk_bf16_f32 v104, v104, v105
v_exp_f32 v108, v108
v_exp_f32 v109, v109
v_cvt_pk_bf16_f32 v105, v106, v107
v_mfma_f32_32x32x16_bf16 v[128:143], v[36:39], v[28:31], v[128:143]
ds_read_b128 v[36:39], v12 offset:15360
v_exp_f32 v110, v110
v_exp_f32 v111, v111
v_cvt_pk_bf16_f32 v106, v108, v109
v_cvt_pk_bf16_f32 v107, v110, v111
v_exp_f32 v112, v112
v_exp_f32 v113, v113
v_exp_f32 v114, v114
v_mfma_f32_32x32x16_bf16 v[160:175], v[44:47], v[104:107], v[160:175]
ds_read_b128 v[44:47], v14 offset:16128
v_exp_f32 v115, v115
v_cvt_pk_bf16_f32 v112, v112, v113
v_exp_f32 v116, v116
v_exp_f32 v117, v117
v_cvt_pk_bf16_f32 v113, v114, v115
v_exp_f32 v118, v118
v_exp_f32 v119, v119
v_cvt_pk_bf16_f32 v114, v116, v117
s_waitcnt lgkmcnt(0)
v_mfma_f32_32x32x4_2b_bf16 v[80:111], v[34:35], v[32:33], v[48:79]
ds_read_b64 v[34:35], v13 offset:18432
v_cvt_pk_bf16_f32 v115, v118, v119
v_exp_f32 v120, v120
v_exp_f32 v121, v121
v_exp_f32 v122, v122
v_exp_f32 v123, v123
v_cvt_pk_bf16_f32 v120, v120, v121
v_exp_f32 v124, v124
v_exp_f32 v125, v125
v_mfma_f32_32x32x16_bf16 v[144:159], v[40:43], v[112:115], v[144:159]
v_cvt_pk_bf16_f32 v121, v122, v123
v_exp_f32 v126, v126
v_exp_f32 v127, v127
v_cvt_pk_bf16_f32 v122, v124, v125
v_cvt_pk_bf16_f32 v123, v126, v127
v_exp_f32 v128, v128
v_exp_f32 v129, v129
v_exp_f32 v130, v130
v_mfma_f32_32x32x16_bf16 v[144:159], v[44:47], v[120:123], v[144:159]
v_exp_f32 v131, v131
v_cvt_pk_bf16_f32 v128, v128, v129
v_exp_f32 v132, v132
v_exp_f32 v133, v133
v_cvt_pk_bf16_f32 v129, v130, v131
v_mfma_f32_32x32x16_bf16 v[80:95], v[36:39], v[24:27], v[80:95]
v_exp_f32 v134, v134
v_exp_f32 v135, v135
v_cvt_pk_bf16_f32 v130, v132, v133
v_cvt_pk_bf16_f32 v131, v134, v135
v_exp_f32 v136, v136
v_exp_f32 v137, v137
v_exp_f32 v138, v138
v_mfma_f32_32x32x16_bf16 v[160:175], v[40:43], v[128:131], v[160:175]
ds_read_b128 v[40:43], v14 offset:18432
v_exp_f32 v139, v139
v_cvt_pk_bf16_f32 v136, v136, v137
v_exp_f32 v140, v140
v_exp_f32 v141, v141
v_cvt_pk_bf16_f32 v137, v138, v139
v_mfma_f32_32x32x16_bf16 v[96:111], v[36:39], v[28:31], v[96:111]
ds_read_b128 v[36:39], v12 offset:18432
v_exp_f32 v142, v142
v_exp_f32 v143, v143
v_cvt_pk_bf16_f32 v138, v140, v141
v_cvt_pk_bf16_f32 v139, v142, v143
v_exp_f32 v80, v80
v_exp_f32 v81, v81
v_exp_f32 v82, v82
v_mfma_f32_32x32x16_bf16 v[160:175], v[44:47], v[136:139], v[160:175]
ds_read_b128 v[44:47], v14 offset:19200
v_exp_f32 v83, v83
v_cvt_pk_bf16_f32 v80, v80, v81
v_exp_f32 v84, v84
v_exp_f32 v85, v85
v_cvt_pk_bf16_f32 v81, v82, v83
v_exp_f32 v86, v86
v_exp_f32 v87, v87
v_cvt_pk_bf16_f32 v82, v84, v85
s_waitcnt lgkmcnt(0)
v_mfma_f32_32x32x4_2b_bf16 v[112:143], v[34:35], v[32:33], v[48:79]
ds_read_b64 v[34:35], v13 offset:21504
v_cvt_pk_bf16_f32 v83, v86, v87
v_exp_f32 v88, v88
v_exp_f32 v89, v89
v_exp_f32 v90, v90
v_exp_f32 v91, v91
v_cvt_pk_bf16_f32 v88, v88, v89
v_exp_f32 v92, v92
v_exp_f32 v93, v93
v_mfma_f32_32x32x16_bf16 v[144:159], v[40:43], v[80:83], v[144:159]
v_cvt_pk_bf16_f32 v89, v90, v91
v_exp_f32 v94, v94
v_exp_f32 v95, v95
v_cvt_pk_bf16_f32 v90, v92, v93
v_cvt_pk_bf16_f32 v91, v94, v95
v_exp_f32 v96, v96
v_exp_f32 v97, v97
v_exp_f32 v98, v98
v_mfma_f32_32x32x16_bf16 v[144:159], v[44:47], v[88:91], v[144:159]
v_exp_f32 v99, v99
v_cvt_pk_bf16_f32 v96, v96, v97
v_exp_f32 v100, v100
v_exp_f32 v101, v101
v_cvt_pk_bf16_f32 v97, v98, v99
v_mfma_f32_32x32x16_bf16 v[112:127], v[36:39], v[24:27], v[112:127]
v_exp_f32 v102, v102
v_exp_f32 v103, v103
v_cvt_pk_bf16_f32 v98, v100, v101
v_cvt_pk_bf16_f32 v99, v102, v103
v_exp_f32 v104, v104
v_exp_f32 v105, v105
v_exp_f32 v106, v106
v_mfma_f32_32x32x16_bf16 v[160:175], v[40:43], v[96:99], v[160:175]
ds_read_b128 v[40:43], v14 offset:21504
v_exp_f32 v107, v107
v_cvt_pk_bf16_f32 v104, v104, v105
v_exp_f32 v108, v108
v_exp_f32 v109, v109
v_cvt_pk_bf16_f32 v105, v106, v107
v_mfma_f32_32x32x16_bf16 v[128:143], v[36:39], v[28:31], v[128:143]
ds_read_b128 v[36:39], v12 offset:21504
v_exp_f32 v110, v110
v_exp_f32 v111, v111
v_cvt_pk_bf16_f32 v106, v108, v109
v_cvt_pk_bf16_f32 v107, v110, v111
v_exp_f32 v112, v112
v_exp_f32 v113, v113
v_exp_f32 v114, v114
v_mfma_f32_32x32x16_bf16 v[160:175], v[44:47], v[104:107], v[160:175]
ds_read_b128 v[44:47], v14 offset:22272
v_exp_f32 v115, v115
v_cvt_pk_bf16_f32 v112, v112, v113
v_exp_f32 v116, v116
v_exp_f32 v117, v117
v_cvt_pk_bf16_f32 v113, v114, v115
v_exp_f32 v118, v118
v_exp_f32 v119, v119
v_cvt_pk_bf16_f32 v114, v116, v117
s_waitcnt vmcnt(0) lgkmcnt(0)
s_barrier
v_mfma_f32_32x32x4_2b_bf16 v[80:111], v[34:35], v[32:33], v[48:79]
s_cmp_eq_u32 s35, 3
s_cbranch_scc1 L_ats_16
s_add_u32 m0, s33, 12288
s_sub_u32 s24, s32, s0
buffer_load_dwordx4 v6, s[4:7], s32 offen sc1 lds
buffer_load_dwordx4 v6, s[4:7], s32 offen offset:1024 sc1 lds
buffer_load_dwordx4 v15, s[4:7], s24 offen offset:2048 sc1 lds
s_add_u32 s32, s32, 12288
L_ats_16:
ds_read_b64 v[34:35], v13 offset:0
v_cvt_pk_bf16_f32 v115, v118, v119
v_exp_f32 v120, v120
v_exp_f32 v121, v121
v_exp_f32 v122, v122
v_exp_f32 v123, v123
v_cvt_pk_bf16_f32 v120, v120, v121
v_exp_f32 v124, v124
v_exp_f32 v125, v125
v_mfma_f32_32x32x16_bf16 v[144:159], v[40:43], v[112:115], v[144:159]
v_cvt_pk_bf16_f32 v121, v122, v123
v_exp_f32 v126, v126
v_exp_f32 v127, v127
v_cvt_pk_bf16_f32 v122, v124, v125
v_cvt_pk_bf16_f32 v123, v126, v127
v_exp_f32 v128, v128
v_exp_f32 v129, v129
v_exp_f32 v130, v130
v_mfma_f32_32x32x16_bf16 v[144:159], v[44:47], v[120:123], v[144:159]
v_exp_f32 v131, v131
v_cvt_pk_bf16_f32 v128, v128, v129
v_exp_f32 v132, v132
v_exp_f32 v133, v133
v_cvt_pk_bf16_f32 v129, v130, v131
v_mfma_f32_32x32x16_bf16 v[80:95], v[36:39], v[24:27], v[80:95]
v_exp_f32 v134, v134
v_exp_f32 v135, v135
v_cvt_pk_bf16_f32 v130, v132, v133
v_cvt_pk_bf16_f32 v131, v134, v135
v_exp_f32 v136, v136
v_exp_f32 v137, v137
v_exp_f32 v138, v138
v_mfma_f32_32x32x16_bf16 v[160:175], v[40:43], v[128:131], v[160:175]
ds_read_b128 v[40:43], v14 offset:0
v_exp_f32 v139, v139
v_cvt_pk_bf16_f32 v136, v136, v137
v_exp_f32 v140, v140
v_exp_f32 v141, v141
v_cvt_pk_bf16_f32 v137, v138, v139
v_mfma_f32_32x32x16_bf16 v[96:111], v[36:39], v[28:31], v[96:111]
ds_read_b128 v[36:39], v12 offset:0
v_exp_f32 v142, v142
v_exp_f32 v143, v143
v_cvt_pk_bf16_f32 v138, v140, v141
v_cvt_pk_bf16_f32 v139, v142, v143
s_add_u32 s35, s35, 1
s_cmp_lt_u32 s35, 4
s_cbranch_scc1 L_at_loop2
s_waitcnt lgkmcnt(0)
s_branch L_at_end
L_end:
s_endpgm
.section .rodata,"a"
.p2align 6
.amdhsa_kernel sequential_preLN__softmax_full_mha__swiglu_ffn__prompt_kernel
  .amdhsa_next_free_vgpr 256
  .amdhsa_next_free_sgpr 68
  .amdhsa_accum_offset 256
  .amdhsa_group_segment_fixed_size 0
  .amdhsa_kernarg_size 80
  .amdhsa_user_sgpr_count 2
  .amdhsa_user_sgpr_kernarg_segment_ptr 1
  .amdhsa_system_sgpr_workgroup_id_x 1
  .amdhsa_float_denorm_mode_32 3
.end_amdhsa_kernel
```
